```python
import torch

def _softmax(x, axis=-1):
    return torch.softmax(x, dim=axis)
def _gelu(x):
    return torch.nn.functional.gelu(x, approximate="tanh")
def _silu(x):
    return torch.nn.functional.silu(x)
def _sigmoid(x):
    return torch.sigmoid(x)
def _layernorm(x, axis=-1, eps=1e-5):
    m = x.mean(dim=axis, keepdim=True)
    v = x.var(dim=axis, keepdim=True, unbiased=False)
    return (x - m) / torch.sqrt(v + eps)
def _scatter_add(tgt, idx, src, axis=0):
    return tgt.clone().index_add_(axis, idx, src)
def _segment_sum(src, seg, n):
    out = torch.zeros((n,) + src.shape[1:], dtype=src.dtype)
    return out.index_add_(0, seg, src)
def _pad(x, pw):
    flat = tuple(v for pair in reversed(pw) for v in pair)
    return torch.nn.functional.pad(x, flat)

kernel_name = 'standalone__mha_softmax__near_ridge'

def setup_inputs():

    _w = (lambda a: (lambda t: t.to(torch.bfloat16) if t.is_floating_point() else t)(torch.as_tensor(a)))
    B, H, Sq, Sk, D = 8, 32, 1312, 512, 128
    return {
        "q": _w((lambda *s: torch.randn(*s, dtype=torch.bfloat16) * 0.8)(B, H, Sq, D)),
        "k": _w((lambda *s: torch.randn(*s, dtype=torch.bfloat16) * 0.8)(B, H, Sk, D)),
        "v": _w((lambda *s: torch.randn(*s, dtype=torch.bfloat16) * 0.05)(B, H, Sk, D)),
    }

def reference(q, k, v):
    scale = q.shape[-1] ** -0.5
    scores = torch.einsum("bhqd,bhkd->bhqk", q, k) * scale
    p = _softmax(scores, axis=-1)
    return torch.einsum("bhqk,bhkd->bhqd", p, v)
```

```asm
; @launch grid=(256,1,1) block=(256,1,1) lds=161664
.amdgcn_target "amdgcn-amd-amdhsa--gfx950"
.text
.globl standalone__mha_softmax__near_ridge_kernel
.p2align 8
.type standalone__mha_softmax__near_ridge_kernel,@function
standalone__mha_softmax__near_ridge_kernel:
    s_cmp_ge_u32 s2, 256
    s_cbranch_scc1 L_end
    s_load_dwordx4 s[36:39], s[0:1], 0
    s_load_dwordx4 s[40:43], s[0:1], 16
    s_getpc_b64 s[56:57]
L_pc:
    s_and_b32 s57, s57, 0xffff
    s_mov_b32 s58, L_end-L_pc
    s_mov_b32 s59, 0x20000
    v_lshlrev_b32 v204, 7, v0
    s_getreg_b32 s73, hwreg(HW_REG_XCC_ID)
    s_bitcmp0_b32 s73, 0
    s_cselect_b32 s55, L_xs-L_pc, 0
    buffer_load_dword v232, v204, s[56:59], s55 offen
    v_and_b32 v200, 63, v0
    v_lshrrev_b32 v203, 6, v0
    s_nop 0
    v_readfirstlane_b32 s20, v203
    v_and_b32 v201, 15, v200
    v_lshrrev_b32 v202, 4, v200
    v_bfe_u32 v208, v200, 2, 2
    v_and_b32 v209, 3, v200
    s_and_b32 s3, s2, 7
    s_lshl_b32 s3, s3, 5
    s_lshr_b32 s75, s2, 3
    s_or_b32 s75, s75, s3
    s_mul_i32 s3, s75, 335872
    s_lshl_b32 s31, s75, 17
    s_lshl_b32 s46, s20, 11
    s_lshl_b32 s64, s20, 15
    v_lshlrev_b32 v7, 8, v208
    v_lshl_add_u32 v7, v202, 6, v7
    v_lshl_add_u32 v7, v209, 4, v7
    v_add_u32 v7, s46, v7
    s_mul_i32 s47, s20, 2080
    s_add_u32 s30, s47, 66560
    s_sub_u32 s44, s64, s46
    s_mul_i32 s54, s20, 8320
    s_add_u32 s54, s54, 33280
    s_mov_b32 s6, 335872
    s_mov_b32 s7, 0x20000
    s_mov_b32 s10, 131072
    s_mov_b32 s11, 0x20000
    s_mov_b32 s14, 131072
    s_mov_b32 s15, 0x20000
    s_mov_b32 s18, 335872
    s_mov_b32 s19, 0x20000
    s_waitcnt lgkmcnt(0)
    s_add_u32 s8, s38, s31
    s_addc_u32 s9, s39, 0
    s_and_b32 s9, s9, 0xffff
    s_add_u32 m0, s54, 0
    s_add_u32 s45, s44, 0
    buffer_load_dwordx4 v7, s[8:11], s45 offen offset:0 nt lds
    buffer_load_dwordx4 v7, s[8:11], s45 offen offset:1024 nt lds
    s_add_u32 m0, s54, 2080
    s_add_u32 s45, s44, 2048
    buffer_load_dwordx4 v7, s[8:11], s45 offen offset:0 nt lds
    buffer_load_dwordx4 v7, s[8:11], s45 offen offset:1024 nt lds
    s_add_u32 m0, s54, 4160
    s_add_u32 s45, s44, 4096
    buffer_load_dwordx4 v7, s[8:11], s45 offen offset:0 nt lds
    buffer_load_dwordx4 v7, s[8:11], s45 offen offset:1024 nt lds
    s_add_u32 m0, s54, 6240
    s_add_u32 s45, s44, 6144
    buffer_load_dwordx4 v7, s[8:11], s45 offen offset:0 nt lds
    buffer_load_dwordx4 v7, s[8:11], s45 offen offset:1024 nt lds
    s_add_u32 s4, s36, s3
    s_addc_u32 s5, s37, 0
    s_and_b32 s5, s5, 0xffff
    s_add_u32 m0, s30, 0
    s_mov_b32 s46, 0
    buffer_load_dwordx4 v7, s[4:7], s46 offen offset:0 nt lds
    buffer_load_dwordx4 v7, s[4:7], s46 offen offset:1024 nt lds
    s_add_u32 m0, s30, 8320
    s_mov_b32 s46, 8192
    buffer_load_dwordx4 v7, s[4:7], s46 offen offset:0 nt lds
    buffer_load_dwordx4 v7, s[4:7], s46 offen offset:1024 nt lds
    s_mov_b32 s55, L_xj-L_pc
    buffer_load_dword v233, v204, s[56:59], s55 offen
    s_add_u32 s12, s40, s31
    s_addc_u32 s13, s41, 0
    s_and_b32 s13, s13, 0xffff
    s_add_u32 s16, s42, s3
    s_addc_u32 s17, s43, 0
    s_and_b32 s17, s17, 0xffff
    s_add_u32 s65, s64, 4096
    s_add_u32 s66, s64, 8192
    s_add_u32 s67, s64, 12288
    s_add_u32 s68, s64, 16384
    s_add_u32 s69, s64, 20480
    s_add_u32 s70, s64, 24576
    s_add_u32 s71, s64, 28672
    s_add_u32 s27, s47, 124800
    v_lshlrev_b32 v203, 2, v202
    v_xor_b32 v203, v203, v201
    v_lshlrev_b32 v203, 4, v203
    v_lshl_add_u32 v0, v202, 8, v203
    s_lshl_b32 s72, s20, 12
    v_lshrrev_b32 v203, 2, v201
    v_lshlrev_b32 v2, 10, v203
    v_lshrrev_b32 v203, 3, v201
    v_lshl_add_u32 v2, v203, 5, v2
    v_lshl_add_u32 v2, v209, 6, v2
    v_lshl_add_u32 v2, v202, 4, v2
    v_add_u32 v1, 66560, v2
    s_add_u32 s49, s20, 0
    s_and_b32 s49, s49, 3
    s_lshl_b32 s50, s49, 13
    v_lshl_add_u32 v3, v200, 4, s50
    s_lshr_b32 s50, s50, 1
    s_add_u32 s50, s50, 108160
    s_add_u32 s49, s20, 1
    s_and_b32 s49, s49, 3
    s_lshl_b32 s51, s49, 13
    v_lshl_add_u32 v4, v200, 4, s51
    s_lshr_b32 s51, s51, 1
    s_add_u32 s51, s51, 108160
    s_add_u32 s49, s20, 2
    s_and_b32 s49, s49, 3
    s_lshl_b32 s52, s49, 13
    v_lshl_add_u32 v5, v200, 4, s52
    s_lshr_b32 s52, s52, 1
    s_add_u32 s52, s52, 108160
    s_add_u32 s49, s20, 3
    s_and_b32 s49, s49, 3
    s_lshl_b32 s53, s49, 13
    v_lshl_add_u32 v6, v200, 4, s53
    s_lshr_b32 s53, s53, 1
    s_add_u32 s53, s53, 108160
    s_lshl_b32 s49, s20, 6
    v_lshlrev_b32 v8, 8, v201
    v_lshl_add_u32 v8, v202, 4, v8
    v_add_u32 v8, s49, v8
    v_lshrrev_b32 v203, 1, v202
    v_lshl_add_u32 v203, v203, 4, v201
    v_lshlrev_b32 v203, 4, v203
    v_add_u32 v10, 157568, v203
    s_lshl_b32 s49, s20, 2
    v_add_u32 v9, s49, v10
    v_mov_b32 v11, 0
    v_mov_b32 v12, 0
    v_mov_b32 v203, 0x3f803f80
    v_and_b32 v204, 11, v201
    v_cmp_eq_u32 vcc, 0, v204
    s_nop 1
    v_cndmask_b32 v24, 0, v203, vcc
    v_cndmask_b32 v25, 0, v203, vcc
    v_cndmask_b32 v26, 0, v203, vcc
    v_cndmask_b32 v27, 0, v203, vcc
    v_cmp_eq_u32 vcc, 8, v204
    s_nop 1
    v_cndmask_b32 v28, 0, v203, vcc
    v_cndmask_b32 v29, 0, v203, vcc
    v_cndmask_b32 v30, 0, v203, vcc
    v_cndmask_b32 v31, 0, v203, vcc
    s_mov_b32 s25, 0
    s_mov_b32 s26, 4096
    v_lshlrev_b32 v203, 2, v208
    v_add_u32 v204, s49, v209
    v_xor_b32 v204, v204, v203
    v_lshl_add_u32 v205, v202, 2, v208
    v_lshlrev_b32 v205, 8, v205
    v_lshl_add_u32 v15, v204, 4, v205
    v_add_u32 v255, s54, v2
    v_lshrrev_b32 v203, 2, v201
    v_cmp_eq_u32 vcc, v203, v202
    v_and_b32 v203, 1, v200
    v_lshlrev_b32 v203, 4, v203
    v_and_b32 v204, 2, v200
    v_cmp_eq_u32 s[48:49], 0, v204
    v_mov_b32 v204, 0x3e03
    v_lshlrev_b32 v204, v203, v204
    v_cndmask_b32 v204, 0, v204, vcc
    v_cndmask_b32 v205, 0, v204, s[48:49]
    v_xor_b32 v204, v204, v205
    v_accvgpr_write_b32 a152, v205
    v_accvgpr_write_b32 a153, v204
    v_accvgpr_write_b32 a154, 0
    v_accvgpr_write_b32 a155, 0
    v_accvgpr_write_b32 a158, v205
    v_accvgpr_write_b32 a159, v204
    v_accvgpr_write_b32 a156, 0
    v_accvgpr_write_b32 a157, 0
    v_mov_b32 v204, 0xb9d8
    v_lshlrev_b32 v204, v203, v204
    v_cndmask_b32 v204, 0, v204, vcc
    v_cndmask_b32 v205, 0, v204, s[48:49]
    v_xor_b32 v204, v204, v205
    v_accvgpr_write_b32 a184, v205
    v_accvgpr_write_b32 a185, v204
    v_accvgpr_write_b32 a186, 0
    v_accvgpr_write_b32 a187, 0
    v_accvgpr_write_b32 a190, v205
    v_accvgpr_write_b32 a191, v204
    v_accvgpr_write_b32 a188, 0
    v_accvgpr_write_b32 a189, 0
    s_bitcmp0_b32 s73, 0
    s_cbranch_scc1 L_xs
    s_add_u32 s23, s30, 16640
    s_mov_b32 s22, 73728
    s_mov_b32 s24, 108160
    s_waitcnt vmcnt(5)
    ds_read_b128 a[0:3], v255 offset:0
    ds_read_b128 a[4:7], v255 offset:256
    ds_read_b128 a[8:11], v255 offset:512
    ds_read_b128 a[12:15], v255 offset:768
    ds_read_b128 a[16:19], v255 offset:4160
    ds_read_b128 a[20:23], v255 offset:4416
    ds_read_b128 a[24:27], v255 offset:4672
    ds_read_b128 a[28:31], v255 offset:4928
    s_waitcnt lgkmcnt(7)
    v_mfma_f32_16x16x32_bf16 v[192:195], a[152:155], a[0:3], 0
    s_nop 1
    v_mfma_f32_16x16x32_bf16 v[192:195], a[184:187], a[0:3], v[192:195]
    s_nop 1
    v_mfma_f32_16x16x32_bf16 v[196:199], a[156:159], a[0:3], 0
    s_add_u32 m0, s30, 16640
    s_mov_b32 s46, 16384
    buffer_load_dwordx4 v7, s[4:7], s46 offen offset:0 nt lds
    s_nop 1
    v_mfma_f32_16x16x32_bf16 v[196:199], a[188:191], a[0:3], v[196:199]
    s_nop 1
    s_waitcnt lgkmcnt(6)
    v_mfma_f32_16x16x32_bf16 v[16:19], a[152:155], a[4:7], 0
    v_cvt_pk_bf16_f32 v192, v192, v193
    v_cvt_pk_bf16_f32 v193, v194, v195
    v_mfma_f32_16x16x32_bf16 v[16:19], a[184:187], a[4:7], v[16:19]
    v_accvgpr_write_b32 a0, v192
    v_accvgpr_write_b32 a1, v193
    v_mfma_f32_16x16x32_bf16 v[192:195], a[156:159], a[4:7], 0
    buffer_load_dwordx4 v7, s[4:7], s46 offen offset:1024 nt lds
    v_cvt_pk_bf16_f32 v196, v196, v197
    v_cvt_pk_bf16_f32 v197, v198, v199
    v_mfma_f32_16x16x32_bf16 v[192:195], a[188:191], a[4:7], v[192:195]
    v_accvgpr_write_b32 a2, v196
    v_accvgpr_write_b32 a3, v197
    s_waitcnt lgkmcnt(5)
    v_mfma_f32_16x16x32_bf16 v[196:199], a[152:155], a[8:11], 0
    v_cvt_pk_bf16_f32 v16, v16, v17
    v_cvt_pk_bf16_f32 v17, v18, v19
    v_mfma_f32_16x16x32_bf16 v[196:199], a[184:187], a[8:11], v[196:199]
    v_accvgpr_write_b32 a4, v16
    v_accvgpr_write_b32 a5, v17
    v_mfma_f32_16x16x32_bf16 v[16:19], a[156:159], a[8:11], 0
    s_add_u32 m0, s72, 124800
    s_nop 0
    buffer_load_dwordx4 v0, s[12:15], s64 offen offset:0 nt lds
    v_cvt_pk_bf16_f32 v192, v192, v193
    v_cvt_pk_bf16_f32 v193, v194, v195
    v_mfma_f32_16x16x32_bf16 v[16:19], a[188:191], a[8:11], v[16:19]
    v_accvgpr_write_b32 a6, v192
    v_accvgpr_write_b32 a7, v193
    s_waitcnt lgkmcnt(4)
    v_mfma_f32_16x16x32_bf16 v[192:195], a[152:155], a[12:15], 0
    v_cvt_pk_bf16_f32 v196, v196, v197
    v_cvt_pk_bf16_f32 v197, v198, v199
    v_mfma_f32_16x16x32_bf16 v[192:195], a[184:187], a[12:15], v[192:195]
    v_accvgpr_write_b32 a8, v196
    v_accvgpr_write_b32 a9, v197
    v_mfma_f32_16x16x32_bf16 v[196:199], a[156:159], a[12:15], 0
    buffer_load_dwordx4 v0, s[12:15], s64 offen offset:1024 nt lds
    v_cvt_pk_bf16_f32 v16, v16, v17
    v_cvt_pk_bf16_f32 v17, v18, v19
    v_mfma_f32_16x16x32_bf16 v[196:199], a[188:191], a[12:15], v[196:199]
    v_accvgpr_write_b32 a10, v16
    v_accvgpr_write_b32 a11, v17
    s_waitcnt lgkmcnt(3)
    v_mfma_f32_16x16x32_bf16 v[16:19], a[152:155], a[16:19], 0
    v_cvt_pk_bf16_f32 v192, v192, v193
    v_cvt_pk_bf16_f32 v193, v194, v195
    v_mfma_f32_16x16x32_bf16 v[16:19], a[184:187], a[16:19], v[16:19]
    v_accvgpr_write_b32 a12, v192
    v_accvgpr_write_b32 a13, v193
    v_mfma_f32_16x16x32_bf16 v[192:195], a[156:159], a[16:19], 0
    buffer_load_dwordx4 v0, s[12:15], s64 offen offset:2048 nt lds
    s_waitcnt vmcnt(6)
    s_barrier
    v_cvt_pk_bf16_f32 v196, v196, v197
    v_cvt_pk_bf16_f32 v197, v198, v199
    v_mfma_f32_16x16x32_bf16 v[192:195], a[188:191], a[16:19], v[192:195]
    v_accvgpr_write_b32 a14, v196
    v_accvgpr_write_b32 a15, v197
    s_waitcnt lgkmcnt(2)
    v_mfma_f32_16x16x32_bf16 v[196:199], a[152:155], a[20:23], 0
    ds_read_b128 v[32:35], v1 offset:0
    ds_read_b128 v[36:39], v1 offset:256
    v_cvt_pk_bf16_f32 v16, v16, v17
    v_cvt_pk_bf16_f32 v17, v18, v19
    v_mfma_f32_16x16x32_bf16 v[196:199], a[184:187], a[20:23], v[196:199]
    v_accvgpr_write_b32 a16, v16
    v_accvgpr_write_b32 a17, v17
    v_mfma_f32_16x16x32_bf16 v[16:19], a[156:159], a[20:23], 0
    buffer_load_dwordx4 v0, s[12:15], s64 offen offset:3072 nt lds
    ds_read_b128 v[40:43], v1 offset:512
    ds_read_b128 v[44:47], v1 offset:768
    v_cvt_pk_bf16_f32 v192, v192, v193
    v_cvt_pk_bf16_f32 v193, v194, v195
    v_mfma_f32_16x16x32_bf16 v[16:19], a[188:191], a[20:23], v[16:19]
    v_accvgpr_write_b32 a18, v192
    v_accvgpr_write_b32 a19, v193
    s_waitcnt lgkmcnt(5)
    v_mfma_f32_16x16x32_bf16 v[192:195], a[152:155], a[24:27], 0
    ds_read_b128 v[48:51], v1 offset:4160
    ds_read_b128 v[52:55], v1 offset:4416
    v_cvt_pk_bf16_f32 v196, v196, v197
    v_cvt_pk_bf16_f32 v197, v198, v199
    v_mfma_f32_16x16x32_bf16 v[192:195], a[184:187], a[24:27], v[192:195]
    v_accvgpr_write_b32 a20, v196
    v_accvgpr_write_b32 a21, v197
    v_mfma_f32_16x16x32_bf16 v[196:199], a[156:159], a[24:27], 0
    s_add_u32 m0, s72, 141184
    s_nop 0
    buffer_load_dwordx4 v0, s[12:15], s65 offen offset:0 nt lds
    ds_read_b128 v[56:59], v1 offset:4672
    ds_read_b128 v[60:63], v1 offset:4928
    v_cvt_pk_bf16_f32 v16, v16, v17
    v_cvt_pk_bf16_f32 v17, v18, v19
    v_mfma_f32_16x16x32_bf16 v[196:199], a[188:191], a[24:27], v[196:199]
    v_accvgpr_write_b32 a22, v16
    v_accvgpr_write_b32 a23, v17
    s_waitcnt lgkmcnt(8)
    v_mfma_f32_16x16x32_bf16 v[16:19], a[152:155], a[28:31], 0
    v_cvt_pk_bf16_f32 v192, v192, v193
    v_cvt_pk_bf16_f32 v193, v194, v195
    v_mfma_f32_16x16x32_bf16 v[16:19], a[184:187], a[28:31], v[16:19]
    v_accvgpr_write_b32 a24, v192
    v_accvgpr_write_b32 a25, v193
    v_mfma_f32_16x16x32_bf16 v[192:195], a[156:159], a[28:31], 0
    buffer_load_dwordx4 v0, s[12:15], s65 offen offset:1024 nt lds
    v_cvt_pk_bf16_f32 v196, v196, v197
    v_cvt_pk_bf16_f32 v197, v198, v199
    v_mfma_f32_16x16x32_bf16 v[192:195], a[188:191], a[28:31], v[192:195]
    v_accvgpr_write_b32 a26, v196
    v_accvgpr_write_b32 a27, v197
    s_waitcnt lgkmcnt(4)
    v_mfma_f32_16x16x32_bf16 v[64:67], a[0:3], v[32:35], -4.0
    v_cvt_pk_bf16_f32 v16, v16, v17
    v_cvt_pk_bf16_f32 v17, v18, v19
    v_accvgpr_write_b32 a28, v16
    v_accvgpr_write_b32 a29, v17
    v_mfma_f32_16x16x32_bf16 v[64:67], a[4:7], v[36:39], v[64:67]
    v_cvt_pk_bf16_f32 v192, v192, v193
    v_cvt_pk_bf16_f32 v193, v194, v195
    v_accvgpr_write_b32 a30, v192
    v_accvgpr_write_b32 a31, v193
    v_mfma_f32_16x16x32_bf16 v[64:67], a[8:11], v[40:43], v[64:67]
    buffer_load_dwordx4 v0, s[12:15], s65 offen offset:2048 nt lds
    v_mfma_f32_16x16x32_bf16 v[64:67], a[12:15], v[44:47], v[64:67]
    s_nop 1
    v_mfma_f32_16x16x32_bf16 v[68:71], a[16:19], v[32:35], -4.0
    ds_read_b128 v[32:35], v1 offset:8320
    s_nop 0
    v_mfma_f32_16x16x32_bf16 v[68:71], a[20:23], v[36:39], v[68:71]
    buffer_load_dwordx4 v0, s[12:15], s65 offen offset:3072 nt lds
    v_mfma_f32_16x16x32_bf16 v[68:71], a[24:27], v[40:43], v[68:71]
    s_add_u32 m0, s30, 24960
    v_exp_f32 v64, v64
    v_mfma_f32_16x16x32_bf16 v[68:71], a[28:31], v[44:47], v[68:71]
    s_waitcnt lgkmcnt(1)
    ds_read_b128 v[36:39], v1 offset:8576
    ds_read_b128 v[40:43], v1 offset:8832
    v_mfma_f32_16x16x32_bf16 v[72:75], a[0:3], v[48:51], -4.0
    s_mov_b32 s46, 24576
    v_exp_f32 v65, v65
    v_mfma_f32_16x16x32_bf16 v[72:75], a[4:7], v[52:55], v[72:75]
    ds_read_b128 v[44:47], v1 offset:9088
    v_cvt_pk_bf16_f32 v96, v64, v65
    v_mfma_f32_16x16x32_bf16 v[72:75], a[8:11], v[56:59], v[72:75]
    buffer_load_dwordx4 v7, s[4:7], s46 offen offset:0 nt lds
    v_mfma_f32_16x16x32_bf16 v[72:75], a[12:15], v[60:63], v[72:75]
    v_exp_f32 v66, v66
    v_mfma_f32_16x16x32_bf16 v[76:79], a[16:19], v[48:51], -4.0
    v_exp_f32 v68, v68
    v_mfma_f32_16x16x32_bf16 v[76:79], a[20:23], v[52:55], v[76:79]
    v_exp_f32 v67, v67
    v_mfma_f32_16x16x32_bf16 v[76:79], a[24:27], v[56:59], v[76:79]
    s_waitcnt lgkmcnt(0)
    v_exp_f32 v69, v69
    v_mfma_f32_16x16x32_bf16 v[76:79], a[28:31], v[60:63], v[76:79]
    v_cvt_pk_bf16_f32 v97, v66, v67
    v_cvt_pk_bf16_f32 v98, v68, v69
    v_mfma_f32_16x16x32_bf16 v[64:67], a[0:3], v[32:35], -4.0
    ds_read_b128 v[48:51], v1 offset:12480
    ds_read_b128 v[52:55], v1 offset:12736
    v_mfma_f32_16x16x32_bf16 v[64:67], a[4:7], v[36:39], v[64:67]
    buffer_load_dwordx4 v7, s[4:7], s46 offen offset:1024 nt lds
    v_mfma_f32_16x16x32_bf16 v[64:67], a[8:11], v[40:43], v[64:67]
    s_add_u32 m0, s30, 33280
    v_exp_f32 v70, v70
    v_exp_f32 v72, v72
    v_mfma_f32_16x16x32_bf16 v[64:67], a[12:15], v[44:47], v[64:67]
    ds_read_b128 v[56:59], v1 offset:12992
    ds_read_b128 v[60:63], v1 offset:13248
    v_exp_f32 v71, v71
    s_nop 0
    v_cvt_pk_bf16_f32 v99, v70, v71
    s_waitcnt vmcnt(10)
    v_mfma_f32_16x16x32_bf16 v[68:71], a[16:19], v[32:35], -4.0
    s_barrier
    v_exp_f32 v73, v73
    v_add_u32 v192, s50, v15
    v_mfma_f32_16x16x32_bf16 v[68:71], a[20:23], v[36:39], v[68:71]
    s_mov_b32 s46, 32768
    v_cvt_pk_bf16_f32 v100, v72, v73
    v_add_u32 v193, s51, v15
    v_mfma_f32_16x16x32_bf16 v[68:71], a[24:27], v[40:43], v[68:71]
    ds_write_b128 v3, v[96:99] offset:0
    v_exp_f32 v74, v74
    v_exp_f32 v76, v76
    v_add_u32 v194, s52, v15
    v_mfma_f32_16x16x32_bf16 v[68:71], a[28:31], v[44:47], v[68:71]
    ds_read_b128 v[32:35], v1 offset:16640
    v_add_u32 v195, s53, v15
    v_exp_f32 v75, v75
    s_nop 0
    v_cvt_pk_bf16_f32 v101, v74, v75
    s_waitcnt lgkmcnt(2)
    v_mfma_f32_16x16x32_bf16 v[72:75], a[0:3], v[48:51], -4.0
    v_exp_f32 v77, v77
    v_mfma_f32_16x16x32_bf16 v[72:75], a[4:7], v[52:55], v[72:75]
    buffer_load_dwordx4 v7, s[4:7], s46 offen offset:0 nt lds
    buffer_load_dwordx4 v7, s[4:7], s46 offen offset:1024 nt lds
    s_add_u32 m0, s54, 0
    s_add_u32 s45, s44, 8192
    v_cvt_pk_bf16_f32 v102, v76, v77
    v_mfma_f32_16x16x32_bf16 v[72:75], a[8:11], v[56:59], v[72:75]
    ds_read_b128 v[36:39], v1 offset:16896
    buffer_load_dwordx4 v7, s[8:11], s45 offen offset:0 nt lds
    v_exp_f32 v78, v78
    v_exp_f32 v64, v64
    v_mfma_f32_16x16x32_bf16 v[72:75], a[12:15], v[60:63], v[72:75]
    ds_read_b128 v[40:43], v1 offset:17152
    buffer_load_dwordx4 v7, s[8:11], s45 offen offset:1024 nt lds
    s_add_u32 m0, s54, 2080
    s_add_u32 s45, s44, 10240
    v_exp_f32 v79, v79
    s_nop 0
    v_cvt_pk_bf16_f32 v103, v78, v79
    v_mfma_f32_16x16x32_bf16 v[20:23], v[24:27], v[96:99], 0
    ds_read_b128 v[44:47], v1 offset:17408
    buffer_load_dwordx4 v7, s[8:11], s45 offen offset:0 nt lds
    v_exp_f32 v65, v65
    v_mfma_f32_16x16x32_bf16 v[20:23], v[28:31], v[100:103], v[20:23]
    buffer_load_dwordx4 v7, s[8:11], s45 offen offset:1024 nt lds
    s_add_u32 m0, s54, 4160
    s_add_u32 s45, s44, 12288
    v_cvt_pk_bf16_f32 v104, v64, v65
    v_mfma_f32_16x16x32_bf16 v[76:79], a[16:19], v[48:51], -4.0
    ds_write_b128 v3, v[100:103] offset:1024
    buffer_load_dwordx4 v7, s[8:11], s45 offen offset:0 nt lds
    v_exp_f32 v66, v66
    v_exp_f32 v68, v68
    v_mfma_f32_16x16x32_bf16 v[76:79], a[20:23], v[52:55], v[76:79]
    buffer_load_dwordx4 v7, s[8:11], s45 offen offset:1024 nt lds
    s_add_u32 m0, s54, 6240
    s_add_u32 s45, s44, 14336
    buffer_load_dwordx4 v7, s[8:11], s45 offen offset:0 nt lds
    v_mfma_f32_16x16x32_bf16 v[76:79], a[24:27], v[56:59], v[76:79]
    s_waitcnt lgkmcnt(4)
    buffer_load_dwordx4 v7, s[8:11], s45 offen offset:1024 nt lds
    v_exp_f32 v67, v67
    v_exp_f32 v69, v69
    v_mfma_f32_16x16x32_bf16 v[76:79], a[28:31], v[60:63], v[76:79]
    v_cvt_pk_bf16_f32 v105, v66, v67
    v_cvt_pk_bf16_f32 v106, v68, v69
    v_mfma_f32_16x16x32_bf16 v[64:67], a[0:3], v[32:35], -4.0
    s_waitcnt vmcnt(10) lgkmcnt(0)
    s_barrier
    v_exp_f32 v70, v70
    v_exp_f32 v72, v72
    v_mfma_f32_16x16x32_bf16 v[64:67], a[4:7], v[36:39], v[64:67]
    s_add_u32 m0, s72, 108160
    ds_read_b128 v[48:51], v1 offset:20800
    ds_read_b128 v[52:55], v1 offset:21056
    v_mfma_f32_16x16x32_bf16 v[64:67], a[8:11], v[40:43], v[64:67]
    v_exp_f32 v71, v71
    v_exp_f32 v73, v73
    v_mfma_f32_16x16x32_bf16 v[64:67], a[12:15], v[44:47], v[64:67]
    ds_read_b128 v[56:59], v1 offset:21312
    v_cvt_pk_bf16_f32 v107, v70, v71
    v_cvt_pk_bf16_f32 v108, v72, v73
    v_mfma_f32_16x16x32_bf16 v[68:71], a[16:19], v[32:35], -4.0
    ds_write_b128 v3, v[104:107] offset:2048
    ds_read_b128 v[60:63], v1 offset:21568
    ds_read_b64_tr_b16 a[128:129], v192 offset:16640
    v_exp_f32 v74, v74
    v_mov_b32 v248, v20
    v_mfma_f32_16x16x32_bf16 v[68:71], a[20:23], v[36:39], v[68:71]
    ds_read_b64_tr_b16 a[130:131], v192 offset:33024
    ds_read_b64_tr_b16 a[132:133], v192 offset:16648
    v_mfma_f32_16x16x32_bf16 v[68:71], a[24:27], v[40:43], v[68:71]
    v_exp_f32 v75, v75
    v_exp_f32 v76, v76
    v_mfma_f32_16x16x32_bf16 v[68:71], a[28:31], v[44:47], v[68:71]
    s_waitcnt lgkmcnt(3)
    ds_read_b64_tr_b16 a[134:135], v192 offset:33032
    v_cvt_pk_bf16_f32 v109, v74, v75
    v_mfma_f32_16x16x32_bf16 v[72:75], a[0:3], v[48:51], -4.0
    buffer_load_dwordx4 v0, s[12:15], s66 offen offset:0 nt lds
    ds_read_b64_tr_b16 a[160:161], v193 offset:16640
    v_exp_f32 v77, v77
    v_mfma_f32_16x16x32_bf16 v[72:75], a[4:7], v[52:55], v[72:75]
    ds_read_b128 v[32:35], v1 offset:24960
    ds_read_b64_tr_b16 a[162:163], v193 offset:33024
    v_cvt_pk_bf16_f32 v110, v76, v77
    v_mfma_f32_16x16x32_bf16 v[72:75], a[8:11], v[56:59], v[72:75]
    ds_read_b128 v[36:39], v1 offset:25216
    ds_read_b64_tr_b16 a[164:165], v193 offset:16648
    v_exp_f32 v78, v78
    v_exp_f32 v64, v64
    v_mfma_f32_16x16x32_bf16 v[72:75], a[12:15], v[60:63], v[72:75]
    ds_read_b128 v[40:43], v1 offset:25472
    ds_read_b64_tr_b16 a[166:167], v193 offset:33032
    v_exp_f32 v79, v79
    s_nop 0
    v_cvt_pk_bf16_f32 v111, v78, v79
    v_mfma_f32_16x16x32_bf16 v[20:23], v[24:27], v[104:107], 0
    ds_read_b128 v[44:47], v1 offset:25728
    ds_read_b64_tr_b16 a[192:193], v194 offset:16640
    v_exp_f32 v65, v65
    v_mfma_f32_16x16x32_bf16 v[20:23], v[28:31], v[108:111], v[20:23]
    ds_read_b64_tr_b16 a[194:195], v194 offset:33024
    v_cvt_pk_bf16_f32 v112, v64, v65
    v_mfma_f32_16x16x32_bf16 v[76:79], a[16:19], v[48:51], -4.0
    ds_write_b128 v3, v[108:111] offset:3072
    ds_read_b64_tr_b16 a[196:197], v194 offset:16648
    v_exp_f32 v66, v66
    v_exp_f32 v68, v68
    v_mfma_f32_16x16x32_bf16 v[76:79], a[20:23], v[52:55], v[76:79]
    ds_read_b128 v[132:135], v4 offset:0
    ds_read_b64_tr_b16 a[198:199], v194 offset:33032
    v_mfma_f32_16x16x32_bf16 v[76:79], a[24:27], v[56:59], v[76:79]
    s_waitcnt lgkmcnt(6)
    ds_read_b128 v[136:139], v5 offset:0
    buffer_load_dwordx4 v0, s[12:15], s66 offen offset:1024 nt lds
    ds_read_b64_tr_b16 a[224:225], v195 offset:16640
    v_exp_f32 v67, v67
    v_exp_f32 v69, v69
    v_mfma_f32_16x16x32_bf16 v[76:79], a[28:31], v[60:63], v[76:79]
    ds_read_b128 v[140:143], v6 offset:0
    ds_read_b64_tr_b16 a[226:227], v195 offset:33024
    v_cvt_pk_bf16_f32 v113, v66, v67
    v_cvt_pk_bf16_f32 v114, v68, v69
    v_mfma_f32_16x16x32_bf16 v[64:67], a[0:3], v[32:35], -4.0
    ds_read_b64_tr_b16 a[228:229], v195 offset:16648
    v_exp_f32 v70, v70
    v_exp_f32 v72, v72
    v_mfma_f32_16x16x32_bf16 v[64:67], a[4:7], v[36:39], v[64:67]
    ds_read_b128 v[48:51], v1 offset:29120
    ds_read_b64_tr_b16 a[230:231], v195 offset:33032
    v_mfma_f32_16x16x32_bf16 v[64:67], a[8:11], v[40:43], v[64:67]
    ds_read_b128 v[52:55], v1 offset:29376
    v_exp_f32 v71, v71
    v_exp_f32 v73, v73
    v_mfma_f32_16x16x32_bf16 v[64:67], a[12:15], v[44:47], v[64:67]
    s_waitcnt vmcnt(10) lgkmcnt(1)
    ds_read_b128 v[56:59], v1 offset:29632
    v_cvt_pk_bf16_f32 v115, v70, v71
    v_cvt_pk_bf16_f32 v116, v72, v73
    v_mfma_f32_16x16x32_bf16 v[80:83], a[128:131], v[96:99], 0
    s_barrier
    ds_write_b128 v3, v[112:115] offset:4096
    ds_read_b128 v[60:63], v1 offset:29888
    v_exp_f32 v74, v74
    v_mov_b32 v249, v20
    v_mfma_f32_16x16x32_bf16 v[80:83], a[160:163], v[132:135], v[80:83]
    v_exp_f32 v75, v75
    v_mfma_f32_16x16x32_bf16 v[80:83], a[192:195], v[136:139], v[80:83]
    v_exp_f32 v76, v76
    v_accvgpr_read_b32 v232, a128
    v_mfma_f32_16x16x32_bf16 v[80:83], a[224:227], v[140:143], v[80:83]
    v_cvt_pk_bf16_f32 v117, v74, v75
    v_accvgpr_read_b32 v233, a129
    v_mfma_f32_16x16x32_bf16 v[68:71], a[16:19], v[32:35], -4.0
    v_exp_f32 v77, v77
    v_mfma_f32_16x16x32_bf16 v[68:71], a[20:23], v[36:39], v[68:71]
    v_cvt_pk_bf16_f32 v118, v76, v77
    v_accvgpr_read_b32 v234, a130
    v_mfma_f32_16x16x32_bf16 v[68:71], a[24:27], v[40:43], v[68:71]
    v_exp_f32 v78, v78
    v_exp_f32 v64, v64
    v_mfma_f32_16x16x32_bf16 v[68:71], a[28:31], v[44:47], v[68:71]
    v_exp_f32 v79, v79
    v_mfma_f32_16x16x32_bf16 v[84:87], a[132:135], v[96:99], 0
    buffer_load_dwordx4 v0, s[12:15], s66 offen offset:2048 nt lds
    v_exp_f32 v65, v65
    v_accvgpr_read_b32 v235, a131
    v_mfma_f32_16x16x32_bf16 v[84:87], a[164:167], v[132:135], v[84:87]
    ds_read_b128 v[148:151], v4 offset:1024
    ds_read_b128 v[32:35], v1 offset:33280
    v_cvt_pk_bf16_f32 v119, v78, v79
    v_cvt_pk_bf16_f32 v120, v64, v65
    v_mfma_f32_16x16x32_bf16 v[84:87], a[196:199], v[136:139], v[84:87]
    ds_write_b128 v3, v[116:119] offset:5120
    ds_read_b128 v[152:155], v5 offset:1024
    ds_read_b128 v[36:39], v1 offset:33536
    v_exp_f32 v66, v66
    v_max3_f32 v236, |v232|, |v233|, |v234|
    v_mfma_f32_16x16x32_bf16 v[84:87], a[228:231], v[140:143], v[84:87]
    s_waitcnt lgkmcnt(5)
    ds_read_b128 v[156:159], v6 offset:1024
    ds_read_b128 v[40:43], v1 offset:33792
    v_mfma_f32_16x16x32_bf16 v[72:75], a[0:3], v[48:51], -4.0
    ds_read_b128 v[44:47], v1 offset:34048
    v_exp_f32 v67, v67
    v_max_f32 v236, v236, |v235|
    v_mfma_f32_16x16x32_bf16 v[72:75], a[4:7], v[52:55], v[72:75]
    v_cvt_pk_bf16_f32 v121, v66, v67
    v_mov_b32 v238, v236
    v_mfma_f32_16x16x32_bf16 v[72:75], a[8:11], v[56:59], v[72:75]
    v_exp_f32 v68, v68
    v_mfma_f32_16x16x32_bf16 v[72:75], a[12:15], v[60:63], v[72:75]
    s_waitcnt lgkmcnt(2)
    v_exp_f32 v69, v69
    v_mfma_f32_16x16x32_bf16 v[88:91], a[128:131], v[100:103], 0
    v_permlane32_swap_b32 v236, v238
    v_cvt_pk_bf16_f32 v122, v68, v69
    v_mfma_f32_16x16x32_bf16 v[88:91], a[160:163], v[148:151], v[88:91]
    v_exp_f32 v70, v70
    v_mfma_f32_16x16x32_bf16 v[88:91], a[192:195], v[152:155], v[88:91]
    ds_read_b128 v[132:135], v4 offset:2048
    v_max_f32 v236, v236, v238
    v_mfma_f32_16x16x32_bf16 v[88:91], a[224:227], v[156:159], v[88:91]
    v_exp_f32 v71, v71
    v_mfma_f32_16x16x32_bf16 v[20:23], v[24:27], v[112:115], 0
    v_mov_b32 v238, v236
    v_cvt_pk_bf16_f32 v123, v70, v71
    v_mfma_f32_16x16x32_bf16 v[20:23], v[28:31], v[116:119], v[20:23]
    ds_write_b128 v3, v[120:123] offset:6144
    v_mfma_f32_16x16x32_bf16 v[76:79], a[16:19], v[48:51], -4.0
    v_exp_f32 v72, v72
    v_permlane16_swap_b32 v236, v238
    v_mfma_f32_16x16x32_bf16 v[76:79], a[20:23], v[52:55], v[76:79]
    v_exp_f32 v73, v73
    v_mfma_f32_16x16x32_bf16 v[76:79], a[24:27], v[56:59], v[76:79]
    buffer_load_dwordx4 v0, s[12:15], s66 offen offset:3072 nt lds
    s_add_u32 m0, s72, 124800
    v_max_f32 v236, v236, v238
    v_mfma_f32_16x16x32_bf16 v[76:79], a[28:31], v[60:63], v[76:79]
    buffer_load_dwordx4 v0, s[12:15], s67 offen offset:0 nt lds
    buffer_load_dwordx4 v0, s[12:15], s67 offen offset:1024 nt lds
    buffer_load_dwordx4 v0, s[12:15], s67 offen offset:2048 nt lds
    buffer_load_dwordx4 v0, s[12:15], s67 offen offset:3072 nt lds
    v_cvt_pk_bf16_f32 v124, v72, v73
    v_mfma_f32_16x16x32_bf16 v[92:95], a[132:135], v[100:103], 0
    v_exp_f32 v74, v74
    v_accvgpr_read_b32 v232, a132
    v_mfma_f32_16x16x32_bf16 v[92:95], a[164:167], v[148:151], v[92:95]
    ds_read_b128 v[48:51], v1 offset:37440
    ds_read_b128 v[136:139], v5 offset:2048
    v_mfma_f32_16x16x32_bf16 v[92:95], a[196:199], v[152:155], v[92:95]
    s_waitcnt lgkmcnt(4)
    ds_read_b128 v[52:55], v1 offset:37696
    v_exp_f32 v75, v75
    v_accvgpr_read_b32 v233, a133
    v_mfma_f32_16x16x32_bf16 v[92:95], a[228:231], v[156:159], v[92:95]
    s_barrier
    ds_read_b128 v[140:143], v6 offset:2048
    ds_read_b128 v[56:59], v1 offset:37952
    v_cvt_pk_bf16_f32 v125, v74, v75
    v_mfma_f32_16x16x32_bf16 v[64:67], a[0:3], v[32:35], -4.0
    ds_read_b128 v[60:63], v1 offset:38208
    v_mov_b32 v250, v20
    v_accvgpr_read_b32 v234, a134
    v_mfma_f32_16x16x32_bf16 v[64:67], a[4:7], v[36:39], v[64:67]
    v_exp_f32 v76, v76
    v_mfma_f32_16x16x32_bf16 v[64:67], a[8:11], v[40:43], v[64:67]
    ds_read_b128 v[148:151], v4 offset:3072
    v_accvgpr_read_b32 v235, a135
    v_mfma_f32_16x16x32_bf16 v[64:67], a[12:15], v[44:47], v[64:67]
    s_waitcnt lgkmcnt(3)
    v_exp_f32 v77, v77
    v_mfma_f32_16x16x32_bf16 v[176:179], a[128:131], v[104:107], 0
    v_max3_f32 v237, |v232|, |v233|, |v234|
    v_cvt_pk_bf16_f32 v126, v76, v77
    v_mfma_f32_16x16x32_bf16 v[176:179], a[160:163], v[132:135], v[176:179]
    v_exp_f32 v78, v78
    v_mfma_f32_16x16x32_bf16 v[176:179], a[192:195], v[136:139], v[176:179]
    ds_read_b128 v[152:155], v5 offset:3072
    v_max_f32 v237, v237, |v235|
    v_mfma_f32_16x16x32_bf16 v[176:179], a[224:227], v[140:143], v[176:179]
    v_exp_f32 v79, v79
    v_mfma_f32_16x16x32_bf16 v[68:71], a[16:19], v[32:35], -4.0
    v_mov_b32 v238, v237
    v_cvt_pk_bf16_f32 v127, v78, v79
    v_mfma_f32_16x16x32_bf16 v[68:71], a[20:23], v[36:39], v[68:71]
    ds_write_b128 v3, v[124:127] offset:7168
    v_mfma_f32_16x16x32_bf16 v[68:71], a[24:27], v[40:43], v[68:71]
    v_exp_f32 v64, v64
    v_permlane32_swap_b32 v237, v238
    v_mfma_f32_16x16x32_bf16 v[68:71], a[28:31], v[44:47], v[68:71]
    v_exp_f32 v65, v65
    v_mfma_f32_16x16x32_bf16 v[180:183], a[132:135], v[104:107], 0
    v_max_f32 v237, v237, v238
    v_cvt_pk_bf16_f32 v96, v64, v65
    v_mfma_f32_16x16x32_bf16 v[180:183], a[164:167], v[132:135], v[180:183]
    ds_read_b128 v[32:35], v1 offset:0
    ds_read_b128 v[36:39], v1 offset:256
    v_mfma_f32_16x16x32_bf16 v[180:183], a[196:199], v[136:139], v[180:183]
    v_exp_f32 v66, v66
    v_mov_b32 v238, v237
    v_mfma_f32_16x16x32_bf16 v[180:183], a[228:231], v[140:143], v[180:183]
    s_waitcnt lgkmcnt(5)
    ds_read_b128 v[156:159], v6 offset:3072
    ds_read_b128 v[40:43], v1 offset:512
    v_mfma_f32_16x16x32_bf16 v[72:75], a[0:3], v[48:51], -4.0
    ds_read_b128 v[44:47], v1 offset:768
    v_exp_f32 v67, v67
    v_permlane16_swap_b32 v237, v238
    v_mfma_f32_16x16x32_bf16 v[72:75], a[4:7], v[52:55], v[72:75]
    v_cvt_pk_bf16_f32 v97, v66, v67
    v_max_f32 v237, v237, v238
    v_mfma_f32_16x16x32_bf16 v[72:75], a[8:11], v[56:59], v[72:75]
    v_exp_f32 v68, v68
    v_mfma_f32_16x16x32_bf16 v[72:75], a[12:15], v[60:63], v[72:75]
    s_waitcnt vmcnt(8) lgkmcnt(2)
    v_exp_f32 v69, v69
    v_mfma_f32_16x16x32_bf16 v[184:187], a[128:131], v[108:111], 0
    v_min_f32 v238, v236, v237
    v_cvt_pk_bf16_f32 v98, v68, v69
    v_mfma_f32_16x16x32_bf16 v[184:187], a[160:163], v[148:151], v[184:187]
    v_exp_f32 v70, v70
    v_mfma_f32_16x16x32_bf16 v[184:187], a[192:195], v[152:155], v[184:187]
    ds_read_b128 a[32:35], v255 offset:0
    v_min_f32_dpp v238, v238, v238 row_ror:8 row_mask:0xf bank_mask:0xf
    v_mfma_f32_16x16x32_bf16 v[184:187], a[224:227], v[156:159], v[184:187]
    v_exp_f32 v71, v71
    v_mfma_f32_16x16x32_bf16 v[20:23], v[24:27], v[120:123], 0
    v_min_f32_dpp v238, v238, v238 row_ror:4 row_mask:0xf bank_mask:0xf
    v_cvt_pk_bf16_f32 v99, v70, v71
    v_mfma_f32_16x16x32_bf16 v[20:23], v[28:31], v[124:127], v[20:23]
    ds_read_b128 a[36:39], v255 offset:256
    v_min_f32_dpp v238, v238, v238 row_ror:2 row_mask:0xf bank_mask:0xf
    v_mfma_f32_16x16x32_bf16 v[76:79], a[16:19], v[48:51], -4.0
    ds_write_b128 v3, v[96:99] offset:0
    ds_read_b128 a[40:43], v255 offset:512
    v_exp_f32 v72, v72
    v_mfma_f32_16x16x32_bf16 v[76:79], a[20:23], v[52:55], v[76:79]
    ds_read_b128 a[44:47], v255 offset:768
    v_min_f32_dpp v238, v238, v238 row_ror:1 row_mask:0xf bank_mask:0xf
    v_mfma_f32_16x16x32_bf16 v[76:79], a[24:27], v[56:59], v[76:79]
    ds_read_b128 a[48:51], v255 offset:4160
    v_exp_f32 v73, v73
    v_mfma_f32_16x16x32_bf16 v[76:79], a[28:31], v[60:63], v[76:79]
    ds_read_b128 a[52:55], v255 offset:4416
    v_cvt_pk_bf16_f32 v100, v72, v73
    v_mfma_f32_16x16x32_bf16 v[188:191], a[132:135], v[108:111], 0
    ds_read_b128 a[56:59], v255 offset:4672
    v_exp_f32 v74, v74
    v_min_f32 v238, 0x5d800000, v238
    v_mfma_f32_16x16x32_bf16 v[188:191], a[164:167], v[148:151], v[188:191]
    ds_read_b128 v[132:135], v4 offset:4096
    ds_read_b128 v[48:51], v1 offset:4160
    ds_read_b128 a[60:63], v255 offset:4928
    v_mfma_f32_16x16x32_bf16 v[188:191], a[196:199], v[152:155], v[188:191]
    ds_read_b128 v[136:139], v5 offset:4096
    ds_read_b128 v[52:55], v1 offset:4416
    v_exp_f32 v75, v75
    v_and_b32 v238, 0x7f800000, v238
    v_mfma_f32_16x16x32_bf16 v[188:191], a[228:231], v[156:159], v[188:191]
    s_barrier
    ds_read_b128 v[140:143], v6 offset:4096
    ds_read_b128 v[56:59], v1 offset:4672
    v_cvt_pk_bf16_f32 v101, v74, v75
    s_waitcnt lgkmcnt(0)
    v_mfma_f32_16x16x32_bf16 v[192:195], a[152:155], a[32:35], 0
    s_add_u32 m0, s54, 0
    s_add_u32 s45, s44, 16384
    buffer_load_dwordx4 v7, s[8:11], s45 offen offset:0 nt lds
    s_nop 1
    v_mfma_f32_16x16x32_bf16 v[192:195], a[184:187], a[32:35], v[192:195]
    s_nop 1
    v_mfma_f32_16x16x32_bf16 v[196:199], a[156:159], a[32:35], 0
    s_nop 1
    v_mfma_f32_16x16x32_bf16 v[196:199], a[188:191], a[32:35], v[196:199]
    s_nop 1
    v_mfma_f32_16x16x32_bf16 v[16:19], a[152:155], a[36:39], 0
    buffer_load_dwordx4 v7, s[8:11], s45 offen offset:1024 nt lds
    v_cvt_pk_bf16_f32 v192, v192, v193
    v_cvt_pk_bf16_f32 v193, v194, v195
    v_mfma_f32_16x16x32_bf16 v[16:19], a[184:187], a[36:39], v[16:19]
    v_accvgpr_write_b32 a32, v192
    v_accvgpr_write_b32 a33, v193
    v_mfma_f32_16x16x32_bf16 v[192:195], a[156:159], a[36:39], 0
    v_cvt_pk_bf16_f32 v196, v196, v197
    v_cvt_pk_bf16_f32 v197, v198, v199
    v_mfma_f32_16x16x32_bf16 v[192:195], a[188:191], a[36:39], v[192:195]
    v_accvgpr_write_b32 a34, v196
    v_accvgpr_write_b32 a35, v197
    v_mfma_f32_16x16x32_bf16 v[196:199], a[152:155], a[40:43], 0
    s_add_u32 m0, s54, 2080
    s_add_u32 s45, s44, 18432
    buffer_load_dwordx4 v7, s[8:11], s45 offen offset:0 nt lds
    v_cvt_pk_bf16_f32 v16, v16, v17
    v_cvt_pk_bf16_f32 v17, v18, v19
    v_mfma_f32_16x16x32_bf16 v[196:199], a[184:187], a[40:43], v[196:199]
    v_accvgpr_write_b32 a36, v16
    v_accvgpr_write_b32 a37, v17
    v_mfma_f32_16x16x32_bf16 v[16:19], a[156:159], a[40:43], 0
    v_cvt_pk_bf16_f32 v192, v192, v193
    v_cvt_pk_bf16_f32 v193, v194, v195
    v_mfma_f32_16x16x32_bf16 v[16:19], a[188:191], a[40:43], v[16:19]
    v_accvgpr_write_b32 a38, v192
    v_accvgpr_write_b32 a39, v193
    v_mfma_f32_16x16x32_bf16 v[192:195], a[152:155], a[44:47], 0
    buffer_load_dwordx4 v7, s[8:11], s45 offen offset:1024 nt lds
    v_cvt_pk_bf16_f32 v196, v196, v197
    v_cvt_pk_bf16_f32 v197, v198, v199
    v_mfma_f32_16x16x32_bf16 v[192:195], a[184:187], a[44:47], v[192:195]
    v_accvgpr_write_b32 a40, v196
    v_accvgpr_write_b32 a41, v197
    v_mfma_f32_16x16x32_bf16 v[196:199], a[156:159], a[44:47], 0
    v_cvt_pk_bf16_f32 v16, v16, v17
    v_cvt_pk_bf16_f32 v17, v18, v19
    v_mfma_f32_16x16x32_bf16 v[196:199], a[188:191], a[44:47], v[196:199]
    v_accvgpr_write_b32 a42, v16
    v_accvgpr_write_b32 a43, v17
    v_mfma_f32_16x16x32_bf16 v[16:19], a[152:155], a[48:51], 0
    s_add_u32 m0, s54, 4160
    s_add_u32 s45, s44, 20480
    buffer_load_dwordx4 v7, s[8:11], s45 offen offset:0 nt lds
    v_cvt_pk_bf16_f32 v192, v192, v193
    v_cvt_pk_bf16_f32 v193, v194, v195
    v_mfma_f32_16x16x32_bf16 v[16:19], a[184:187], a[48:51], v[16:19]
    v_accvgpr_write_b32 a44, v192
    v_accvgpr_write_b32 a45, v193
    v_mfma_f32_16x16x32_bf16 v[192:195], a[156:159], a[48:51], 0
    v_cvt_pk_bf16_f32 v196, v196, v197
    v_cvt_pk_bf16_f32 v197, v198, v199
    v_mfma_f32_16x16x32_bf16 v[192:195], a[188:191], a[48:51], v[192:195]
    v_accvgpr_write_b32 a46, v196
    v_accvgpr_write_b32 a47, v197
    v_mfma_f32_16x16x32_bf16 v[196:199], a[152:155], a[52:55], 0
    buffer_load_dwordx4 v7, s[8:11], s45 offen offset:1024 nt lds
    v_cvt_pk_bf16_f32 v16, v16, v17
    v_cvt_pk_bf16_f32 v17, v18, v19
    v_mfma_f32_16x16x32_bf16 v[196:199], a[184:187], a[52:55], v[196:199]
    v_accvgpr_write_b32 a48, v16
    v_accvgpr_write_b32 a49, v17
    v_mfma_f32_16x16x32_bf16 v[16:19], a[156:159], a[52:55], 0
    v_cvt_pk_bf16_f32 v192, v192, v193
    v_cvt_pk_bf16_f32 v193, v194, v195
    v_mfma_f32_16x16x32_bf16 v[16:19], a[188:191], a[52:55], v[16:19]
    v_accvgpr_write_b32 a50, v192
    v_accvgpr_write_b32 a51, v193
    v_mfma_f32_16x16x32_bf16 v[192:195], a[152:155], a[56:59], 0
    s_add_u32 m0, s54, 6240
    s_add_u32 s45, s44, 22528
    buffer_load_dwordx4 v7, s[8:11], s45 offen offset:0 nt lds
    v_cvt_pk_bf16_f32 v196, v196, v197
    v_cvt_pk_bf16_f32 v197, v198, v199
    v_mfma_f32_16x16x32_bf16 v[192:195], a[184:187], a[56:59], v[192:195]
    v_accvgpr_write_b32 a52, v196
    v_accvgpr_write_b32 a53, v197
    v_mfma_f32_16x16x32_bf16 v[196:199], a[156:159], a[56:59], 0
    v_cvt_pk_bf16_f32 v16, v16, v17
    v_cvt_pk_bf16_f32 v17, v18, v19
    v_mfma_f32_16x16x32_bf16 v[196:199], a[188:191], a[56:59], v[196:199]
    v_accvgpr_write_b32 a54, v16
    v_accvgpr_write_b32 a55, v17
    v_mfma_f32_16x16x32_bf16 v[16:19], a[152:155], a[60:63], 0
    buffer_load_dwordx4 v7, s[8:11], s45 offen offset:1024 nt lds
    v_cvt_pk_bf16_f32 v192, v192, v193
    v_cvt_pk_bf16_f32 v193, v194, v195
    v_mfma_f32_16x16x32_bf16 v[16:19], a[184:187], a[60:63], v[16:19]
    v_accvgpr_write_b32 a56, v192
    v_accvgpr_write_b32 a57, v193
    v_mfma_f32_16x16x32_bf16 v[192:195], a[156:159], a[60:63], 0
    v_cvt_pk_bf16_f32 v196, v196, v197
    v_cvt_pk_bf16_f32 v197, v198, v199
    v_mfma_f32_16x16x32_bf16 v[192:195], a[188:191], a[60:63], v[192:195]
    v_accvgpr_write_b32 a58, v196
    v_accvgpr_write_b32 a59, v197
    v_mfma_f32_16x16x32_bf16 v[64:67], a[32:35], v[32:35], -4.0
    ds_read_b128 v[60:63], v1 offset:4928
    v_cvt_pk_bf16_f32 v16, v16, v17
    v_cvt_pk_bf16_f32 v17, v18, v19
    v_accvgpr_write_b32 a60, v16
    v_accvgpr_write_b32 a61, v17
    v_cvt_pk_bf16_f32 v192, v192, v193
    v_cvt_pk_bf16_f32 v193, v194, v195
    v_accvgpr_write_b32 a62, v192
    v_accvgpr_write_b32 a63, v193
    v_mov_b32 v251, v20
    v_add_u32 v240, 0x1400000, v238
    v_mfma_f32_16x16x32_bf16 v[64:67], a[36:39], v[36:39], v[64:67]
    v_exp_f32 v76, v76
    v_mfma_f32_16x16x32_bf16 v[64:67], a[40:43], v[40:43], v[64:67]
    ds_read_b128 v[148:151], v4 offset:5120
    v_add_u32 v241, 0x1400000, v238
    v_mfma_f32_16x16x32_bf16 v[64:67], a[44:47], v[44:47], v[64:67]
    v_exp_f32 v77, v77
    v_mfma_f32_16x16x32_bf16 v[200:203], a[128:131], v[112:115], 0
    v_add_u32 v242, 0x1400000, v238
    v_cvt_pk_bf16_f32 v102, v76, v77
    v_mfma_f32_16x16x32_bf16 v[200:203], a[160:163], v[132:135], v[200:203]
    v_exp_f32 v78, v78
    v_mfma_f32_16x16x32_bf16 v[200:203], a[192:195], v[136:139], v[200:203]
    ds_read_b128 v[152:155], v5 offset:5120
    v_add_u32 v243, 0x1400000, v238
    v_mfma_f32_16x16x32_bf16 v[200:203], a[224:227], v[140:143], v[200:203]
    v_exp_f32 v79, v79
    v_mfma_f32_16x16x32_bf16 v[68:71], a[48:51], v[32:35], -4.0
    ds_read_b128 v[32:35], v1 offset:8320
    v_cvt_pk_bf16_f32 v103, v78, v79
    v_mfma_f32_16x16x32_bf16 v[68:71], a[52:55], v[36:39], v[68:71]
    ds_write_b128 v3, v[100:103] offset:1024
    v_mfma_f32_16x16x32_bf16 v[68:71], a[56:59], v[40:43], v[68:71]
    v_exp_f32 v64, v64
    v_mfma_f32_16x16x32_bf16 v[68:71], a[60:63], v[44:47], v[68:71]
    v_exp_f32 v65, v65
    v_mfma_f32_16x16x32_bf16 v[204:207], a[132:135], v[112:115], 0
    ds_read_b128 v[36:39], v1 offset:8576
    v_cvt_pk_bf16_f32 v104, v64, v65
    v_mfma_f32_16x16x32_bf16 v[204:207], a[164:167], v[132:135], v[204:207]
    v_exp_f32 v66, v66
    v_mfma_f32_16x16x32_bf16 v[204:207], a[196:199], v[136:139], v[204:207]
    ds_read_b128 v[156:159], v6 offset:5120
    ds_read_b128 v[40:43], v1 offset:8832
    v_mfma_f32_16x16x32_bf16 v[204:207], a[228:231], v[140:143], v[204:207]
    s_waitcnt lgkmcnt(7)
    v_exp_f32 v67, v67
    v_mfma_f32_16x16x32_bf16 v[72:75], a[32:35], v[48:51], -4.0
    ds_read_b128 v[44:47], v1 offset:9088
    v_cvt_pk_bf16_f32 v105, v66, v67
    v_mfma_f32_16x16x32_bf16 v[72:75], a[36:39], v[52:55], v[72:75]
    v_exp_f32 v68, v68
    v_mfma_f32_16x16x32_bf16 v[72:75], a[40:43], v[56:59], v[72:75]
    v_exp_f32 v69, v69
    v_mfma_f32_16x16x32_bf16 v[72:75], a[44:47], v[60:63], v[72:75]
    s_waitcnt lgkmcnt(2)
    ds_read_b128 v[132:135], v4 offset:6144
    v_cvt_pk_bf16_f32 v106, v68, v69
    v_mfma_f32_16x16x32_bf16 v[208:211], a[128:131], v[116:119], 0
    v_exp_f32 v70, v70
    v_mfma_f32_16x16x32_bf16 v[208:211], a[160:163], v[148:151], v[208:211]
    v_exp_f32 v71, v71
    v_mfma_f32_16x16x32_bf16 v[208:211], a[192:195], v[152:155], v[208:211]
    ds_read_b128 v[136:139], v5 offset:6144
    v_cvt_pk_bf16_f32 v107, v70, v71
    v_mfma_f32_16x16x32_bf16 v[208:211], a[224:227], v[156:159], v[208:211]
    ds_write_b128 v3, v[104:107] offset:2048
    v_mfma_f32_16x16x32_bf16 v[20:23], v[24:27], v[96:99], 0
    v_exp_f32 v72, v72
    v_mfma_f32_16x16x32_bf16 v[20:23], v[28:31], v[100:103], v[20:23]
    v_exp_f32 v73, v73
    v_mfma_f32_16x16x32_bf16 v[76:79], a[48:51], v[48:51], -4.0
    s_add_u32 m0, s72, 141184
    ds_read_b128 v[48:51], v1 offset:12480
    v_cvt_pk_bf16_f32 v108, v72, v73
    v_mfma_f32_16x16x32_bf16 v[76:79], a[52:55], v[52:55], v[76:79]
    v_exp_f32 v74, v74
    v_mfma_f32_16x16x32_bf16 v[76:79], a[56:59], v[56:59], v[76:79]
    v_exp_f32 v75, v75
    v_mfma_f32_16x16x32_bf16 v[76:79], a[60:63], v[60:63], v[76:79]
    ds_read_b128 v[52:55], v1 offset:12736
    v_cvt_pk_bf16_f32 v109, v74, v75
    v_mfma_f32_16x16x32_bf16 v[212:215], a[132:135], v[116:119], 0
    ds_read_b128 v[140:143], v6 offset:6144
    ds_read_b128 v[56:59], v1 offset:12992
    v_mfma_f32_16x16x32_bf16 v[212:215], a[164:167], v[148:151], v[212:215]
    ds_read_b128 v[60:63], v1 offset:13248
    v_mov_b32 v252, v20
    v_mfma_f32_16x16x32_bf16 v[212:215], a[196:199], v[152:155], v[212:215]
    s_waitcnt lgkmcnt(8)
    buffer_load_dwordx4 v0, s[12:15], s68 offen offset:0 nt lds
    v_mfma_f32_16x16x32_bf16 v[212:215], a[228:231], v[156:159], v[212:215]
    s_barrier
    v_exp_f32 v76, v76
    v_mfma_f32_16x16x32_bf16 v[64:67], a[32:35], v[32:35], -4.0
    v_exp_f32 v77, v77
    v_mfma_f32_16x16x32_bf16 v[64:67], a[36:39], v[36:39], v[64:67]
    v_add_u32 v192, s50, v15
    v_cvt_pk_bf16_f32 v110, v76, v77
    v_mfma_f32_16x16x32_bf16 v[64:67], a[40:43], v[40:43], v[64:67]
    v_add_u32 v193, s51, v15
    v_add_u32 v194, s52, v15
    v_mfma_f32_16x16x32_bf16 v[64:67], a[44:47], v[44:47], v[64:67]
    s_waitcnt lgkmcnt(2)
    v_exp_f32 v78, v78
    v_mfma_f32_16x16x32_bf16 v[216:219], a[128:131], v[120:123], 0
    ds_read_b128 v[148:151], v4 offset:7168
    v_add_u32 v195, s53, v15
    v_mfma_f32_16x16x32_bf16 v[216:219], a[160:163], v[132:135], v[216:219]
    v_exp_f32 v79, v79
    v_mfma_f32_16x16x32_bf16 v[216:219], a[192:195], v[136:139], v[216:219]
    ds_read_b128 v[152:155], v5 offset:7168
    v_cvt_pk_bf16_f32 v111, v78, v79
    v_mfma_f32_16x16x32_bf16 v[216:219], a[224:227], v[140:143], v[216:219]
    buffer_load_dwordx4 v0, s[12:15], s68 offen offset:1024 nt lds
    v_mfma_f32_16x16x32_bf16 v[68:71], a[48:51], v[32:35], -4.0
    ds_write_b128 v3, v[108:111] offset:3072
    v_mfma_f32_16x16x32_bf16 v[68:71], a[52:55], v[36:39], v[68:71]
    v_exp_f32 v64, v64
    v_mfma_f32_16x16x32_bf16 v[68:71], a[56:59], v[40:43], v[68:71]
    v_exp_f32 v65, v65
    v_mfma_f32_16x16x32_bf16 v[68:71], a[60:63], v[44:47], v[68:71]
    ds_read_b128 v[32:35], v1 offset:16640
    v_cvt_pk_bf16_f32 v112, v64, v65
    v_mfma_f32_16x16x32_bf16 v[220:223], a[132:135], v[120:123], 0
    v_exp_f32 v66, v66
    v_mfma_f32_16x16x32_bf16 v[220:223], a[164:167], v[132:135], v[220:223]
    ds_read_b128 v[36:39], v1 offset:16896
    ds_read_b128 v[156:159], v6 offset:7168
    v_mfma_f32_16x16x32_bf16 v[220:223], a[196:199], v[136:139], v[220:223]
    ds_read_b128 v[40:43], v1 offset:17152
    ds_read_b128 v[44:47], v1 offset:17408
    v_mfma_f32_16x16x32_bf16 v[220:223], a[228:231], v[140:143], v[220:223]
    s_waitcnt lgkmcnt(8)
    v_exp_f32 v67, v67
    v_mfma_f32_16x16x32_bf16 v[72:75], a[32:35], v[48:51], -4.0
    ds_read_b128 v[132:135], v4 offset:0
    v_cvt_pk_bf16_f32 v113, v66, v67
    v_mfma_f32_16x16x32_bf16 v[72:75], a[36:39], v[52:55], v[72:75]
    v_exp_f32 v68, v68
    v_mfma_f32_16x16x32_bf16 v[72:75], a[40:43], v[56:59], v[72:75]
    buffer_load_dwordx4 v0, s[12:15], s68 offen offset:2048 nt lds
    v_mfma_f32_16x16x32_bf16 v[72:75], a[44:47], v[60:63], v[72:75]
    s_waitcnt lgkmcnt(3)
    v_exp_f32 v69, v69
    v_mfma_f32_16x16x32_bf16 v[224:227], a[128:131], v[124:127], 0
    ds_read_b128 v[136:139], v5 offset:0
    v_cvt_pk_bf16_f32 v114, v68, v69
    v_mfma_f32_16x16x32_bf16 v[224:227], a[160:163], v[148:151], v[224:227]
    v_exp_f32 v70, v70
    v_mfma_f32_16x16x32_bf16 v[224:227], a[192:195], v[152:155], v[224:227]
    v_exp_f32 v71, v71
    v_mfma_f32_16x16x32_bf16 v[224:227], a[224:227], v[156:159], v[224:227]
    ds_read_b128 v[140:143], v6 offset:0
    v_cvt_pk_bf16_f32 v115, v70, v71
    v_mfma_f32_16x16x32_bf16 v[20:23], v[24:27], v[104:107], 0
    ds_write_b128 v3, v[112:115] offset:4096
    v_mfma_f32_16x16x32_bf16 v[20:23], v[28:31], v[108:111], v[20:23]
    v_exp_f32 v72, v72
    v_mfma_f32_16x16x32_bf16 v[76:79], a[48:51], v[48:51], -4.0
    buffer_load_dwordx4 v0, s[12:15], s68 offen offset:3072 nt lds
    v_mfma_f32_16x16x32_bf16 v[76:79], a[52:55], v[52:55], v[76:79]
    v_exp_f32 v73, v73
    v_mfma_f32_16x16x32_bf16 v[76:79], a[56:59], v[56:59], v[76:79]
    ds_read_b128 v[48:51], v1 offset:20800
    v_cvt_pk_bf16_f32 v116, v72, v73
    v_mfma_f32_16x16x32_bf16 v[76:79], a[60:63], v[60:63], v[76:79]
    v_exp_f32 v74, v74
    v_mfma_f32_16x16x32_bf16 v[228:231], a[132:135], v[124:127], 0
    v_exp_f32 v75, v75
    v_mfma_f32_16x16x32_bf16 v[228:231], a[164:167], v[148:151], v[228:231]
    ds_read_b128 v[52:55], v1 offset:21056
    v_cvt_pk_bf16_f32 v117, v74, v75
    v_mfma_f32_16x16x32_bf16 v[228:231], a[196:199], v[152:155], v[228:231]
    s_waitcnt vmcnt(12) lgkmcnt(6)
    ds_read_b128 v[56:59], v1 offset:21312
    v_add_f32 v248, v248, v20
    v_mfma_f32_16x16x32_bf16 v[228:231], a[228:231], v[156:159], v[228:231]
    s_barrier
    ds_read_b128 v[60:63], v1 offset:21568
    ds_read_b64_tr_b16 a[136:137], v192 offset:0
    v_mfma_f32_16x16x32_bf16 v[64:67], a[32:35], v[32:35], -4.0
    v_exp_f32 v76, v76
    v_mfma_f32_16x16x32_bf16 v[64:67], a[36:39], v[36:39], v[64:67]
    v_exp_f32 v77, v77
    v_mfma_f32_16x16x32_bf16 v[64:67], a[40:43], v[40:43], v[64:67]
    ds_read_b64_tr_b16 a[138:139], v192 offset:16640
    v_cvt_pk_bf16_f32 v118, v76, v77
    v_mfma_f32_16x16x32_bf16 v[64:67], a[44:47], v[44:47], v[64:67]
    s_waitcnt lgkmcnt(7)
    v_exp_f32 v78, v78
    v_mfma_f32_16x16x32_bf16 v[160:163], a[128:131], v[96:99], v[240:243]
    ds_read_b64_tr_b16 a[140:141], v192 offset:8
    ds_read_b64_tr_b16 a[142:143], v192 offset:16648
    v_mfma_f32_16x16x32_bf16 v[160:163], a[160:163], v[132:135], v[160:163]
    v_exp_f32 v79, v79
    v_mfma_f32_16x16x32_bf16 v[160:163], a[192:195], v[136:139], v[160:163]
    ds_read_b64_tr_b16 a[168:169], v193 offset:0
    v_cvt_pk_bf16_f32 v119, v78, v79
    v_mfma_f32_16x16x32_bf16 v[160:163], a[224:227], v[140:143], v[160:163]
    ds_read_b64_tr_b16 a[170:171], v193 offset:16640
    ds_read_b64_tr_b16 a[172:173], v193 offset:8
    v_mfma_f32_16x16x32_bf16 v[68:71], a[48:51], v[32:35], -4.0
    ds_write_b128 v3, v[116:119] offset:5120
    v_mfma_f32_16x16x32_bf16 v[68:71], a[52:55], v[36:39], v[68:71]
    v_exp_f32 v64, v64
    v_mfma_f32_16x16x32_bf16 v[68:71], a[56:59], v[40:43], v[68:71]
    ds_read_b64_tr_b16 a[174:175], v193 offset:16648
    ds_read_b64_tr_b16 a[200:201], v194 offset:0
    v_mfma_f32_16x16x32_bf16 v[68:71], a[60:63], v[44:47], v[68:71]
    v_exp_f32 v65, v65
    v_mfma_f32_16x16x32_bf16 v[164:167], a[132:135], v[96:99], v[240:243]
    ds_read_b128 v[148:151], v4 offset:1024
    v_cvt_pk_bf16_f32 v120, v64, v65
    v_mfma_f32_16x16x32_bf16 v[164:167], a[164:167], v[132:135], v[164:167]
    ds_read_b128 v[32:35], v1 offset:24960
    ds_read_b64_tr_b16 a[202:203], v194 offset:16640
    v_mfma_f32_16x16x32_bf16 v[164:167], a[196:199], v[136:139], v[164:167]
    ds_read_b128 v[152:155], v5 offset:1024
    ds_read_b128 v[36:39], v1 offset:25216
    ds_read_b64_tr_b16 a[204:205], v194 offset:8
    v_exp_f32 v66, v66
    v_mfma_f32_16x16x32_bf16 v[164:167], a[228:231], v[140:143], v[164:167]
    s_waitcnt lgkmcnt(14)
    ds_read_b128 v[156:159], v6 offset:1024
    ds_read_b128 v[40:43], v1 offset:25472
    ds_read_b64_tr_b16 a[206:207], v194 offset:16648
    v_mfma_f32_16x16x32_bf16 v[72:75], a[32:35], v[48:51], -4.0
    ds_read_b128 v[44:47], v1 offset:25728
    ds_read_b64_tr_b16 a[232:233], v195 offset:0
    v_exp_f32 v67, v67
    v_mfma_f32_16x16x32_bf16 v[72:75], a[36:39], v[52:55], v[72:75]
    ds_read_b64_tr_b16 a[234:235], v195 offset:16640
    v_cvt_pk_bf16_f32 v121, v66, v67
    v_mfma_f32_16x16x32_bf16 v[72:75], a[40:43], v[56:59], v[72:75]
    ds_read_b64_tr_b16 a[236:237], v195 offset:8
    v_exp_f32 v68, v68
    v_mfma_f32_16x16x32_bf16 v[72:75], a[44:47], v[60:63], v[72:75]
    s_waitcnt lgkmcnt(6)
    ds_read_b64_tr_b16 a[238:239], v195 offset:16648
    ds_read_b128 v[132:135], v4 offset:2048
    v_mfma_f32_16x16x32_bf16 v[168:171], a[128:131], v[100:103], v[240:243]
    v_exp_f32 v69, v69
    v_mfma_f32_16x16x32_bf16 v[168:171], a[160:163], v[148:151], v[168:171]
    ds_read_b128 v[136:139], v5 offset:2048
    v_cvt_pk_bf16_f32 v122, v68, v69
    v_mfma_f32_16x16x32_bf16 v[168:171], a[192:195], v[152:155], v[168:171]
    v_exp_f32 v70, v70
    v_mfma_f32_16x16x32_bf16 v[168:171], a[224:227], v[156:159], v[168:171]
    v_exp_f32 v71, v71
    v_mfma_f32_16x16x32_bf16 v[20:23], v[24:27], v[112:115], 0
    ds_read_b128 v[140:143], v6 offset:2048
    v_cvt_pk_bf16_f32 v123, v70, v71
    v_mfma_f32_16x16x32_bf16 v[20:23], v[28:31], v[116:119], v[20:23]
    ds_write_b128 v3, v[120:123] offset:6144
    v_mfma_f32_16x16x32_bf16 v[76:79], a[48:51], v[48:51], -4.0
    v_exp_f32 v72, v72
    v_mfma_f32_16x16x32_bf16 v[76:79], a[52:55], v[52:55], v[76:79]
    v_exp_f32 v73, v73
    v_mfma_f32_16x16x32_bf16 v[76:79], a[56:59], v[56:59], v[76:79]
    ds_read_b128 v[48:51], v1 offset:29120
    v_cvt_pk_bf16_f32 v124, v72, v73
    v_mfma_f32_16x16x32_bf16 v[76:79], a[60:63], v[60:63], v[76:79]
    v_exp_f32 v74, v74
    v_mfma_f32_16x16x32_bf16 v[172:175], a[132:135], v[100:103], v[240:243]
    v_exp_f32 v75, v75
    v_mfma_f32_16x16x32_bf16 v[172:175], a[164:167], v[148:151], v[172:175]
    ds_read_b128 v[52:55], v1 offset:29376
    v_cvt_pk_bf16_f32 v125, v74, v75
    v_mfma_f32_16x16x32_bf16 v[172:175], a[196:199], v[152:155], v[172:175]
    s_waitcnt lgkmcnt(6)
    ds_read_b128 v[56:59], v1 offset:29632
    v_add_f32 v249, v249, v20
    v_mfma_f32_16x16x32_bf16 v[172:175], a[228:231], v[156:159], v[172:175]
    s_barrier
    ds_read_b128 v[60:63], v1 offset:29888
    ds_read_b128 v[148:151], v4 offset:3072
    v_mfma_f32_16x16x32_bf16 v[64:67], a[32:35], v[32:35], -4.0
    s_add_u32 m0, s72, 108160
    v_exp_f32 v76, v76
    v_mfma_f32_16x16x32_bf16 v[64:67], a[36:39], v[36:39], v[64:67]
    v_exp_f32 v77, v77
    v_mfma_f32_16x16x32_bf16 v[64:67], a[40:43], v[40:43], v[64:67]
    ds_read_b128 v[152:155], v5 offset:3072
    v_cvt_pk_bf16_f32 v126, v76, v77
    v_mfma_f32_16x16x32_bf16 v[64:67], a[44:47], v[44:47], v[64:67]
    s_waitcnt lgkmcnt(7)
    v_exp_f32 v78, v78
    v_mfma_f32_16x16x32_bf16 v[80:83], a[136:139], v[104:107], v[80:83]
    buffer_load_dwordx4 v0, s[12:15], s69 offen offset:0 nt lds
    v_mfma_f32_16x16x32_bf16 v[80:83], a[168:171], v[132:135], v[80:83]
    v_exp_f32 v79, v79
    v_mfma_f32_16x16x32_bf16 v[80:83], a[200:203], v[136:139], v[80:83]
    ds_read_b128 v[156:159], v6 offset:3072
    v_cvt_pk_bf16_f32 v127, v78, v79
    v_mfma_f32_16x16x32_bf16 v[80:83], a[232:235], v[140:143], v[80:83]
    ds_write_b128 v3, v[124:127] offset:7168
    v_mfma_f32_16x16x32_bf16 v[68:71], a[48:51], v[32:35], -4.0
    v_exp_f32 v64, v64
    v_mfma_f32_16x16x32_bf16 v[68:71], a[52:55], v[36:39], v[68:71]
    v_exp_f32 v65, v65
    v_mfma_f32_16x16x32_bf16 v[68:71], a[56:59], v[40:43], v[68:71]
    buffer_load_dwordx4 v0, s[12:15], s69 offen offset:1024 nt lds
    v_mfma_f32_16x16x32_bf16 v[68:71], a[60:63], v[44:47], v[68:71]
    ds_read_b128 v[32:35], v1 offset:33280
    v_cvt_pk_bf16_f32 v96, v64, v65
    v_mfma_f32_16x16x32_bf16 v[84:87], a[140:143], v[104:107], v[84:87]
    v_exp_f32 v66, v66
    v_mfma_f32_16x16x32_bf16 v[84:87], a[172:175], v[132:135], v[84:87]
    ds_read_b128 v[36:39], v1 offset:33536
    ds_read_b128 v[40:43], v1 offset:33792
    v_mfma_f32_16x16x32_bf16 v[84:87], a[204:207], v[136:139], v[84:87]
    v_exp_f32 v67, v67
    v_mfma_f32_16x16x32_bf16 v[84:87], a[236:239], v[140:143], v[84:87]
    s_waitcnt lgkmcnt(7)
    ds_read_b128 v[44:47], v1 offset:34048
    v_cvt_pk_bf16_f32 v97, v66, v67
    v_mfma_f32_16x16x32_bf16 v[72:75], a[32:35], v[48:51], -4.0
    buffer_load_dwordx4 v0, s[12:15], s69 offen offset:2048 nt lds
    v_mfma_f32_16x16x32_bf16 v[72:75], a[36:39], v[52:55], v[72:75]
    v_exp_f32 v68, v68
    v_mfma_f32_16x16x32_bf16 v[72:75], a[40:43], v[56:59], v[72:75]
    v_exp_f32 v69, v69
    v_mfma_f32_16x16x32_bf16 v[72:75], a[44:47], v[60:63], v[72:75]
    s_waitcnt lgkmcnt(5)
    ds_read_b128 v[132:135], v4 offset:4096
    v_cvt_pk_bf16_f32 v98, v68, v69
    v_mfma_f32_16x16x32_bf16 v[88:91], a[136:139], v[108:111], v[88:91]
    v_exp_f32 v70, v70
    v_mfma_f32_16x16x32_bf16 v[88:91], a[168:171], v[148:151], v[88:91]
    buffer_load_dwordx4 v0, s[12:15], s69 offen offset:3072 nt lds
    v_mfma_f32_16x16x32_bf16 v[88:91], a[200:203], v[152:155], v[88:91]
    v_exp_f32 v71, v71
    v_mfma_f32_16x16x32_bf16 v[88:91], a[232:235], v[156:159], v[88:91]
    ds_read_b128 v[136:139], v5 offset:4096
    v_cvt_pk_bf16_f32 v99, v70, v71
    v_mfma_f32_16x16x32_bf16 v[20:23], v[24:27], v[120:123], 0
    ds_write_b128 v3, v[96:99] offset:0
    v_mfma_f32_16x16x32_bf16 v[20:23], v[28:31], v[124:127], v[20:23]
    v_exp_f32 v72, v72
    v_mfma_f32_16x16x32_bf16 v[76:79], a[48:51], v[48:51], -4.0
    v_exp_f32 v73, v73
    v_mfma_f32_16x16x32_bf16 v[76:79], a[52:55], v[52:55], v[76:79]
    ds_read_b128 v[48:51], v1 offset:37440
    v_cvt_pk_bf16_f32 v100, v72, v73
    v_mfma_f32_16x16x32_bf16 v[76:79], a[56:59], v[56:59], v[76:79]
    v_exp_f32 v74, v74
    v_mfma_f32_16x16x32_bf16 v[76:79], a[60:63], v[60:63], v[76:79]
    v_exp_f32 v75, v75
    v_mfma_f32_16x16x32_bf16 v[92:95], a[140:143], v[108:111], v[92:95]
    ds_read_b128 v[52:55], v1 offset:37696
    v_cvt_pk_bf16_f32 v101, v74, v75
    v_mfma_f32_16x16x32_bf16 v[92:95], a[172:175], v[148:151], v[92:95]
    ds_read_b128 v[140:143], v6 offset:4096
    ds_read_b128 v[56:59], v1 offset:37952
    v_mfma_f32_16x16x32_bf16 v[92:95], a[204:207], v[152:155], v[92:95]
    s_waitcnt lgkmcnt(7)
    ds_read_b128 v[60:63], v1 offset:38208
    v_add_f32 v250, v250, v20
    v_mfma_f32_16x16x32_bf16 v[92:95], a[236:239], v[156:159], v[92:95]
    s_barrier
    v_exp_f32 v76, v76
    v_mfma_f32_16x16x32_bf16 v[64:67], a[32:35], v[32:35], -4.0
    v_exp_f32 v77, v77
    v_mfma_f32_16x16x32_bf16 v[64:67], a[36:39], v[36:39], v[64:67]
    ds_read_b128 v[148:151], v4 offset:5120
    v_cvt_pk_bf16_f32 v102, v76, v77
    v_mfma_f32_16x16x32_bf16 v[64:67], a[40:43], v[40:43], v[64:67]
    v_exp_f32 v78, v78
    v_mfma_f32_16x16x32_bf16 v[64:67], a[44:47], v[44:47], v[64:67]
    s_waitcnt lgkmcnt(3)
    v_exp_f32 v79, v79
    v_mfma_f32_16x16x32_bf16 v[176:179], a[136:139], v[112:115], v[176:179]
    ds_read_b128 v[152:155], v5 offset:5120
    v_cvt_pk_bf16_f32 v103, v78, v79
    v_mfma_f32_16x16x32_bf16 v[176:179], a[168:171], v[132:135], v[176:179]
    ds_write_b128 v3, v[100:103] offset:1024
    v_mfma_f32_16x16x32_bf16 v[176:179], a[200:203], v[136:139], v[176:179]
    ds_read_b128 v[156:159], v6 offset:5120
    v_mfma_f32_16x16x32_bf16 v[176:179], a[232:235], v[140:143], v[176:179]
    v_exp_f32 v64, v64
    v_mfma_f32_16x16x32_bf16 v[68:71], a[48:51], v[32:35], -4.0
    v_exp_f32 v65, v65
    v_mfma_f32_16x16x32_bf16 v[68:71], a[52:55], v[36:39], v[68:71]
    ds_read_b128 v[32:35], v1 offset:0
    v_cvt_pk_bf16_f32 v104, v64, v65
    v_mfma_f32_16x16x32_bf16 v[68:71], a[56:59], v[40:43], v[68:71]
    v_exp_f32 v66, v66
    v_mfma_f32_16x16x32_bf16 v[68:71], a[60:63], v[44:47], v[68:71]
    ds_read_b128 v[36:39], v1 offset:256
    ds_read_b128 v[40:43], v1 offset:512
    v_mfma_f32_16x16x32_bf16 v[180:183], a[140:143], v[112:115], v[180:183]
    v_exp_f32 v67, v67
    v_mfma_f32_16x16x32_bf16 v[180:183], a[172:175], v[132:135], v[180:183]
    ds_read_b128 v[44:47], v1 offset:768
    v_cvt_pk_bf16_f32 v105, v66, v67
    v_mfma_f32_16x16x32_bf16 v[180:183], a[204:207], v[136:139], v[180:183]
    v_exp_f32 v68, v68
    v_mfma_f32_16x16x32_bf16 v[180:183], a[236:239], v[140:143], v[180:183]
    s_waitcnt lgkmcnt(8)
    v_exp_f32 v69, v69
    v_mfma_f32_16x16x32_bf16 v[72:75], a[32:35], v[48:51], -4.0
    ds_read_b128 v[132:135], v4 offset:6144
    v_cvt_pk_bf16_f32 v106, v68, v69
    v_mfma_f32_16x16x32_bf16 v[72:75], a[36:39], v[52:55], v[72:75]
    v_exp_f32 v70, v70
    v_mfma_f32_16x16x32_bf16 v[72:75], a[40:43], v[56:59], v[72:75]
    v_exp_f32 v71, v71
    v_mfma_f32_16x16x32_bf16 v[72:75], a[44:47], v[60:63], v[72:75]
    s_waitcnt vmcnt(8) lgkmcnt(5)
    ds_read_b128 a[64:67], v255 offset:0
    v_cvt_pk_bf16_f32 v107, v70, v71
    v_mfma_f32_16x16x32_bf16 v[184:187], a[136:139], v[116:119], v[184:187]
    ds_read_b128 a[68:71], v255 offset:256
    ds_read_b128 a[72:75], v255 offset:512
    v_mfma_f32_16x16x32_bf16 v[184:187], a[168:171], v[148:151], v[184:187]
    ds_write_b128 v3, v[104:107] offset:2048
    v_mfma_f32_16x16x32_bf16 v[184:187], a[200:203], v[152:155], v[184:187]
    v_exp_f32 v72, v72
    v_mfma_f32_16x16x32_bf16 v[184:187], a[232:235], v[156:159], v[184:187]
    ds_read_b128 a[76:79], v255 offset:768
    ds_read_b128 a[80:83], v255 offset:4160
    v_mfma_f32_16x16x32_bf16 v[20:23], v[24:27], v[96:99], 0
    v_exp_f32 v73, v73
    v_mfma_f32_16x16x32_bf16 v[20:23], v[28:31], v[100:103], v[20:23]
    ds_read_b128 a[84:87], v255 offset:4416
    v_cvt_pk_bf16_f32 v108, v72, v73
    v_mfma_f32_16x16x32_bf16 v[76:79], a[48:51], v[48:51], -4.0
    v_exp_f32 v74, v74
    v_mfma_f32_16x16x32_bf16 v[76:79], a[52:55], v[52:55], v[76:79]
    ds_read_b128 a[88:91], v255 offset:4672
    ds_read_b128 v[48:51], v1 offset:4160
    v_mfma_f32_16x16x32_bf16 v[76:79], a[56:59], v[56:59], v[76:79]
    ds_read_b128 a[92:95], v255 offset:4928
    ds_read_b128 v[136:139], v5 offset:6144
    v_mfma_f32_16x16x32_bf16 v[76:79], a[60:63], v[60:63], v[76:79]
    v_exp_f32 v75, v75
    v_mfma_f32_16x16x32_bf16 v[188:191], a[140:143], v[116:119], v[188:191]
    ds_read_b128 v[52:55], v1 offset:4416
    v_cvt_pk_bf16_f32 v109, v74, v75
    v_mfma_f32_16x16x32_bf16 v[188:191], a[172:175], v[148:151], v[188:191]
    ds_read_b128 v[140:143], v6 offset:6144
    ds_read_b128 v[56:59], v1 offset:4672
    v_mfma_f32_16x16x32_bf16 v[188:191], a[204:207], v[152:155], v[188:191]
    ds_read_b128 v[60:63], v1 offset:4928
    v_add_f32 v251, v251, v20
    v_mfma_f32_16x16x32_bf16 v[188:191], a[236:239], v[156:159], v[188:191]
    s_barrier
    v_exp_f32 v76, v76
    s_waitcnt lgkmcnt(0)
    v_mfma_f32_16x16x32_bf16 v[192:195], a[152:155], a[64:67], 0
    s_add_u32 m0, s54, 0
    s_add_u32 s45, s44, 24576
    buffer_load_dwordx4 v7, s[8:11], s45 offen offset:0 nt lds
    s_nop 1
    v_mfma_f32_16x16x32_bf16 v[192:195], a[184:187], a[64:67], v[192:195]
    s_nop 1
    v_mfma_f32_16x16x32_bf16 v[196:199], a[156:159], a[64:67], 0
    s_nop 1
    v_mfma_f32_16x16x32_bf16 v[196:199], a[188:191], a[64:67], v[196:199]
    s_nop 1
    v_mfma_f32_16x16x32_bf16 v[16:19], a[152:155], a[68:71], 0
    buffer_load_dwordx4 v7, s[8:11], s45 offen offset:1024 nt lds
    v_cvt_pk_bf16_f32 v192, v192, v193
    v_cvt_pk_bf16_f32 v193, v194, v195
    v_mfma_f32_16x16x32_bf16 v[16:19], a[184:187], a[68:71], v[16:19]
    v_accvgpr_write_b32 a64, v192
    v_accvgpr_write_b32 a65, v193
    v_mfma_f32_16x16x32_bf16 v[192:195], a[156:159], a[68:71], 0
    v_cvt_pk_bf16_f32 v196, v196, v197
    v_cvt_pk_bf16_f32 v197, v198, v199
    v_mfma_f32_16x16x32_bf16 v[192:195], a[188:191], a[68:71], v[192:195]
    v_accvgpr_write_b32 a66, v196
    v_accvgpr_write_b32 a67, v197
    v_mfma_f32_16x16x32_bf16 v[196:199], a[152:155], a[72:75], 0
    s_add_u32 m0, s54, 2080
    s_add_u32 s45, s44, 26624
    buffer_load_dwordx4 v7, s[8:11], s45 offen offset:0 nt lds
    v_cvt_pk_bf16_f32 v16, v16, v17
    v_cvt_pk_bf16_f32 v17, v18, v19
    v_mfma_f32_16x16x32_bf16 v[196:199], a[184:187], a[72:75], v[196:199]
    v_accvgpr_write_b32 a68, v16
    v_accvgpr_write_b32 a69, v17
    v_mfma_f32_16x16x32_bf16 v[16:19], a[156:159], a[72:75], 0
    v_cvt_pk_bf16_f32 v192, v192, v193
    v_cvt_pk_bf16_f32 v193, v194, v195
    v_mfma_f32_16x16x32_bf16 v[16:19], a[188:191], a[72:75], v[16:19]
    v_accvgpr_write_b32 a70, v192
    v_accvgpr_write_b32 a71, v193
    v_mfma_f32_16x16x32_bf16 v[192:195], a[152:155], a[76:79], 0
    buffer_load_dwordx4 v7, s[8:11], s45 offen offset:1024 nt lds
    v_cvt_pk_bf16_f32 v196, v196, v197
    v_cvt_pk_bf16_f32 v197, v198, v199
    v_mfma_f32_16x16x32_bf16 v[192:195], a[184:187], a[76:79], v[192:195]
    v_accvgpr_write_b32 a72, v196
    v_accvgpr_write_b32 a73, v197
    v_mfma_f32_16x16x32_bf16 v[196:199], a[156:159], a[76:79], 0
    v_cvt_pk_bf16_f32 v16, v16, v17
    v_cvt_pk_bf16_f32 v17, v18, v19
    v_mfma_f32_16x16x32_bf16 v[196:199], a[188:191], a[76:79], v[196:199]
    v_accvgpr_write_b32 a74, v16
    v_accvgpr_write_b32 a75, v17
    v_mfma_f32_16x16x32_bf16 v[16:19], a[152:155], a[80:83], 0
    s_add_u32 m0, s54, 4160
    s_add_u32 s45, s44, 28672
    buffer_load_dwordx4 v7, s[8:11], s45 offen offset:0 nt lds
    v_cvt_pk_bf16_f32 v192, v192, v193
    v_cvt_pk_bf16_f32 v193, v194, v195
    v_mfma_f32_16x16x32_bf16 v[16:19], a[184:187], a[80:83], v[16:19]
    v_accvgpr_write_b32 a76, v192
    v_accvgpr_write_b32 a77, v193
    v_mfma_f32_16x16x32_bf16 v[192:195], a[156:159], a[80:83], 0
    v_cvt_pk_bf16_f32 v196, v196, v197
    v_cvt_pk_bf16_f32 v197, v198, v199
    v_mfma_f32_16x16x32_bf16 v[192:195], a[188:191], a[80:83], v[192:195]
    v_accvgpr_write_b32 a78, v196
    v_accvgpr_write_b32 a79, v197
    v_mfma_f32_16x16x32_bf16 v[196:199], a[152:155], a[84:87], 0
    buffer_load_dwordx4 v7, s[8:11], s45 offen offset:1024 nt lds
    v_cvt_pk_bf16_f32 v16, v16, v17
    v_cvt_pk_bf16_f32 v17, v18, v19
    v_mfma_f32_16x16x32_bf16 v[196:199], a[184:187], a[84:87], v[196:199]
    v_accvgpr_write_b32 a80, v16
    v_accvgpr_write_b32 a81, v17
    v_mfma_f32_16x16x32_bf16 v[16:19], a[156:159], a[84:87], 0
    v_cvt_pk_bf16_f32 v192, v192, v193
    v_cvt_pk_bf16_f32 v193, v194, v195
    v_mfma_f32_16x16x32_bf16 v[16:19], a[188:191], a[84:87], v[16:19]
    v_accvgpr_write_b32 a82, v192
    v_accvgpr_write_b32 a83, v193
    v_mfma_f32_16x16x32_bf16 v[192:195], a[152:155], a[88:91], 0
    s_add_u32 m0, s54, 6240
    s_add_u32 s45, s44, 30720
    buffer_load_dwordx4 v7, s[8:11], s45 offen offset:0 nt lds
    v_cvt_pk_bf16_f32 v196, v196, v197
    v_cvt_pk_bf16_f32 v197, v198, v199
    v_mfma_f32_16x16x32_bf16 v[192:195], a[184:187], a[88:91], v[192:195]
    v_accvgpr_write_b32 a84, v196
    v_accvgpr_write_b32 a85, v197
    v_mfma_f32_16x16x32_bf16 v[196:199], a[156:159], a[88:91], 0
    v_cvt_pk_bf16_f32 v16, v16, v17
    v_cvt_pk_bf16_f32 v17, v18, v19
    v_mfma_f32_16x16x32_bf16 v[196:199], a[188:191], a[88:91], v[196:199]
    v_accvgpr_write_b32 a86, v16
    v_accvgpr_write_b32 a87, v17
    v_mfma_f32_16x16x32_bf16 v[16:19], a[152:155], a[92:95], 0
    buffer_load_dwordx4 v7, s[8:11], s45 offen offset:1024 nt lds
    v_cvt_pk_bf16_f32 v192, v192, v193
    v_cvt_pk_bf16_f32 v193, v194, v195
    v_mfma_f32_16x16x32_bf16 v[16:19], a[184:187], a[92:95], v[16:19]
    v_accvgpr_write_b32 a88, v192
    v_accvgpr_write_b32 a89, v193
    v_mfma_f32_16x16x32_bf16 v[192:195], a[156:159], a[92:95], 0
    v_cvt_pk_bf16_f32 v196, v196, v197
    v_cvt_pk_bf16_f32 v197, v198, v199
    v_mfma_f32_16x16x32_bf16 v[192:195], a[188:191], a[92:95], v[192:195]
    v_accvgpr_write_b32 a90, v196
    v_accvgpr_write_b32 a91, v197
    v_mfma_f32_16x16x32_bf16 v[64:67], a[64:67], v[32:35], -4.0
    ds_read_b128 v[148:151], v4 offset:7168
    v_cvt_pk_bf16_f32 v16, v16, v17
    v_cvt_pk_bf16_f32 v17, v18, v19
    v_accvgpr_write_b32 a92, v16
    v_accvgpr_write_b32 a93, v17
    v_cvt_pk_bf16_f32 v192, v192, v193
    v_cvt_pk_bf16_f32 v193, v194, v195
    v_accvgpr_write_b32 a94, v192
    v_accvgpr_write_b32 a95, v193
    v_mfma_f32_16x16x32_bf16 v[64:67], a[68:71], v[36:39], v[64:67]
    v_exp_f32 v77, v77
    v_mfma_f32_16x16x32_bf16 v[64:67], a[72:75], v[40:43], v[64:67]
    ds_read_b128 v[152:155], v5 offset:7168
    v_cvt_pk_bf16_f32 v110, v76, v77
    v_mfma_f32_16x16x32_bf16 v[64:67], a[76:79], v[44:47], v[64:67]
    v_exp_f32 v78, v78
    v_mfma_f32_16x16x32_bf16 v[200:203], a[136:139], v[120:123], v[200:203]
    v_exp_f32 v79, v79
    v_mfma_f32_16x16x32_bf16 v[200:203], a[168:171], v[132:135], v[200:203]
    ds_read_b128 v[156:159], v6 offset:7168
    v_cvt_pk_bf16_f32 v111, v78, v79
    v_mfma_f32_16x16x32_bf16 v[200:203], a[200:203], v[136:139], v[200:203]
    ds_write_b128 v3, v[108:111] offset:3072
    v_mfma_f32_16x16x32_bf16 v[200:203], a[232:235], v[140:143], v[200:203]
    v_exp_f32 v64, v64
    v_mfma_f32_16x16x32_bf16 v[68:71], a[80:83], v[32:35], -4.0
    v_exp_f32 v65, v65
    v_mfma_f32_16x16x32_bf16 v[68:71], a[84:87], v[36:39], v[68:71]
    ds_read_b128 v[32:35], v1 offset:8320
    v_cvt_pk_bf16_f32 v112, v64, v65
    v_mfma_f32_16x16x32_bf16 v[68:71], a[88:91], v[40:43], v[68:71]
    v_exp_f32 v66, v66
    v_mfma_f32_16x16x32_bf16 v[68:71], a[92:95], v[44:47], v[68:71]
    ds_read_b128 v[36:39], v1 offset:8576
    ds_read_b128 v[40:43], v1 offset:8832
    v_mfma_f32_16x16x32_bf16 v[204:207], a[140:143], v[120:123], v[204:207]
    v_exp_f32 v67, v67
    v_mfma_f32_16x16x32_bf16 v[204:207], a[172:175], v[132:135], v[204:207]
    ds_read_b128 v[44:47], v1 offset:9088
    v_cvt_pk_bf16_f32 v113, v66, v67
    v_mfma_f32_16x16x32_bf16 v[204:207], a[204:207], v[136:139], v[204:207]
    v_exp_f32 v68, v68
    v_mfma_f32_16x16x32_bf16 v[204:207], a[236:239], v[140:143], v[204:207]
    v_exp_f32 v69, v69
    v_mfma_f32_16x16x32_bf16 v[72:75], a[64:67], v[48:51], -4.0
    ds_read_b128 v[132:135], v4 offset:0
    v_cvt_pk_bf16_f32 v114, v68, v69
    v_mfma_f32_16x16x32_bf16 v[72:75], a[68:71], v[52:55], v[72:75]
    v_exp_f32 v70, v70
    v_mfma_f32_16x16x32_bf16 v[72:75], a[72:75], v[56:59], v[72:75]
    v_exp_f32 v71, v71
    v_mfma_f32_16x16x32_bf16 v[72:75], a[76:79], v[60:63], v[72:75]
    s_waitcnt lgkmcnt(6)
    ds_read_b128 v[136:139], v5 offset:0
    v_cvt_pk_bf16_f32 v115, v70, v71
    v_mfma_f32_16x16x32_bf16 v[208:211], a[136:139], v[124:127], v[208:211]
    ds_write_b128 v3, v[112:115] offset:4096
    v_mfma_f32_16x16x32_bf16 v[208:211], a[168:171], v[148:151], v[208:211]
    ds_read_b128 v[140:143], v6 offset:0
    s_nop 0
    v_mfma_f32_16x16x32_bf16 v[208:211], a[200:203], v[152:155], v[208:211]
    v_exp_f32 v72, v72
    v_mfma_f32_16x16x32_bf16 v[208:211], a[232:235], v[156:159], v[208:211]
    v_exp_f32 v73, v73
    v_mfma_f32_16x16x32_bf16 v[20:23], v[24:27], v[104:107], 0
    v_exp_f32 v74, v74
    v_mfma_f32_16x16x32_bf16 v[20:23], v[28:31], v[108:111], v[20:23]
    v_cvt_pk_bf16_f32 v116, v72, v73
    s_nop 0
    v_mfma_f32_16x16x32_bf16 v[76:79], a[80:83], v[48:51], -4.0
    s_add_u32 m0, s72, 124800
    v_exp_f32 v75, v75
    v_mfma_f32_16x16x32_bf16 v[76:79], a[84:87], v[52:55], v[76:79]
    ds_read_b128 v[48:51], v1 offset:12480
    ds_read_b128 v[52:55], v1 offset:12736
    v_mfma_f32_16x16x32_bf16 v[76:79], a[88:91], v[56:59], v[76:79]
    ds_read_b128 v[56:59], v1 offset:12992
    v_cvt_pk_bf16_f32 v117, v74, v75
    v_mfma_f32_16x16x32_bf16 v[76:79], a[92:95], v[60:63], v[76:79]
    ds_read_b128 v[60:63], v1 offset:13248
    v_add_f32 v252, v252, v20
    v_mfma_f32_16x16x32_bf16 v[212:215], a[140:143], v[124:127], v[212:215]
    buffer_load_dwordx4 v0, s[12:15], s70 offen offset:0 nt lds
    v_mfma_f32_16x16x32_bf16 v[212:215], a[172:175], v[148:151], v[212:215]
    ds_read_b128 v[148:151], v4 offset:1024
    s_nop 0
    v_mfma_f32_16x16x32_bf16 v[212:215], a[204:207], v[152:155], v[212:215]
    s_waitcnt lgkmcnt(9)
    v_exp_f32 v76, v76
    v_mfma_f32_16x16x32_bf16 v[212:215], a[236:239], v[156:159], v[212:215]
    s_barrier
    v_exp_f32 v77, v77
    v_mfma_f32_16x16x32_bf16 v[64:67], a[64:67], v[32:35], -4.0
    v_add_u32 v192, s50, v15
    v_cvt_pk_bf16_f32 v118, v76, v77
    v_mfma_f32_16x16x32_bf16 v[64:67], a[68:71], v[36:39], v[64:67]
    v_add_u32 v193, s51, v15
    v_add_u32 v194, s52, v15
    v_mfma_f32_16x16x32_bf16 v[64:67], a[72:75], v[40:43], v[64:67]
    v_exp_f32 v78, v78
    v_mfma_f32_16x16x32_bf16 v[64:67], a[76:79], v[44:47], v[64:67]
    s_waitcnt lgkmcnt(5)
    ds_read_b128 v[152:155], v5 offset:1024
    v_add_u32 v195, s53, v15
    v_mfma_f32_16x16x32_bf16 v[216:219], a[136:139], v[96:99], v[216:219]
    v_exp_f32 v79, v79
    v_mfma_f32_16x16x32_bf16 v[216:219], a[168:171], v[132:135], v[216:219]
    ds_read_b128 v[156:159], v6 offset:1024
    v_cvt_pk_bf16_f32 v119, v78, v79
    v_mfma_f32_16x16x32_bf16 v[216:219], a[200:203], v[136:139], v[216:219]
    buffer_load_dwordx4 v0, s[12:15], s70 offen offset:1024 nt lds
    v_mfma_f32_16x16x32_bf16 v[216:219], a[232:235], v[140:143], v[216:219]
    ds_write_b128 v3, v[116:119] offset:5120
    v_mfma_f32_16x16x32_bf16 v[68:71], a[80:83], v[32:35], -4.0
    v_exp_f32 v64, v64
    v_mfma_f32_16x16x32_bf16 v[68:71], a[84:87], v[36:39], v[68:71]
    v_exp_f32 v65, v65
    v_mfma_f32_16x16x32_bf16 v[68:71], a[88:91], v[40:43], v[68:71]
    ds_read_b128 v[32:35], v1 offset:16640
    v_cvt_pk_bf16_f32 v120, v64, v65
    v_mfma_f32_16x16x32_bf16 v[68:71], a[92:95], v[44:47], v[68:71]
    v_exp_f32 v66, v66
    v_mfma_f32_16x16x32_bf16 v[220:223], a[140:143], v[96:99], v[220:223]
    ds_read_b128 v[36:39], v1 offset:16896
    ds_read_b128 v[40:43], v1 offset:17152
    v_mfma_f32_16x16x32_bf16 v[220:223], a[172:175], v[132:135], v[220:223]
    v_exp_f32 v67, v67
    v_mfma_f32_16x16x32_bf16 v[220:223], a[204:207], v[136:139], v[220:223]
    ds_read_b128 v[44:47], v1 offset:17408
    v_cvt_pk_bf16_f32 v121, v66, v67
    v_mfma_f32_16x16x32_bf16 v[220:223], a[236:239], v[140:143], v[220:223]
    s_waitcnt lgkmcnt(8)
    v_exp_f32 v68, v68
    v_mfma_f32_16x16x32_bf16 v[72:75], a[64:67], v[48:51], -4.0
    buffer_load_dwordx4 v0, s[12:15], s70 offen offset:2048 nt lds
    v_mfma_f32_16x16x32_bf16 v[72:75], a[68:71], v[52:55], v[72:75]
    v_exp_f32 v69, v69
    v_mfma_f32_16x16x32_bf16 v[72:75], a[72:75], v[56:59], v[72:75]
    ds_read_b128 v[132:135], v4 offset:2048
    v_cvt_pk_bf16_f32 v122, v68, v69
    v_mfma_f32_16x16x32_bf16 v[72:75], a[76:79], v[60:63], v[72:75]
    s_waitcnt lgkmcnt(6)
    v_exp_f32 v70, v70
    v_mfma_f32_16x16x32_bf16 v[224:227], a[136:139], v[100:103], v[224:227]
    v_exp_f32 v71, v71
    v_mfma_f32_16x16x32_bf16 v[224:227], a[168:171], v[148:151], v[224:227]
    ds_read_b128 v[136:139], v5 offset:2048
    v_cvt_pk_bf16_f32 v123, v70, v71
    v_mfma_f32_16x16x32_bf16 v[224:227], a[200:203], v[152:155], v[224:227]
    ds_write_b128 v3, v[120:123] offset:6144
    v_mfma_f32_16x16x32_bf16 v[224:227], a[232:235], v[156:159], v[224:227]
    v_exp_f32 v72, v72
    v_mfma_f32_16x16x32_bf16 v[20:23], v[24:27], v[112:115], 0
    buffer_load_dwordx4 v0, s[12:15], s70 offen offset:3072 nt lds
    v_mfma_f32_16x16x32_bf16 v[20:23], v[28:31], v[116:119], v[20:23]
    v_exp_f32 v73, v73
    v_mfma_f32_16x16x32_bf16 v[76:79], a[80:83], v[48:51], -4.0
    ds_read_b128 v[48:51], v1 offset:20800
    v_cvt_pk_bf16_f32 v124, v72, v73
    v_mfma_f32_16x16x32_bf16 v[76:79], a[84:87], v[52:55], v[76:79]
    v_exp_f32 v74, v74
    v_mfma_f32_16x16x32_bf16 v[76:79], a[88:91], v[56:59], v[76:79]
    v_exp_f32 v75, v75
    v_mfma_f32_16x16x32_bf16 v[76:79], a[92:95], v[60:63], v[76:79]
    ds_read_b128 v[52:55], v1 offset:21056
    v_cvt_pk_bf16_f32 v125, v74, v75
    v_mfma_f32_16x16x32_bf16 v[228:231], a[140:143], v[100:103], v[228:231]
    ds_read_b128 v[140:143], v6 offset:2048
    ds_read_b128 v[56:59], v1 offset:21312
    v_mfma_f32_16x16x32_bf16 v[228:231], a[172:175], v[148:151], v[228:231]
    ds_read_b128 v[60:63], v1 offset:21568
    v_add_f32 v248, v248, v20
    v_mfma_f32_16x16x32_bf16 v[228:231], a[204:207], v[152:155], v[228:231]
    s_waitcnt vmcnt(12) lgkmcnt(8)
    v_exp_f32 v76, v76
    v_mfma_f32_16x16x32_bf16 v[228:231], a[236:239], v[156:159], v[228:231]
    s_barrier
    v_exp_f32 v77, v77
    v_mfma_f32_16x16x32_bf16 v[64:67], a[64:67], v[32:35], -4.0
    ds_read_b64_tr_b16 a[144:145], v192 offset:33024
    v_cvt_pk_bf16_f32 v126, v76, v77
    v_mfma_f32_16x16x32_bf16 v[64:67], a[68:71], v[36:39], v[64:67]
    ds_read_b64_tr_b16 a[146:147], v192 offset:0
    ds_read_b64_tr_b16 a[148:149], v192 offset:33032
    v_mfma_f32_16x16x32_bf16 v[64:67], a[72:75], v[40:43], v[64:67]
    v_exp_f32 v78, v78
    v_mfma_f32_16x16x32_bf16 v[64:67], a[76:79], v[44:47], v[64:67]
    s_waitcnt lgkmcnt(5)
    ds_read_b64_tr_b16 a[150:151], v192 offset:8
    ds_read_b64_tr_b16 a[176:177], v193 offset:33024
    v_mfma_f32_16x16x32_bf16 v[160:163], a[136:139], v[104:107], v[160:163]
    v_exp_f32 v79, v79
    v_mfma_f32_16x16x32_bf16 v[160:163], a[168:171], v[132:135], v[160:163]
    ds_read_b64_tr_b16 a[178:179], v193 offset:0
    v_cvt_pk_bf16_f32 v127, v78, v79
    v_mfma_f32_16x16x32_bf16 v[160:163], a[200:203], v[136:139], v[160:163]
    ds_write_b128 v3, v[124:127] offset:7168
    v_mfma_f32_16x16x32_bf16 v[160:163], a[232:235], v[140:143], v[160:163]
    v_exp_f32 v64, v64
    v_mfma_f32_16x16x32_bf16 v[68:71], a[80:83], v[32:35], -4.0
    ds_read_b64_tr_b16 a[180:181], v193 offset:33032
    ds_read_b64_tr_b16 a[182:183], v193 offset:8
    v_mfma_f32_16x16x32_bf16 v[68:71], a[84:87], v[36:39], v[68:71]
    v_exp_f32 v65, v65
    v_mfma_f32_16x16x32_bf16 v[68:71], a[88:91], v[40:43], v[68:71]
    ds_read_b64_tr_b16 a[208:209], v194 offset:33024
    v_cvt_pk_bf16_f32 v96, v64, v65
    v_mfma_f32_16x16x32_bf16 v[68:71], a[92:95], v[44:47], v[68:71]
    ds_read_b128 v[148:151], v4 offset:3072
    ds_read_b128 v[32:35], v1 offset:24960
    v_mfma_f32_16x16x32_bf16 v[164:167], a[140:143], v[104:107], v[164:167]
    ds_read_b64_tr_b16 a[210:211], v194 offset:0
    ds_read_b128 v[152:155], v5 offset:3072
    v_mfma_f32_16x16x32_bf16 v[164:167], a[172:175], v[132:135], v[164:167]
    v_exp_f32 v66, v66
    v_mfma_f32_16x16x32_bf16 v[164:167], a[204:207], v[136:139], v[164:167]
    ds_read_b128 v[36:39], v1 offset:25216
    ds_read_b64_tr_b16 a[212:213], v194 offset:33032
    v_mfma_f32_16x16x32_bf16 v[164:167], a[236:239], v[140:143], v[164:167]
    s_waitcnt lgkmcnt(14)
    ds_read_b128 v[156:159], v6 offset:3072
    ds_read_b128 v[40:43], v1 offset:25472
    ds_read_b64_tr_b16 a[214:215], v194 offset:8
    v_mfma_f32_16x16x32_bf16 v[72:75], a[64:67], v[48:51], -4.0
    ds_read_b128 v[44:47], v1 offset:25728
    ds_read_b64_tr_b16 a[240:241], v195 offset:33024
    v_exp_f32 v67, v67
    v_mfma_f32_16x16x32_bf16 v[72:75], a[68:71], v[52:55], v[72:75]
    ds_read_b64_tr_b16 a[242:243], v195 offset:0
    v_cvt_pk_bf16_f32 v97, v66, v67
    v_mfma_f32_16x16x32_bf16 v[72:75], a[72:75], v[56:59], v[72:75]
    ds_read_b64_tr_b16 a[244:245], v195 offset:33032
    v_exp_f32 v68, v68
    v_mfma_f32_16x16x32_bf16 v[72:75], a[76:79], v[60:63], v[72:75]
    s_waitcnt lgkmcnt(6)
    ds_read_b64_tr_b16 a[246:247], v195 offset:8
    ds_read_b128 v[132:135], v4 offset:4096
    v_mfma_f32_16x16x32_bf16 v[168:171], a[136:139], v[108:111], v[168:171]
    v_exp_f32 v69, v69
    v_mfma_f32_16x16x32_bf16 v[168:171], a[168:171], v[148:151], v[168:171]
    ds_read_b128 v[136:139], v5 offset:4096
    v_cvt_pk_bf16_f32 v98, v68, v69
    v_mfma_f32_16x16x32_bf16 v[168:171], a[200:203], v[152:155], v[168:171]
    v_exp_f32 v70, v70
    v_mfma_f32_16x16x32_bf16 v[168:171], a[232:235], v[156:159], v[168:171]
    v_exp_f32 v71, v71
    v_mfma_f32_16x16x32_bf16 v[20:23], v[24:27], v[120:123], 0
    ds_read_b128 v[140:143], v6 offset:4096
    v_cvt_pk_bf16_f32 v99, v70, v71
    v_mfma_f32_16x16x32_bf16 v[20:23], v[28:31], v[124:127], v[20:23]
    ds_write_b128 v3, v[96:99] offset:0
    v_mfma_f32_16x16x32_bf16 v[76:79], a[80:83], v[48:51], -4.0
    v_exp_f32 v72, v72
    v_mfma_f32_16x16x32_bf16 v[76:79], a[84:87], v[52:55], v[76:79]
    v_exp_f32 v73, v73
    v_mfma_f32_16x16x32_bf16 v[76:79], a[88:91], v[56:59], v[76:79]
    ds_read_b128 v[48:51], v1 offset:29120
    v_cvt_pk_bf16_f32 v100, v72, v73
    v_mfma_f32_16x16x32_bf16 v[76:79], a[92:95], v[60:63], v[76:79]
    v_exp_f32 v74, v74
    v_mfma_f32_16x16x32_bf16 v[172:175], a[140:143], v[108:111], v[172:175]
    v_exp_f32 v75, v75
    v_mfma_f32_16x16x32_bf16 v[172:175], a[172:175], v[148:151], v[172:175]
    ds_read_b128 v[52:55], v1 offset:29376
    v_cvt_pk_bf16_f32 v101, v74, v75
    v_mfma_f32_16x16x32_bf16 v[172:175], a[204:207], v[152:155], v[172:175]
    s_waitcnt lgkmcnt(6)
    ds_read_b128 v[56:59], v1 offset:29632
    v_add_f32 v249, v249, v20
    v_mfma_f32_16x16x32_bf16 v[172:175], a[236:239], v[156:159], v[172:175]
    s_barrier
    ds_read_b128 v[60:63], v1 offset:29888
    ds_read_b128 v[148:151], v4 offset:5120
    v_mfma_f32_16x16x32_bf16 v[64:67], a[64:67], v[32:35], -4.0
    s_add_u32 m0, s72, 141184
    v_exp_f32 v76, v76
    v_mfma_f32_16x16x32_bf16 v[64:67], a[68:71], v[36:39], v[64:67]
    v_exp_f32 v77, v77
    v_mfma_f32_16x16x32_bf16 v[64:67], a[72:75], v[40:43], v[64:67]
    ds_read_b128 v[152:155], v5 offset:5120
    v_cvt_pk_bf16_f32 v102, v76, v77
    v_mfma_f32_16x16x32_bf16 v[64:67], a[76:79], v[44:47], v[64:67]
    s_waitcnt lgkmcnt(7)
    v_exp_f32 v78, v78
    v_mfma_f32_16x16x32_bf16 v[80:83], a[144:147], v[112:115], v[80:83]
    buffer_load_dwordx4 v0, s[12:15], s71 offen offset:0 nt lds
    v_mfma_f32_16x16x32_bf16 v[80:83], a[176:179], v[132:135], v[80:83]
    v_exp_f32 v79, v79
    v_mfma_f32_16x16x32_bf16 v[80:83], a[208:211], v[136:139], v[80:83]
    ds_read_b128 v[156:159], v6 offset:5120
    v_cvt_pk_bf16_f32 v103, v78, v79
    v_mfma_f32_16x16x32_bf16 v[80:83], a[240:243], v[140:143], v[80:83]
    ds_write_b128 v3, v[100:103] offset:1024
    v_mfma_f32_16x16x32_bf16 v[68:71], a[80:83], v[32:35], -4.0
    v_exp_f32 v64, v64
    v_mfma_f32_16x16x32_bf16 v[68:71], a[84:87], v[36:39], v[68:71]
    v_exp_f32 v65, v65
    v_mfma_f32_16x16x32_bf16 v[68:71], a[88:91], v[40:43], v[68:71]
    buffer_load_dwordx4 v0, s[12:15], s71 offen offset:1024 nt lds
    v_mfma_f32_16x16x32_bf16 v[68:71], a[92:95], v[44:47], v[68:71]
    ds_read_b128 v[32:35], v1 offset:33280
    v_cvt_pk_bf16_f32 v104, v64, v65
    v_mfma_f32_16x16x32_bf16 v[84:87], a[148:151], v[112:115], v[84:87]
    v_exp_f32 v66, v66
    v_mfma_f32_16x16x32_bf16 v[84:87], a[180:183], v[132:135], v[84:87]
    ds_read_b128 v[36:39], v1 offset:33536
    ds_read_b128 v[40:43], v1 offset:33792
    v_mfma_f32_16x16x32_bf16 v[84:87], a[212:215], v[136:139], v[84:87]
    v_exp_f32 v67, v67
    v_mfma_f32_16x16x32_bf16 v[84:87], a[244:247], v[140:143], v[84:87]
    s_waitcnt lgkmcnt(7)
    ds_read_b128 v[44:47], v1 offset:34048
    v_cvt_pk_bf16_f32 v105, v66, v67
    v_mfma_f32_16x16x32_bf16 v[72:75], a[64:67], v[48:51], -4.0
    buffer_load_dwordx4 v0, s[12:15], s71 offen offset:2048 nt lds
    v_mfma_f32_16x16x32_bf16 v[72:75], a[68:71], v[52:55], v[72:75]
    v_exp_f32 v68, v68
    v_mfma_f32_16x16x32_bf16 v[72:75], a[72:75], v[56:59], v[72:75]
    v_exp_f32 v69, v69
    v_mfma_f32_16x16x32_bf16 v[72:75], a[76:79], v[60:63], v[72:75]
    s_waitcnt lgkmcnt(5)
    ds_read_b128 v[132:135], v4 offset:6144
    v_cvt_pk_bf16_f32 v106, v68, v69
    v_mfma_f32_16x16x32_bf16 v[88:91], a[144:147], v[116:119], v[88:91]
    v_exp_f32 v70, v70
    v_mfma_f32_16x16x32_bf16 v[88:91], a[176:179], v[148:151], v[88:91]
    buffer_load_dwordx4 v0, s[12:15], s71 offen offset:3072 nt lds
    v_mfma_f32_16x16x32_bf16 v[88:91], a[208:211], v[152:155], v[88:91]
    v_exp_f32 v71, v71
    v_mfma_f32_16x16x32_bf16 v[88:91], a[240:243], v[156:159], v[88:91]
    ds_read_b128 v[136:139], v5 offset:6144
    v_cvt_pk_bf16_f32 v107, v70, v71
    v_mfma_f32_16x16x32_bf16 v[20:23], v[24:27], v[96:99], 0
    ds_write_b128 v3, v[104:107] offset:2048
    v_mfma_f32_16x16x32_bf16 v[20:23], v[28:31], v[100:103], v[20:23]
    v_exp_f32 v72, v72
    v_mfma_f32_16x16x32_bf16 v[76:79], a[80:83], v[48:51], -4.0
    v_exp_f32 v73, v73
    v_mfma_f32_16x16x32_bf16 v[76:79], a[84:87], v[52:55], v[76:79]
    ds_read_b128 v[48:51], v1 offset:37440
    v_cvt_pk_bf16_f32 v108, v72, v73
    v_mfma_f32_16x16x32_bf16 v[76:79], a[88:91], v[56:59], v[76:79]
    v_exp_f32 v74, v74
    v_mfma_f32_16x16x32_bf16 v[76:79], a[92:95], v[60:63], v[76:79]
    v_exp_f32 v75, v75
    v_mfma_f32_16x16x32_bf16 v[92:95], a[148:151], v[116:119], v[92:95]
    ds_read_b128 v[52:55], v1 offset:37696
    v_cvt_pk_bf16_f32 v109, v74, v75
    v_mfma_f32_16x16x32_bf16 v[92:95], a[180:183], v[148:151], v[92:95]
    ds_read_b128 v[140:143], v6 offset:6144
    ds_read_b128 v[56:59], v1 offset:37952
    v_mfma_f32_16x16x32_bf16 v[92:95], a[212:215], v[152:155], v[92:95]
    s_waitcnt lgkmcnt(7)
    ds_read_b128 v[60:63], v1 offset:38208
    v_add_f32 v250, v250, v20
    v_mfma_f32_16x16x32_bf16 v[92:95], a[244:247], v[156:159], v[92:95]
    s_barrier
    v_exp_f32 v76, v76
    v_mfma_f32_16x16x32_bf16 v[64:67], a[64:67], v[32:35], -4.0
    v_exp_f32 v77, v77
    v_mfma_f32_16x16x32_bf16 v[64:67], a[68:71], v[36:39], v[64:67]
    ds_read_b128 v[148:151], v4 offset:7168
    v_cvt_pk_bf16_f32 v110, v76, v77
    v_mfma_f32_16x16x32_bf16 v[64:67], a[72:75], v[40:43], v[64:67]
    v_exp_f32 v78, v78
    v_mfma_f32_16x16x32_bf16 v[64:67], a[76:79], v[44:47], v[64:67]
    s_waitcnt lgkmcnt(3)
    v_exp_f32 v79, v79
    v_mfma_f32_16x16x32_bf16 v[176:179], a[144:147], v[120:123], v[176:179]
    s_add_u32 m0, s30, 41600
    ds_read_b128 v[152:155], v5 offset:7168
    v_cvt_pk_bf16_f32 v111, v78, v79
    v_mfma_f32_16x16x32_bf16 v[176:179], a[176:179], v[132:135], v[176:179]
    s_mov_b32 s46, 40960
    ds_write_b128 v3, v[108:111] offset:3072
    v_mfma_f32_16x16x32_bf16 v[176:179], a[208:211], v[136:139], v[176:179]
    v_exp_f32 v64, v64
    v_mfma_f32_16x16x32_bf16 v[176:179], a[240:243], v[140:143], v[176:179]
    v_exp_f32 v65, v65
    v_mfma_f32_16x16x32_bf16 v[68:71], a[80:83], v[32:35], -4.0
    buffer_load_dwordx4 v7, s[4:7], s46 offen offset:0 nt lds
    v_mfma_f32_16x16x32_bf16 v[68:71], a[84:87], v[36:39], v[68:71]
    ds_read_b128 v[32:35], v1 offset:0
    v_cvt_pk_bf16_f32 v112, v64, v65
    v_mfma_f32_16x16x32_bf16 v[68:71], a[88:91], v[40:43], v[68:71]
    v_exp_f32 v66, v66
    v_mfma_f32_16x16x32_bf16 v[68:71], a[92:95], v[44:47], v[68:71]
    ds_read_b128 v[36:39], v1 offset:256
    ds_read_b128 v[156:159], v6 offset:7168
    v_mfma_f32_16x16x32_bf16 v[180:183], a[148:151], v[120:123], v[180:183]
    ds_read_b128 v[40:43], v1 offset:512
    ds_read_b128 v[44:47], v1 offset:768
    v_mfma_f32_16x16x32_bf16 v[180:183], a[180:183], v[132:135], v[180:183]
    v_exp_f32 v67, v67
    v_mfma_f32_16x16x32_bf16 v[180:183], a[212:215], v[136:139], v[180:183]
    ds_read_b128 v[132:135], v4 offset:0
    v_cvt_pk_bf16_f32 v113, v66, v67
    v_mfma_f32_16x16x32_bf16 v[180:183], a[244:247], v[140:143], v[180:183]
    s_waitcnt lgkmcnt(9)
    v_exp_f32 v68, v68
    v_mfma_f32_16x16x32_bf16 v[72:75], a[64:67], v[48:51], -4.0
    v_exp_f32 v69, v69
    v_mfma_f32_16x16x32_bf16 v[72:75], a[68:71], v[52:55], v[72:75]
    ds_read_b128 v[136:139], v5 offset:0
    v_cvt_pk_bf16_f32 v114, v68, v69
    v_mfma_f32_16x16x32_bf16 v[72:75], a[72:75], v[56:59], v[72:75]
    v_exp_f32 v70, v70
    v_mfma_f32_16x16x32_bf16 v[72:75], a[76:79], v[60:63], v[72:75]
    s_waitcnt vmcnt(9) lgkmcnt(4)
    buffer_load_dwordx4 v7, s[4:7], s46 offen offset:1024 nt lds
    v_mfma_f32_16x16x32_bf16 v[184:187], a[144:147], v[124:127], v[184:187]
    v_exp_f32 v71, v71
    v_mfma_f32_16x16x32_bf16 v[184:187], a[176:179], v[148:151], v[184:187]
    ds_read_b128 a[96:99], v255 offset:0
    v_cvt_pk_bf16_f32 v115, v70, v71
    v_mfma_f32_16x16x32_bf16 v[184:187], a[208:211], v[152:155], v[184:187]
    ds_read_b128 a[100:103], v255 offset:256
    ds_read_b128 a[104:107], v255 offset:512
    v_mfma_f32_16x16x32_bf16 v[184:187], a[240:243], v[156:159], v[184:187]
    ds_write_b128 v3, v[112:115] offset:4096
    v_mfma_f32_16x16x32_bf16 v[20:23], v[24:27], v[104:107], 0
    v_exp_f32 v72, v72
    v_mfma_f32_16x16x32_bf16 v[20:23], v[28:31], v[108:111], v[20:23]
    ds_read_b128 a[108:111], v255 offset:768
    ds_read_b128 a[112:115], v255 offset:4160
    v_mfma_f32_16x16x32_bf16 v[76:79], a[80:83], v[48:51], -4.0
    v_exp_f32 v73, v73
    v_mfma_f32_16x16x32_bf16 v[76:79], a[84:87], v[52:55], v[76:79]
    ds_read_b128 a[116:119], v255 offset:4416
    v_cvt_pk_bf16_f32 v116, v72, v73
    v_mfma_f32_16x16x32_bf16 v[76:79], a[88:91], v[56:59], v[76:79]
    v_exp_f32 v74, v74
    v_mfma_f32_16x16x32_bf16 v[76:79], a[92:95], v[60:63], v[76:79]
    ds_read_b128 a[120:123], v255 offset:4672
    ds_read_b128 v[48:51], v1 offset:4160
    v_mfma_f32_16x16x32_bf16 v[188:191], a[148:151], v[124:127], v[188:191]
    ds_read_b128 a[124:127], v255 offset:4928
    ds_read_b128 v[52:55], v1 offset:4416
    v_mfma_f32_16x16x32_bf16 v[188:191], a[180:183], v[148:151], v[188:191]
    v_exp_f32 v75, v75
    v_mfma_f32_16x16x32_bf16 v[188:191], a[212:215], v[152:155], v[188:191]
    ds_read_b128 v[140:143], v6 offset:0
    v_cvt_pk_bf16_f32 v117, v74, v75
    v_mfma_f32_16x16x32_bf16 v[188:191], a[244:247], v[156:159], v[188:191]
    s_barrier
    ds_read_b128 v[56:59], v1 offset:4672
    v_add_f32 v251, v251, v20
    s_waitcnt lgkmcnt(12)
    v_mfma_f32_16x16x32_bf16 v[192:195], a[152:155], a[96:99], 0
    s_nop 1
    v_mfma_f32_16x16x32_bf16 v[192:195], a[184:187], a[96:99], v[192:195]
    s_nop 1
    v_mfma_f32_16x16x32_bf16 v[196:199], a[156:159], a[96:99], 0
    s_nop 1
    v_mfma_f32_16x16x32_bf16 v[196:199], a[188:191], a[96:99], v[196:199]
    s_nop 1
    s_waitcnt lgkmcnt(11)
    v_mfma_f32_16x16x32_bf16 v[16:19], a[152:155], a[100:103], 0
    v_cvt_pk_bf16_f32 v192, v192, v193
    v_cvt_pk_bf16_f32 v193, v194, v195
    v_mfma_f32_16x16x32_bf16 v[16:19], a[184:187], a[100:103], v[16:19]
    v_accvgpr_write_b32 a96, v192
    v_accvgpr_write_b32 a97, v193
    v_mfma_f32_16x16x32_bf16 v[192:195], a[156:159], a[100:103], 0
    v_cvt_pk_bf16_f32 v196, v196, v197
    v_cvt_pk_bf16_f32 v197, v198, v199
    v_mfma_f32_16x16x32_bf16 v[192:195], a[188:191], a[100:103], v[192:195]
    v_accvgpr_write_b32 a98, v196
    v_accvgpr_write_b32 a99, v197
    s_waitcnt lgkmcnt(10)
    v_mfma_f32_16x16x32_bf16 v[196:199], a[152:155], a[104:107], 0
    v_cvt_pk_bf16_f32 v16, v16, v17
    v_cvt_pk_bf16_f32 v17, v18, v19
    v_mfma_f32_16x16x32_bf16 v[196:199], a[184:187], a[104:107], v[196:199]
    v_accvgpr_write_b32 a100, v16
    v_accvgpr_write_b32 a101, v17
    v_mfma_f32_16x16x32_bf16 v[16:19], a[156:159], a[104:107], 0
    v_cvt_pk_bf16_f32 v192, v192, v193
    v_cvt_pk_bf16_f32 v193, v194, v195
    v_mfma_f32_16x16x32_bf16 v[16:19], a[188:191], a[104:107], v[16:19]
    v_accvgpr_write_b32 a102, v192
    v_accvgpr_write_b32 a103, v193
    s_waitcnt lgkmcnt(8)
    v_mfma_f32_16x16x32_bf16 v[192:195], a[152:155], a[108:111], 0
    v_cvt_pk_bf16_f32 v196, v196, v197
    v_cvt_pk_bf16_f32 v197, v198, v199
    v_mfma_f32_16x16x32_bf16 v[192:195], a[184:187], a[108:111], v[192:195]
    v_accvgpr_write_b32 a104, v196
    v_accvgpr_write_b32 a105, v197
    v_mfma_f32_16x16x32_bf16 v[196:199], a[156:159], a[108:111], 0
    v_cvt_pk_bf16_f32 v16, v16, v17
    v_cvt_pk_bf16_f32 v17, v18, v19
    v_mfma_f32_16x16x32_bf16 v[196:199], a[188:191], a[108:111], v[196:199]
    v_accvgpr_write_b32 a106, v16
    v_accvgpr_write_b32 a107, v17
    s_waitcnt lgkmcnt(7)
    v_mfma_f32_16x16x32_bf16 v[16:19], a[152:155], a[112:115], 0
    v_cvt_pk_bf16_f32 v192, v192, v193
    v_cvt_pk_bf16_f32 v193, v194, v195
    v_mfma_f32_16x16x32_bf16 v[16:19], a[184:187], a[112:115], v[16:19]
    v_accvgpr_write_b32 a108, v192
    v_accvgpr_write_b32 a109, v193
    v_mfma_f32_16x16x32_bf16 v[192:195], a[156:159], a[112:115], 0
    v_cvt_pk_bf16_f32 v196, v196, v197
    v_cvt_pk_bf16_f32 v197, v198, v199
    v_mfma_f32_16x16x32_bf16 v[192:195], a[188:191], a[112:115], v[192:195]
    v_accvgpr_write_b32 a110, v196
    v_accvgpr_write_b32 a111, v197
    s_waitcnt lgkmcnt(6)
    v_mfma_f32_16x16x32_bf16 v[196:199], a[152:155], a[116:119], 0
    v_cvt_pk_bf16_f32 v16, v16, v17
    v_cvt_pk_bf16_f32 v17, v18, v19
    v_mfma_f32_16x16x32_bf16 v[196:199], a[184:187], a[116:119], v[196:199]
    v_accvgpr_write_b32 a112, v16
    v_accvgpr_write_b32 a113, v17
    v_mfma_f32_16x16x32_bf16 v[16:19], a[156:159], a[116:119], 0
    v_cvt_pk_bf16_f32 v192, v192, v193
    v_cvt_pk_bf16_f32 v193, v194, v195
    v_mfma_f32_16x16x32_bf16 v[16:19], a[188:191], a[116:119], v[16:19]
    v_accvgpr_write_b32 a114, v192
    v_accvgpr_write_b32 a115, v193
    s_waitcnt lgkmcnt(5)
    v_mfma_f32_16x16x32_bf16 v[192:195], a[152:155], a[120:123], 0
    v_cvt_pk_bf16_f32 v196, v196, v197
    v_cvt_pk_bf16_f32 v197, v198, v199
    v_mfma_f32_16x16x32_bf16 v[192:195], a[184:187], a[120:123], v[192:195]
    v_accvgpr_write_b32 a116, v196
    v_accvgpr_write_b32 a117, v197
    v_mfma_f32_16x16x32_bf16 v[196:199], a[156:159], a[120:123], 0
    v_cvt_pk_bf16_f32 v16, v16, v17
    v_cvt_pk_bf16_f32 v17, v18, v19
    v_mfma_f32_16x16x32_bf16 v[196:199], a[188:191], a[120:123], v[196:199]
    v_accvgpr_write_b32 a118, v16
    v_accvgpr_write_b32 a119, v17
    s_waitcnt lgkmcnt(3)
    v_mfma_f32_16x16x32_bf16 v[16:19], a[152:155], a[124:127], 0
    v_cvt_pk_bf16_f32 v192, v192, v193
    v_cvt_pk_bf16_f32 v193, v194, v195
    v_mfma_f32_16x16x32_bf16 v[16:19], a[184:187], a[124:127], v[16:19]
    v_accvgpr_write_b32 a120, v192
    v_accvgpr_write_b32 a121, v193
    v_mfma_f32_16x16x32_bf16 v[192:195], a[156:159], a[124:127], 0
    v_cvt_pk_bf16_f32 v196, v196, v197
    v_cvt_pk_bf16_f32 v197, v198, v199
    v_mfma_f32_16x16x32_bf16 v[192:195], a[188:191], a[124:127], v[192:195]
    v_accvgpr_write_b32 a122, v196
    v_accvgpr_write_b32 a123, v197
    v_mfma_f32_16x16x32_bf16 v[64:67], a[96:99], v[32:35], -4.0
    ds_read_b128 v[60:63], v1 offset:4928
    v_cvt_pk_bf16_f32 v16, v16, v17
    v_cvt_pk_bf16_f32 v17, v18, v19
    v_accvgpr_write_b32 a124, v16
    v_accvgpr_write_b32 a125, v17
    v_cvt_pk_bf16_f32 v192, v192, v193
    v_cvt_pk_bf16_f32 v193, v194, v195
    v_accvgpr_write_b32 a126, v192
    v_accvgpr_write_b32 a127, v193
    v_mfma_f32_16x16x32_bf16 v[64:67], a[100:103], v[36:39], v[64:67]
    v_exp_f32 v76, v76
    v_mfma_f32_16x16x32_bf16 v[64:67], a[104:107], v[40:43], v[64:67]
    v_exp_f32 v77, v77
    v_mfma_f32_16x16x32_bf16 v[64:67], a[108:111], v[44:47], v[64:67]
    s_waitcnt lgkmcnt(2)
    ds_read_b128 v[148:151], v4 offset:1024
    v_cvt_pk_bf16_f32 v118, v76, v77
    v_mfma_f32_16x16x32_bf16 v[200:203], a[144:147], v[96:99], v[200:203]
    s_add_u32 m0, s30, 49920
    v_exp_f32 v78, v78
    v_mfma_f32_16x16x32_bf16 v[200:203], a[176:179], v[132:135], v[200:203]
    s_mov_b32 s46, 49152
    v_exp_f32 v79, v79
    v_mfma_f32_16x16x32_bf16 v[200:203], a[208:211], v[136:139], v[200:203]
    ds_read_b128 v[152:155], v5 offset:1024
    v_cvt_pk_bf16_f32 v119, v78, v79
    v_mfma_f32_16x16x32_bf16 v[200:203], a[240:243], v[140:143], v[200:203]
    ds_write_b128 v3, v[116:119] offset:5120
    v_mfma_f32_16x16x32_bf16 v[68:71], a[112:115], v[32:35], -4.0
    v_exp_f32 v64, v64
    v_mfma_f32_16x16x32_bf16 v[68:71], a[116:119], v[36:39], v[68:71]
    v_exp_f32 v65, v65
    v_mfma_f32_16x16x32_bf16 v[68:71], a[120:123], v[40:43], v[68:71]
    buffer_load_dwordx4 v7, s[4:7], s46 offen offset:0 nt lds
    v_mfma_f32_16x16x32_bf16 v[68:71], a[124:127], v[44:47], v[68:71]
    ds_read_b128 v[32:35], v1 offset:8320
    v_cvt_pk_bf16_f32 v120, v64, v65
    v_mfma_f32_16x16x32_bf16 v[204:207], a[148:151], v[96:99], v[204:207]
    v_exp_f32 v66, v66
    v_mfma_f32_16x16x32_bf16 v[204:207], a[180:183], v[132:135], v[204:207]
    ds_read_b128 v[36:39], v1 offset:8576
    ds_read_b128 v[156:159], v6 offset:1024
    v_mfma_f32_16x16x32_bf16 v[204:207], a[212:215], v[136:139], v[204:207]
    ds_read_b128 v[40:43], v1 offset:8832
    ds_read_b128 v[44:47], v1 offset:9088
    v_mfma_f32_16x16x32_bf16 v[204:207], a[244:247], v[140:143], v[204:207]
    s_waitcnt lgkmcnt(8)
    v_exp_f32 v67, v67
    v_mfma_f32_16x16x32_bf16 v[72:75], a[96:99], v[48:51], -4.0
    ds_read_b128 v[132:135], v4 offset:2048
    v_cvt_pk_bf16_f32 v121, v66, v67
    v_mfma_f32_16x16x32_bf16 v[72:75], a[100:103], v[52:55], v[72:75]
    v_exp_f32 v68, v68
    v_mfma_f32_16x16x32_bf16 v[72:75], a[104:107], v[56:59], v[72:75]
    v_exp_f32 v69, v69
    v_mfma_f32_16x16x32_bf16 v[72:75], a[108:111], v[60:63], v[72:75]
    s_waitcnt lgkmcnt(3)
    ds_read_b128 v[136:139], v5 offset:2048
    v_cvt_pk_bf16_f32 v122, v68, v69
    v_mfma_f32_16x16x32_bf16 v[208:211], a[144:147], v[100:103], v[208:211]
    v_exp_f32 v70, v70
    v_mfma_f32_16x16x32_bf16 v[208:211], a[176:179], v[148:151], v[208:211]
    buffer_load_dwordx4 v7, s[4:7], s46 offen offset:1024 nt lds
    v_mfma_f32_16x16x32_bf16 v[208:211], a[208:211], v[152:155], v[208:211]
    v_exp_f32 v71, v71
    v_mfma_f32_16x16x32_bf16 v[208:211], a[240:243], v[156:159], v[208:211]
    ds_read_b128 v[140:143], v6 offset:2048
    v_cvt_pk_bf16_f32 v123, v70, v71
    v_mfma_f32_16x16x32_bf16 v[20:23], v[24:27], v[112:115], 0
    ds_write_b128 v3, v[120:123] offset:6144
    v_mfma_f32_16x16x32_bf16 v[20:23], v[28:31], v[116:119], v[20:23]
    v_exp_f32 v72, v72
    v_mfma_f32_16x16x32_bf16 v[76:79], a[112:115], v[48:51], -4.0
    v_exp_f32 v73, v73
    v_mfma_f32_16x16x32_bf16 v[76:79], a[116:119], v[52:55], v[76:79]
    ds_read_b128 v[48:51], v1 offset:12480
    v_cvt_pk_bf16_f32 v124, v72, v73
    v_mfma_f32_16x16x32_bf16 v[76:79], a[120:123], v[56:59], v[76:79]
    v_exp_f32 v74, v74
    v_mfma_f32_16x16x32_bf16 v[76:79], a[124:127], v[60:63], v[76:79]
    v_exp_f32 v75, v75
    v_mfma_f32_16x16x32_bf16 v[212:215], a[148:151], v[100:103], v[212:215]
    ds_read_b128 v[52:55], v1 offset:12736
    v_cvt_pk_bf16_f32 v125, v74, v75
    v_mfma_f32_16x16x32_bf16 v[212:215], a[180:183], v[148:151], v[212:215]
    ds_read_b128 v[56:59], v1 offset:12992
    v_add_f32 v252, v252, v20
    v_mfma_f32_16x16x32_bf16 v[212:215], a[212:215], v[152:155], v[212:215]
    s_waitcnt lgkmcnt(7)
    ds_read_b128 v[60:63], v1 offset:13248
    ds_read_b128 v[148:151], v4 offset:3072
    v_mfma_f32_16x16x32_bf16 v[212:215], a[244:247], v[156:159], v[212:215]
    s_barrier
    v_exp_f32 v76, v76
    v_mfma_f32_16x16x32_bf16 v[64:67], a[96:99], v[32:35], -4.0
    v_exp_f32 v77, v77
    v_mfma_f32_16x16x32_bf16 v[64:67], a[100:103], v[36:39], v[64:67]
    v_add_u32 v192, s50, v15
    v_cvt_pk_bf16_f32 v126, v76, v77
    v_mfma_f32_16x16x32_bf16 v[64:67], a[104:107], v[40:43], v[64:67]
    v_add_u32 v193, s51, v15
    v_add_u32 v194, s52, v15
    v_mfma_f32_16x16x32_bf16 v[64:67], a[108:111], v[44:47], v[64:67]
    s_waitcnt lgkmcnt(6)
    v_exp_f32 v78, v78
    v_mfma_f32_16x16x32_bf16 v[216:219], a[144:147], v[104:107], v[216:219]
    s_add_u32 m0, s30, 0
    ds_read_b128 v[152:155], v5 offset:3072
    v_add_u32 v195, s53, v15
    v_mfma_f32_16x16x32_bf16 v[216:219], a[176:179], v[132:135], v[216:219]
    s_mov_b32 s46, 57344
    v_exp_f32 v79, v79
    v_mfma_f32_16x16x32_bf16 v[216:219], a[208:211], v[136:139], v[216:219]
    ds_read_b128 v[156:159], v6 offset:3072
    v_cvt_pk_bf16_f32 v127, v78, v79
    v_mfma_f32_16x16x32_bf16 v[216:219], a[240:243], v[140:143], v[216:219]
    ds_write_b128 v3, v[124:127] offset:7168
    v_mfma_f32_16x16x32_bf16 v[68:71], a[112:115], v[32:35], -4.0
    v_exp_f32 v64, v64
    v_mfma_f32_16x16x32_bf16 v[68:71], a[116:119], v[36:39], v[68:71]
    v_exp_f32 v65, v65
    v_mfma_f32_16x16x32_bf16 v[68:71], a[120:123], v[40:43], v[68:71]
    buffer_load_dwordx4 v7, s[4:7], s46 offen offset:0 nt lds
    v_mfma_f32_16x16x32_bf16 v[68:71], a[124:127], v[44:47], v[68:71]
    ds_read_b128 v[32:35], v1 offset:16640
    v_cvt_pk_bf16_f32 v96, v64, v65
    v_mfma_f32_16x16x32_bf16 v[220:223], a[148:151], v[104:107], v[220:223]
    v_exp_f32 v66, v66
    v_mfma_f32_16x16x32_bf16 v[220:223], a[180:183], v[132:135], v[220:223]
    ds_read_b128 v[36:39], v1 offset:16896
    ds_read_b128 v[40:43], v1 offset:17152
    v_mfma_f32_16x16x32_bf16 v[220:223], a[212:215], v[136:139], v[220:223]
    v_exp_f32 v67, v67
    v_mfma_f32_16x16x32_bf16 v[220:223], a[244:247], v[140:143], v[220:223]
    s_waitcnt lgkmcnt(7)
    ds_read_b128 v[44:47], v1 offset:17408
    v_cvt_pk_bf16_f32 v97, v66, v67
    v_mfma_f32_16x16x32_bf16 v[72:75], a[96:99], v[48:51], -4.0
    v_exp_f32 v68, v68
    v_mfma_f32_16x16x32_bf16 v[72:75], a[100:103], v[52:55], v[72:75]
    v_exp_f32 v69, v69
    v_mfma_f32_16x16x32_bf16 v[72:75], a[104:107], v[56:59], v[72:75]
    ds_read_b128 v[132:135], v4 offset:4096
    v_cvt_pk_bf16_f32 v98, v68, v69
    v_mfma_f32_16x16x32_bf16 v[72:75], a[108:111], v[60:63], v[72:75]
    s_waitcnt lgkmcnt(6)
    v_exp_f32 v70, v70
    v_mfma_f32_16x16x32_bf16 v[224:227], a[144:147], v[108:111], v[224:227]
    buffer_load_dwordx4 v7, s[4:7], s46 offen offset:1024 nt lds
    v_mfma_f32_16x16x32_bf16 v[224:227], a[176:179], v[148:151], v[224:227]
    v_exp_f32 v71, v71
    v_mfma_f32_16x16x32_bf16 v[224:227], a[208:211], v[152:155], v[224:227]
    ds_read_b128 v[136:139], v5 offset:4096
    v_cvt_pk_bf16_f32 v99, v70, v71
    v_mfma_f32_16x16x32_bf16 v[224:227], a[240:243], v[156:159], v[224:227]
    ds_write_b128 v3, v[96:99] offset:0
    v_mfma_f32_16x16x32_bf16 v[20:23], v[24:27], v[120:123], 0
    v_exp_f32 v72, v72
    v_mfma_f32_16x16x32_bf16 v[20:23], v[28:31], v[124:127], v[20:23]
    v_exp_f32 v73, v73
    v_mfma_f32_16x16x32_bf16 v[76:79], a[112:115], v[48:51], -4.0
    ds_read_b128 v[48:51], v1 offset:20800
    v_cvt_pk_bf16_f32 v100, v72, v73
    v_mfma_f32_16x16x32_bf16 v[76:79], a[116:119], v[52:55], v[76:79]
    v_exp_f32 v74, v74
    v_mfma_f32_16x16x32_bf16 v[76:79], a[120:123], v[56:59], v[76:79]
    v_exp_f32 v75, v75
    v_mfma_f32_16x16x32_bf16 v[76:79], a[124:127], v[60:63], v[76:79]
    ds_read_b128 v[52:55], v1 offset:21056
    v_cvt_pk_bf16_f32 v101, v74, v75
    v_mfma_f32_16x16x32_bf16 v[228:231], a[148:151], v[108:111], v[228:231]
    ds_read_b128 v[140:143], v6 offset:4096
    ds_read_b128 v[56:59], v1 offset:21312
    v_mfma_f32_16x16x32_bf16 v[228:231], a[180:183], v[148:151], v[228:231]
    ds_read_b128 v[60:63], v1 offset:21568
    v_add_f32 v248, v248, v20
    v_mfma_f32_16x16x32_bf16 v[228:231], a[212:215], v[152:155], v[228:231]
    s_waitcnt lgkmcnt(10)
    v_exp_f32 v76, v76
    v_mfma_f32_16x16x32_bf16 v[228:231], a[244:247], v[156:159], v[228:231]
    ds_write_b32 v9, v248 offset:1024
    v_mfma_f32_16x16x32_bf16 v[64:67], a[96:99], v[32:35], -4.0
    v_exp_f32 v77, v77
    v_mfma_f32_16x16x32_bf16 v[64:67], a[100:103], v[36:39], v[64:67]
    s_waitcnt vmcnt(6) lgkmcnt(0)
    s_barrier
    ds_read_b64_tr_b16 a[152:153], v192 offset:16640
    v_cvt_pk_bf16_f32 v102, v76, v77
    v_mfma_f32_16x16x32_bf16 v[64:67], a[104:107], v[40:43], v[64:67]
    ds_read_b64_tr_b16 a[154:155], v192 offset:33024
    ds_read_b64_tr_b16 a[156:157], v192 offset:16648
    v_mfma_f32_16x16x32_bf16 v[64:67], a[108:111], v[44:47], v[64:67]
    v_exp_f32 v78, v78
    v_mfma_f32_16x16x32_bf16 v[160:163], a[144:147], v[112:115], v[160:163]
    s_add_u32 m0, s30, 8320
    ds_read_b64_tr_b16 a[158:159], v192 offset:33032
    ds_read_b64_tr_b16 a[184:185], v193 offset:16640
    v_mfma_f32_16x16x32_bf16 v[160:163], a[176:179], v[132:135], v[160:163]
    s_mov_b32 s46, 65536
    v_exp_f32 v79, v79
    v_mfma_f32_16x16x32_bf16 v[160:163], a[208:211], v[136:139], v[160:163]
    ds_read_b64_tr_b16 a[186:187], v193 offset:33024
    v_cvt_pk_bf16_f32 v103, v78, v79
    v_mfma_f32_16x16x32_bf16 v[160:163], a[240:243], v[140:143], v[160:163]
    ds_write_b128 v3, v[100:103] offset:1024
    v_mfma_f32_16x16x32_bf16 v[68:71], a[112:115], v[32:35], -4.0
    v_exp_f32 v64, v64
    v_mfma_f32_16x16x32_bf16 v[68:71], a[116:119], v[36:39], v[68:71]
    ds_read_b64_tr_b16 a[188:189], v193 offset:16648
    ds_read_b64_tr_b16 a[190:191], v193 offset:33032
    v_mfma_f32_16x16x32_bf16 v[68:71], a[120:123], v[40:43], v[68:71]
    v_exp_f32 v65, v65
    v_mfma_f32_16x16x32_bf16 v[68:71], a[124:127], v[44:47], v[68:71]
    ds_read_b64_tr_b16 a[216:217], v194 offset:16640
    v_cvt_pk_bf16_f32 v104, v64, v65
    v_mfma_f32_16x16x32_bf16 v[164:167], a[148:151], v[112:115], v[164:167]
    buffer_load_dwordx4 v7, s[4:7], s46 offen offset:0 nt lds
    v_mfma_f32_16x16x32_bf16 v[164:167], a[180:183], v[132:135], v[164:167]
    ds_read_b128 v[148:151], v4 offset:5120
    ds_read_b128 v[32:35], v1 offset:24960
    ds_read_b64_tr_b16 a[218:219], v194 offset:33024
    v_mfma_f32_16x16x32_bf16 v[164:167], a[212:215], v[136:139], v[164:167]
    ds_read_b128 v[152:155], v5 offset:5120
    ds_read_b128 v[36:39], v1 offset:25216
    ds_read_b64_tr_b16 a[220:221], v194 offset:16648
    v_exp_f32 v66, v66
    v_mfma_f32_16x16x32_bf16 v[164:167], a[244:247], v[140:143], v[164:167]
    ds_read_b128 v[156:159], v6 offset:5120
    ds_read_b128 v[40:43], v1 offset:25472
    ds_read_b64_tr_b16 a[222:223], v194 offset:33032
    v_mfma_f32_16x16x32_bf16 v[72:75], a[96:99], v[48:51], -4.0
    ds_read_b128 v[44:47], v1 offset:25728
    ds_read_b64_tr_b16 a[248:249], v195 offset:16640
    v_exp_f32 v67, v67
    v_mfma_f32_16x16x32_bf16 v[72:75], a[100:103], v[52:55], v[72:75]
    ds_read_b64_tr_b16 a[250:251], v195 offset:33024
    v_cvt_pk_bf16_f32 v105, v66, v67
    v_mfma_f32_16x16x32_bf16 v[72:75], a[104:107], v[56:59], v[72:75]
    ds_read_b64_tr_b16 a[252:253], v195 offset:16648
    v_exp_f32 v68, v68
    v_mfma_f32_16x16x32_bf16 v[72:75], a[108:111], v[60:63], v[72:75]
    s_waitcnt lgkmcnt(6)
    ds_read_b64_tr_b16 a[254:255], v195 offset:33032
    ds_read_b128 v[132:135], v4 offset:6144
    v_mfma_f32_16x16x32_bf16 v[168:171], a[144:147], v[116:119], v[168:171]
    v_exp_f32 v69, v69
    v_mfma_f32_16x16x32_bf16 v[168:171], a[176:179], v[148:151], v[168:171]
    ds_read_b128 v[136:139], v5 offset:6144
    v_cvt_pk_bf16_f32 v106, v68, v69
    v_mfma_f32_16x16x32_bf16 v[168:171], a[208:211], v[152:155], v[168:171]
    v_exp_f32 v70, v70
    v_mfma_f32_16x16x32_bf16 v[168:171], a[240:243], v[156:159], v[168:171]
    buffer_load_dwordx4 v7, s[4:7], s46 offen offset:1024 nt lds
    v_mfma_f32_16x16x32_bf16 v[20:23], v[24:27], v[96:99], 0
    v_exp_f32 v71, v71
    v_mfma_f32_16x16x32_bf16 v[20:23], v[28:31], v[100:103], v[20:23]
    ds_read_b128 v[140:143], v6 offset:6144
    v_cvt_pk_bf16_f32 v107, v70, v71
    v_mfma_f32_16x16x32_bf16 v[76:79], a[112:115], v[48:51], -4.0
    ds_write_b128 v3, v[104:107] offset:2048
    v_exp_f32 v72, v72
    v_mfma_f32_16x16x32_bf16 v[76:79], a[116:119], v[52:55], v[76:79]
    v_exp_f32 v73, v73
    v_mfma_f32_16x16x32_bf16 v[76:79], a[120:123], v[56:59], v[76:79]
    ds_read_b128 v[48:51], v1 offset:29120
    v_cvt_pk_bf16_f32 v108, v72, v73
    v_mfma_f32_16x16x32_bf16 v[76:79], a[124:127], v[60:63], v[76:79]
    v_exp_f32 v74, v74
    v_mfma_f32_16x16x32_bf16 v[172:175], a[148:151], v[116:119], v[172:175]
    v_exp_f32 v75, v75
    v_mfma_f32_16x16x32_bf16 v[172:175], a[180:183], v[148:151], v[172:175]
    ds_read_b128 v[52:55], v1 offset:29376
    v_cvt_pk_bf16_f32 v109, v74, v75
    v_mfma_f32_16x16x32_bf16 v[172:175], a[212:215], v[152:155], v[172:175]
    s_waitcnt lgkmcnt(10)
    ds_read_b128 v[56:59], v1 offset:29632
    v_add_f32 v249, v249, v20
    v_mfma_f32_16x16x32_bf16 v[172:175], a[244:247], v[156:159], v[172:175]
    ds_read_b128 v[60:63], v1 offset:29888
    ds_read_b128 v[16:19], v10 offset:1024
    v_mfma_f32_16x16x32_bf16 v[64:67], a[96:99], v[32:35], -4.0
    v_exp_f32 v76, v76
    v_mfma_f32_16x16x32_bf16 v[64:67], a[100:103], v[36:39], v[64:67]
    ds_write_b32 v9, v249 offset:1536
    v_mfma_f32_16x16x32_bf16 v[64:67], a[104:107], v[40:43], v[64:67]
    v_exp_f32 v77, v77
    v_mfma_f32_16x16x32_bf16 v[64:67], a[108:111], v[44:47], v[64:67]
    s_waitcnt lgkmcnt(0)
    ds_read_b128 v[148:151], v4 offset:7168
    v_cvt_pk_bf16_f32 v110, v76, v77
    v_mfma_f32_16x16x32_bf16 v[80:83], a[152:155], v[120:123], v[80:83]
    s_barrier
L_merged:
    v_exp_f32 v78, v78
    v_mfma_f32_16x16x32_bf16 v[80:83], a[184:187], v[132:135], v[80:83]
    v_exp_f32 v79, v79
    v_mfma_f32_16x16x32_bf16 v[80:83], a[216:219], v[136:139], v[80:83]
    ds_read_b128 v[152:155], v5 offset:7168
    v_cvt_pk_bf16_f32 v111, v78, v79
    v_mfma_f32_16x16x32_bf16 v[80:83], a[248:251], v[140:143], v[80:83]
    ds_write_b128 v3, v[108:111] offset:3072
    v_mfma_f32_16x16x32_bf16 v[68:71], a[112:115], v[32:35], -4.0
    v_exp_f32 v64, v64
    v_mfma_f32_16x16x32_bf16 v[68:71], a[116:119], v[36:39], v[68:71]
    v_exp_f32 v65, v65
    v_mfma_f32_16x16x32_bf16 v[68:71], a[120:123], v[40:43], v[68:71]
    ds_read_b128 v[32:35], v1 offset:33280
    v_cvt_pk_bf16_f32 v112, v64, v65
    v_mfma_f32_16x16x32_bf16 v[68:71], a[124:127], v[44:47], v[68:71]
    v_exp_f32 v66, v66
    v_mfma_f32_16x16x32_bf16 v[84:87], a[156:159], v[120:123], v[84:87]
    ds_read_b128 v[36:39], v1 offset:33536
    ds_read_b128 v[156:159], v6 offset:7168
    v_mfma_f32_16x16x32_bf16 v[84:87], a[188:191], v[132:135], v[84:87]
    ds_read_b128 v[40:43], v1 offset:33792
    ds_read_b128 v[44:47], v1 offset:34048
    v_mfma_f32_16x16x32_bf16 v[84:87], a[220:223], v[136:139], v[84:87]
    v_exp_f32 v67, v67
    v_mfma_f32_16x16x32_bf16 v[84:87], a[252:255], v[140:143], v[84:87]
    v_cvt_pk_bf16_f32 v113, v66, v67
    v_add_f32 v16, v16, v17
    v_mfma_f32_16x16x32_bf16 v[72:75], a[96:99], v[48:51], -4.0
    ds_read_b128 v[132:135], v4 offset:0
    v_add_f32 v18, v18, v19
    v_mfma_f32_16x16x32_bf16 v[72:75], a[100:103], v[52:55], v[72:75]
    v_exp_f32 v68, v68
    v_mfma_f32_16x16x32_bf16 v[72:75], a[104:107], v[56:59], v[72:75]
    ds_read_b128 v[136:139], v5 offset:0
    v_add_f32 v16, v16, v18
    v_rcp_f32 v13, v16
    v_mfma_f32_16x16x32_bf16 v[72:75], a[108:111], v[60:63], v[72:75]
    s_waitcnt lgkmcnt(4)
    v_mov_b32 v14, v13
    v_max_u32 v12, v12, v13
    v_mfma_f32_16x16x32_bf16 v[88:91], a[152:155], v[124:127], v[88:91]
    v_permlane32_swap_b32 v13, v14
    v_exp_f32 v69, v69
    v_mfma_f32_16x16x32_bf16 v[88:91], a[184:187], v[148:151], v[88:91]
    v_cvt_pk_bf16_f32 v114, v68, v69
    v_mul_f32 v80, v80, v13
    v_mfma_f32_16x16x32_bf16 v[88:91], a[216:219], v[152:155], v[88:91]
    v_exp_f32 v70, v70
    v_mfma_f32_16x16x32_bf16 v[88:91], a[248:251], v[156:159], v[88:91]
    v_exp_f32 v71, v71
    v_mfma_f32_16x16x32_bf16 v[20:23], v[24:27], v[104:107], 0
    v_cvt_pk_bf16_f32 v115, v70, v71
    v_mul_f32 v81, v81, v13
    v_mfma_f32_16x16x32_bf16 v[20:23], v[28:31], v[108:111], v[20:23]
    ds_write_b128 v3, v[112:115] offset:4096
    v_mfma_f32_16x16x32_bf16 v[76:79], a[112:115], v[48:51], -4.0
    v_exp_f32 v72, v72
    v_cvt_pk_bf16_f32 v192, v80, v81
    v_mfma_f32_16x16x32_bf16 v[76:79], a[116:119], v[52:55], v[76:79]
    v_max_u32 v11, v11, v16
    v_mul_f32 v82, v82, v13
    v_mfma_f32_16x16x32_bf16 v[76:79], a[120:123], v[56:59], v[76:79]
    v_exp_f32 v73, v73
    v_mfma_f32_16x16x32_bf16 v[76:79], a[124:127], v[60:63], v[76:79]
    v_cvt_pk_bf16_f32 v116, v72, v73
    v_mul_f32 v83, v83, v13
    v_mfma_f32_16x16x32_bf16 v[92:95], a[156:159], v[124:127], v[92:95]
    v_exp_f32 v74, v74
    v_cvt_pk_bf16_f32 v193, v82, v83
    v_mfma_f32_16x16x32_bf16 v[92:95], a[188:191], v[148:151], v[92:95]
    ds_read_b128 v[48:51], v1 offset:37440
    v_mul_f32 v84, v84, v13
    v_mfma_f32_16x16x32_bf16 v[92:95], a[220:223], v[152:155], v[92:95]
    s_waitcnt lgkmcnt(4)
    ds_read_b128 v[52:55], v1 offset:37696
    v_exp_f32 v75, v75
    v_mfma_f32_16x16x32_bf16 v[92:95], a[252:255], v[156:159], v[92:95]
    ds_read_b128 v[140:143], v6 offset:0
    ds_read_b128 v[56:59], v1 offset:37952
    v_cvt_pk_bf16_f32 v117, v74, v75
    v_mul_f32 v85, v85, v13
    v_mfma_f32_16x16x32_bf16 v[64:67], a[96:99], v[32:35], -4.0
    ds_read_b128 v[60:63], v1 offset:38208
    v_add_f32 v250, v250, v20
    v_cvt_pk_bf16_f32 v194, v84, v85
    v_mfma_f32_16x16x32_bf16 v[64:67], a[100:103], v[36:39], v[64:67]
    v_mul_f32 v86, v86, v13
    v_mul_f32 v87, v87, v13
    v_mfma_f32_16x16x32_bf16 v[64:67], a[104:107], v[40:43], v[64:67]
    ds_write_b32 v9, v250 offset:2048
    v_exp_f32 v76, v76
    v_mfma_f32_16x16x32_bf16 v[64:67], a[108:111], v[44:47], v[64:67]
    s_waitcnt vmcnt(6) lgkmcnt(0)
    v_exp_f32 v77, v77
    v_mfma_f32_16x16x32_bf16 v[176:179], a[152:155], v[96:99], v[176:179]
    s_barrier
    v_cvt_pk_bf16_f32 v195, v86, v87
    v_cvt_pk_bf16_f32 v118, v76, v77
    v_mfma_f32_16x16x32_bf16 v[176:179], a[184:187], v[132:135], v[176:179]
    v_mul_f32 v88, v88, v14
    v_mul_f32 v89, v89, v14
    v_mfma_f32_16x16x32_bf16 v[176:179], a[216:219], v[136:139], v[176:179]
    v_exp_f32 v78, v78
    v_mfma_f32_16x16x32_bf16 v[176:179], a[248:251], v[140:143], v[176:179]
    buffer_store_dwordx4 v[192:195], v8, s[16:19], s25 offen sc0 sc1
    v_mfma_f32_16x16x32_bf16 v[68:71], a[112:115], v[32:35], -4.0
    s_add_u32 s25, s25, 8192
    v_exp_f32 v79, v79
    v_cvt_pk_bf16_f32 v196, v88, v89
    v_mfma_f32_16x16x32_bf16 v[68:71], a[116:119], v[36:39], v[68:71]
    v_cvt_pk_bf16_f32 v119, v78, v79
    v_mul_f32 v90, v90, v14
    v_mfma_f32_16x16x32_bf16 v[68:71], a[120:123], v[40:43], v[68:71]
    ds_write_b128 v3, v[116:119] offset:5120
    v_exp_f32 v64, v64
    v_mul_f32 v91, v91, v14
    v_mfma_f32_16x16x32_bf16 v[68:71], a[124:127], v[44:47], v[68:71]
    v_exp_f32 v65, v65
    v_mfma_f32_16x16x32_bf16 v[180:183], a[156:159], v[96:99], v[180:183]
    v_cvt_pk_bf16_f32 v197, v90, v91
    v_cvt_pk_bf16_f32 v120, v64, v65
    v_mfma_f32_16x16x32_bf16 v[180:183], a[188:191], v[132:135], v[180:183]
    ds_read_b128 v[148:151], v4 offset:1024
    ds_read_b128 v[32:35], v1 offset:41600
    v_mul_f32 v92, v92, v14
    v_mfma_f32_16x16x32_bf16 v[180:183], a[220:223], v[136:139], v[180:183]
    ds_read_b128 v[152:155], v5 offset:1024
    ds_read_b128 v[36:39], v1 offset:41856
    v_exp_f32 v66, v66
    v_mul_f32 v93, v93, v14
    v_mfma_f32_16x16x32_bf16 v[180:183], a[252:255], v[140:143], v[180:183]
    ds_read_b128 v[156:159], v6 offset:1024
    ds_read_b128 v[40:43], v1 offset:42112
    v_cvt_pk_bf16_f32 v198, v92, v93
    v_mfma_f32_16x16x32_bf16 v[72:75], a[96:99], v[48:51], -4.0
    ds_read_b128 v[44:47], v1 offset:42368
    v_exp_f32 v67, v67
    v_mfma_f32_16x16x32_bf16 v[72:75], a[100:103], v[52:55], v[72:75]
    v_cvt_pk_bf16_f32 v121, v66, v67
    v_mul_f32 v94, v94, v14
    v_mfma_f32_16x16x32_bf16 v[72:75], a[104:107], v[56:59], v[72:75]
    v_exp_f32 v68, v68
    v_mul_f32 v95, v95, v14
    v_mfma_f32_16x16x32_bf16 v[72:75], a[108:111], v[60:63], v[72:75]
    s_waitcnt lgkmcnt(2)
    ds_read_b128 v[16:19], v10 offset:1536
    v_cvt_pk_bf16_f32 v199, v94, v95
    v_mfma_f32_16x16x32_bf16 v[184:187], a[152:155], v[100:103], v[184:187]
    v_exp_f32 v69, v69
    v_mfma_f32_16x16x32_bf16 v[184:187], a[184:187], v[148:151], v[184:187]
    ds_read_b128 v[132:135], v4 offset:2048
    v_cvt_pk_bf16_f32 v122, v68, v69
    v_mfma_f32_16x16x32_bf16 v[184:187], a[216:219], v[152:155], v[184:187]
    buffer_store_dwordx4 v[196:199], v8, s[16:19], s26 offen sc0 sc1
    v_exp_f32 v70, v70
    v_mfma_f32_16x16x32_bf16 v[184:187], a[248:251], v[156:159], v[184:187]
    s_add_u32 s26, s26, 8192
    ds_read_b128 v[136:139], v5 offset:2048
    v_mfma_f32_16x16x32_bf16 v[20:23], v[24:27], v[112:115], 0
    v_exp_f32 v71, v71
    v_mfma_f32_16x16x32_bf16 v[20:23], v[28:31], v[116:119], v[20:23]
    s_waitcnt lgkmcnt(2)
    v_cvt_pk_bf16_f32 v123, v70, v71
    v_add_f32 v16, v16, v17
    v_mfma_f32_16x16x32_bf16 v[76:79], a[112:115], v[48:51], -4.0
    ds_write_b128 v3, v[120:123] offset:6144
    v_exp_f32 v72, v72
    v_mfma_f32_16x16x32_bf16 v[76:79], a[116:119], v[52:55], v[76:79]
    v_exp_f32 v73, v73
    v_mfma_f32_16x16x32_bf16 v[76:79], a[120:123], v[56:59], v[76:79]
    ds_read_b128 v[48:51], v1 offset:45760
    v_cvt_pk_bf16_f32 v124, v72, v73
    v_mfma_f32_16x16x32_bf16 v[76:79], a[124:127], v[60:63], v[76:79]
    v_exp_f32 v74, v74
    v_mfma_f32_16x16x32_bf16 v[188:191], a[156:159], v[100:103], v[188:191]
    v_exp_f32 v75, v75
    v_mfma_f32_16x16x32_bf16 v[188:191], a[188:191], v[148:151], v[188:191]
    ds_read_b128 v[52:55], v1 offset:46016
    v_cvt_pk_bf16_f32 v125, v74, v75
    v_mfma_f32_16x16x32_bf16 v[188:191], a[220:223], v[152:155], v[188:191]
    ds_read_b128 v[56:59], v1 offset:46272
    v_add_f32 v251, v251, v20
    v_mfma_f32_16x16x32_bf16 v[188:191], a[252:255], v[156:159], v[188:191]
    ds_read_b128 v[60:63], v1 offset:46528
    v_add_f32 v18, v18, v19
    v_mfma_f32_16x16x32_bf16 v[88:91], a[0:3], v[32:35], -4.0
    v_exp_f32 v76, v76
    v_mfma_f32_16x16x32_bf16 v[88:91], a[4:7], v[36:39], v[88:91]
    ds_write_b32 v9, v251 offset:2560
    v_mfma_f32_16x16x32_bf16 v[88:91], a[8:11], v[40:43], v[88:91]
    ds_read_b128 v[140:143], v6 offset:2048
    v_add_f32 v16, v16, v18
    v_mfma_f32_16x16x32_bf16 v[88:91], a[12:15], v[44:47], v[88:91]
    v_rcp_f32 v13, v16
    v_mfma_f32_16x16x32_bf16 v[92:95], a[16:19], v[32:35], -4.0
    v_exp_f32 v77, v77
    v_mov_b32 v14, v13
    v_max_u32 v12, v12, v13
    v_mfma_f32_16x16x32_bf16 v[92:95], a[20:23], v[36:39], v[92:95]
    v_permlane32_swap_b32 v13, v14
    v_cvt_pk_bf16_f32 v126, v76, v77
    v_mfma_f32_16x16x32_bf16 v[92:95], a[24:27], v[40:43], v[92:95]
    s_waitcnt vmcnt(6) lgkmcnt(0)
    v_exp_f32 v78, v78
    v_mfma_f32_16x16x32_bf16 v[92:95], a[28:31], v[44:47], v[92:95]
    s_barrier
    v_exp_f32 v79, v79
    v_mfma_f32_16x16x32_bf16 v[200:203], a[152:155], v[104:107], v[200:203]
    s_mov_b32 m0, s23
    v_cvt_pk_bf16_f32 v127, v78, v79
    v_max_u32 v11, v11, v16
    v_mfma_f32_16x16x32_bf16 v[200:203], a[184:187], v[132:135], v[200:203]
    s_add_u32 s24, s24, 8320
    ds_read_b128 v[16:19], v10 offset:2048
    ds_read_b128 v[148:151], v4 offset:3072
    v_mfma_f32_16x16x32_bf16 v[200:203], a[216:219], v[136:139], v[200:203]
    s_cmp_eq_u32 s24, 124800
    ds_write_b128 v3, v[124:127] offset:7168
    v_exp_f32 v88, v88
    v_mfma_f32_16x16x32_bf16 v[200:203], a[248:251], v[140:143], v[200:203]
    v_exp_f32 v89, v89
    v_mfma_f32_16x16x32_bf16 v[204:207], a[156:159], v[104:107], v[204:207]
    s_cselect_b32 s24, 66560, s24
    v_exp_f32 v92, v92
    v_mfma_f32_16x16x32_bf16 v[204:207], a[188:191], v[132:135], v[204:207]
    s_add_u32 s23, s23, 8320
    ds_read_b128 v[152:155], v5 offset:3072
    v_mul_f32 v176, v176, v13
    v_mfma_f32_16x16x32_bf16 v[204:207], a[220:223], v[136:139], v[204:207]
    s_cmp_eq_u32 s23, s27
    v_exp_f32 v90, v90
    v_exp_f32 v93, v93
    v_mul_f32 v177, v177, v13
    v_mfma_f32_16x16x32_bf16 v[204:207], a[252:255], v[140:143], v[204:207]
    s_waitcnt lgkmcnt(3)
    ds_read_b128 v[156:159], v6 offset:3072
    v_add_f32 v16, v16, v17
    v_add_f32 v18, v18, v19
    v_add_f32 v16, v16, v18
    v_cvt_pk_bf16_f32 v98, v92, v93
    v_cvt_pk_bf16_f32 v192, v176, v177
    v_mfma_f32_16x16x32_bf16 v[64:67], a[0:3], v[48:51], -4.0
    s_cselect_b32 s23, s30, s23
    v_exp_f32 v91, v91
    v_cvt_pk_bf16_f32 v96, v88, v89
    v_cvt_pk_bf16_f32 v97, v90, v91
    v_exp_f32 v94, v94
    v_mul_f32 v178, v178, v13
    v_mfma_f32_16x16x32_bf16 v[64:67], a[4:7], v[52:55], v[64:67]
    buffer_load_dwordx4 v7, s[4:7], s22 offen offset:0 nt lds
    v_mul_f32 v179, v179, v13
    v_mfma_f32_16x16x32_bf16 v[64:67], a[8:11], v[56:59], v[64:67]
    v_exp_f32 v95, v95
    v_mfma_f32_16x16x32_bf16 v[64:67], a[12:15], v[60:63], v[64:67]
    s_waitcnt lgkmcnt(0)
    v_cvt_pk_bf16_f32 v99, v94, v95
    v_cvt_pk_bf16_f32 v193, v178, v179
    v_mfma_f32_16x16x32_bf16 v[208:211], a[152:155], v[108:111], v[208:211]
    ds_write_b128 v3, v[96:99] offset:33280
    v_mul_f32 v180, v180, v13
    v_mfma_f32_16x16x32_bf16 v[208:211], a[184:187], v[148:151], v[208:211]
    buffer_load_dwordx4 v7, s[4:7], s22 offen offset:1024 nt lds
    v_max_u32 v11, v11, v16
    v_mul_f32 v181, v181, v13
    v_mfma_f32_16x16x32_bf16 v[208:211], a[216:219], v[152:155], v[208:211]
    s_add_u32 s22, s22, 8192
    v_cvt_pk_bf16_f32 v194, v180, v181
    v_mul_f32 v182, v182, v13
    v_mfma_f32_16x16x32_bf16 v[208:211], a[248:251], v[156:159], v[208:211]
    v_exp_f32 v64, v64
    v_mfma_f32_16x16x32_bf16 v[68:71], a[16:19], v[48:51], -4.0
    v_mul_f32 v183, v183, v13
    v_cvt_pk_bf16_f32 v195, v182, v183
    v_mfma_f32_16x16x32_bf16 v[68:71], a[20:23], v[52:55], v[68:71]
    v_exp_f32 v65, v65
    v_mfma_f32_16x16x32_bf16 v[68:71], a[24:27], v[56:59], v[68:71]
    v_cvt_pk_bf16_f32 v100, v64, v65
    v_mul_f32 v184, v184, v14
    v_mfma_f32_16x16x32_bf16 v[68:71], a[28:31], v[60:63], v[68:71]
    buffer_store_dwordx4 v[192:195], v8, s[16:19], s25 offen sc0 sc1
    v_mfma_f32_16x16x32_bf16 v[20:23], v[24:27], v[120:123], 0
    s_add_u32 s25, s25, 8192
    v_exp_f32 v66, v66
    v_mul_f32 v185, v185, v14
    v_mfma_f32_16x16x32_bf16 v[20:23], v[28:31], v[124:127], v[20:23]
    v_cvt_pk_bf16_f32 v196, v184, v185
    v_mul_f32 v186, v186, v14
    v_mfma_f32_16x16x32_bf16 v[72:75], a[32:35], v[32:35], -4.0
    v_exp_f32 v67, v67
    v_mfma_f32_16x16x32_bf16 v[72:75], a[36:39], v[36:39], v[72:75]
    v_cvt_pk_bf16_f32 v101, v66, v67
    v_mul_f32 v187, v187, v14
    v_mfma_f32_16x16x32_bf16 v[72:75], a[40:43], v[40:43], v[72:75]
    v_exp_f32 v68, v68
    v_mfma_f32_16x16x32_bf16 v[72:75], a[44:47], v[44:47], v[72:75]
    ds_read_b128 v[128:131], v3 offset:4096
    v_cvt_pk_bf16_f32 v197, v186, v187
    v_mfma_f32_16x16x32_bf16 v[212:215], a[156:159], v[108:111], v[212:215]
    s_barrier
    v_exp_f32 v69, v69
    v_mul_f32 v188, v188, v14
    v_mfma_f32_16x16x32_bf16 v[212:215], a[188:191], v[148:151], v[212:215]
    ds_read_b128 v[132:135], v4 offset:4096
    v_cvt_pk_bf16_f32 v102, v68, v69
    v_mul_f32 v189, v189, v14
    v_mfma_f32_16x16x32_bf16 v[212:215], a[220:223], v[152:155], v[212:215]
    ds_read_b128 v[136:139], v5 offset:4096
    v_exp_f32 v70, v70
    v_mfma_f32_16x16x32_bf16 v[212:215], a[252:255], v[156:159], v[212:215]
    ds_read_b128 v[140:143], v6 offset:4096
    v_cvt_pk_bf16_f32 v198, v188, v189
    v_mfma_f32_16x16x32_bf16 v[76:79], a[48:51], v[32:35], -4.0
    v_exp_f32 v71, v71
    v_exp_f32 v72, v72
    v_add_f32 v252, v252, v20
    v_mul_f32 v190, v190, v14
    v_mfma_f32_16x16x32_bf16 v[76:79], a[52:55], v[36:39], v[76:79]
    v_cvt_pk_bf16_f32 v103, v70, v71
    v_mul_f32 v191, v191, v14
    v_rcp_f32 v13, v16
    v_mfma_f32_16x16x32_bf16 v[76:79], a[56:59], v[40:43], v[76:79]
    ds_write_b128 v3, v[100:103] offset:34304
    ds_write_b32 v9, v252 offset:0
    v_mov_b32 v14, v13
    v_max_u32 v12, v12, v13
    v_exp_f32 v73, v73
    v_permlane32_swap_b32 v13, v14
    v_mul_f32 v200, v200, v13
    v_mul_f32 v201, v201, v13
    v_mul_f32 v202, v202, v13
    v_mul_f32 v203, v203, v13
    v_mul_f32 v204, v204, v13
    v_mul_f32 v205, v205, v13
    v_mul_f32 v206, v206, v13
    v_mul_f32 v207, v207, v13
    v_mul_f32 v208, v208, v14
    v_mul_f32 v209, v209, v14
    v_mul_f32 v210, v210, v14
    v_cvt_pk_bf16_f32 v199, v190, v191
    v_mfma_f32_16x16x32_bf16 v[76:79], a[60:63], v[44:47], v[76:79]
    s_waitcnt lgkmcnt(2)
    ds_read_b128 v[16:19], v10 offset:2560
    v_cvt_pk_bf16_f32 v104, v72, v73
    v_mul_f32 v211, v211, v14
    v_mfma_f32_16x16x32_bf16 v[216:219], a[152:155], v[128:131], v[216:219]
    v_exp_f32 v74, v74
    v_mfma_f32_16x16x32_bf16 v[216:219], a[184:187], v[132:135], v[216:219]
    buffer_store_dwordx4 v[196:199], v8, s[16:19], s26 offen sc0 sc1
    s_add_u32 s26, s26, 8192
    v_cvt_pk_bf16_f32 v192, v200, v201
    v_cvt_pk_bf16_f32 v193, v202, v203
    v_cvt_pk_bf16_f32 v194, v204, v205
    v_cvt_pk_bf16_f32 v195, v206, v207
    v_cvt_pk_bf16_f32 v196, v208, v209
    v_cvt_pk_bf16_f32 v197, v210, v211
    v_mul_f32 v212, v212, v14
    v_mfma_f32_16x16x32_bf16 v[216:219], a[216:219], v[136:139], v[216:219]
    v_exp_f32 v75, v75
    v_mul_f32 v213, v213, v14
    v_mfma_f32_16x16x32_bf16 v[216:219], a[248:251], v[140:143], v[216:219]
    s_waitcnt lgkmcnt(0)
    v_cvt_pk_bf16_f32 v105, v74, v75
    v_cvt_pk_bf16_f32 v198, v212, v213
    v_mfma_f32_16x16x32_bf16 v[80:83], a[32:35], v[48:51], -4.0
    buffer_store_dwordx4 v[192:195], v8, s[16:19], s25 offen sc0 sc1
    v_exp_f32 v76, v76
    v_mfma_f32_16x16x32_bf16 v[80:83], a[36:39], v[52:55], v[80:83]
    s_add_u32 s25, s25, 8192
    v_add_f32 v16, v16, v17
    v_add_f32 v18, v18, v19
    v_add_f32 v16, v16, v18
    v_mul_f32 v214, v214, v14
    v_mfma_f32_16x16x32_bf16 v[80:83], a[40:43], v[56:59], v[80:83]
    v_exp_f32 v77, v77
    v_mul_f32 v215, v215, v14
    v_rcp_f32 v13, v16
    v_mfma_f32_16x16x32_bf16 v[80:83], a[44:47], v[60:63], v[80:83]
    v_mov_b32 v14, v13
    v_max_u32 v12, v12, v13
    v_cvt_pk_bf16_f32 v106, v76, v77
    v_permlane32_swap_b32 v13, v14
    v_cvt_pk_bf16_f32 v199, v214, v215
    v_mfma_f32_16x16x32_bf16 v[84:87], a[48:51], v[48:51], -4.0
    v_exp_f32 v78, v78
    v_mfma_f32_16x16x32_bf16 v[84:87], a[52:55], v[52:55], v[84:87]
    v_exp_f32 v79, v79
    v_mfma_f32_16x16x32_bf16 v[84:87], a[56:59], v[56:59], v[84:87]
    buffer_store_dwordx4 v[196:199], v8, s[16:19], s26 offen sc0 sc1
    s_add_u32 s26, s26, 8192
    v_mfma_f32_16x16x32_bf16 v[84:87], a[60:63], v[60:63], v[84:87]
    v_cvt_pk_bf16_f32 v107, v78, v79
    v_max_u32 v11, v11, v16
    v_mfma_f32_16x16x32_bf16 v[220:223], a[156:159], v[128:131], v[220:223]
    ds_write_b128 v3, v[104:107] offset:35328
    v_exp_f32 v80, v80
    v_mfma_f32_16x16x32_bf16 v[220:223], a[188:191], v[132:135], v[220:223]
    v_exp_f32 v81, v81
    v_mfma_f32_16x16x32_bf16 v[220:223], a[220:223], v[136:139], v[220:223]
    v_mul_f32 v216, v216, v13
    v_cvt_pk_bf16_f32 v108, v80, v81
    v_mfma_f32_16x16x32_bf16 v[220:223], a[252:255], v[140:143], v[220:223]
    ds_read_b128 v[144:147], v3 offset:5120
    v_mul_f32 v217, v217, v13
    v_mfma_f32_16x16x32_bf16 v[88:91], a[64:67], v[32:35], -4.0
    v_exp_f32 v82, v82
    v_exp_f32 v84, v84
    v_cvt_pk_bf16_f32 v192, v216, v217
    v_mfma_f32_16x16x32_bf16 v[88:91], a[68:71], v[36:39], v[88:91]
    ds_read_b128 v[148:151], v4 offset:5120
    v_mul_f32 v218, v218, v13
    v_mfma_f32_16x16x32_bf16 v[88:91], a[72:75], v[40:43], v[88:91]
    ds_read_b128 v[152:155], v5 offset:5120
    v_exp_f32 v83, v83
    v_exp_f32 v85, v85
    v_mul_f32 v219, v219, v13
    v_mfma_f32_16x16x32_bf16 v[88:91], a[76:79], v[44:47], v[88:91]
    ds_read_b128 v[156:159], v6 offset:5120
    v_cvt_pk_bf16_f32 v109, v82, v83
    v_cvt_pk_bf16_f32 v110, v84, v85
    v_mfma_f32_16x16x32_bf16 v[92:95], a[80:83], v[32:35], -4.0
    v_exp_f32 v86, v86
    v_cvt_pk_bf16_f32 v193, v218, v219
    v_mfma_f32_16x16x32_bf16 v[92:95], a[84:87], v[36:39], v[92:95]
    v_mul_f32 v220, v220, v13
    v_mul_f32 v221, v221, v13
    v_mfma_f32_16x16x32_bf16 v[92:95], a[88:91], v[40:43], v[92:95]
    v_exp_f32 v87, v87
    v_mfma_f32_16x16x32_bf16 v[92:95], a[92:95], v[44:47], v[92:95]
    s_waitcnt lgkmcnt(0)
    v_cvt_pk_bf16_f32 v111, v86, v87
    v_cvt_pk_bf16_f32 v194, v220, v221
    v_mfma_f32_16x16x32_bf16 v[224:227], a[152:155], v[144:147], v[224:227]
    ds_write_b128 v3, v[108:111] offset:36352
    v_exp_f32 v88, v88
    v_mul_f32 v222, v222, v13
    v_mfma_f32_16x16x32_bf16 v[224:227], a[184:187], v[148:151], v[224:227]
    v_exp_f32 v89, v89
    v_mfma_f32_16x16x32_bf16 v[224:227], a[216:219], v[152:155], v[224:227]
    v_mul_f32 v223, v223, v13
    v_cvt_pk_bf16_f32 v112, v88, v89
    v_mfma_f32_16x16x32_bf16 v[224:227], a[248:251], v[156:159], v[224:227]
    v_cvt_pk_bf16_f32 v195, v222, v223
    v_add_u32 v1, s24, v2
    v_mfma_f32_16x16x32_bf16 v[64:67], a[64:67], v[48:51], -4.0
    v_exp_f32 v90, v90
    v_exp_f32 v92, v92
    v_mfma_f32_16x16x32_bf16 v[64:67], a[68:71], v[52:55], v[64:67]
    v_exp_f32 v91, v91
    v_mfma_f32_16x16x32_bf16 v[64:67], a[72:75], v[56:59], v[64:67]
    buffer_store_dwordx4 v[192:195], v8, s[16:19], s25 offen sc0 sc1
    v_mul_f32 v224, v224, v14
    v_mul_f32 v225, v225, v14
    v_exp_f32 v93, v93
    v_cvt_pk_bf16_f32 v196, v224, v225
    v_mfma_f32_16x16x32_bf16 v[64:67], a[76:79], v[60:63], v[64:67]
    v_cvt_pk_bf16_f32 v113, v90, v91
    v_cvt_pk_bf16_f32 v114, v92, v93
    v_mfma_f32_16x16x32_bf16 v[68:71], a[80:83], v[48:51], -4.0
    s_add_u32 s25, s25, 8192
    v_exp_f32 v94, v94
    v_mul_f32 v226, v226, v14
    v_mfma_f32_16x16x32_bf16 v[68:71], a[84:87], v[52:55], v[68:71]
    ds_read_b128 v[128:131], v3 offset:6144
    v_mul_f32 v227, v227, v14
    v_mfma_f32_16x16x32_bf16 v[68:71], a[88:91], v[56:59], v[68:71]
    v_exp_f32 v95, v95
    v_cvt_pk_bf16_f32 v197, v226, v227
    v_mfma_f32_16x16x32_bf16 v[68:71], a[92:95], v[60:63], v[68:71]
    ds_read_b128 v[132:135], v4 offset:6144
    v_cvt_pk_bf16_f32 v115, v94, v95
    v_mfma_f32_16x16x32_bf16 v[228:231], a[156:159], v[144:147], v[228:231]
    ds_write_b128 v3, v[112:115] offset:37376
    v_exp_f32 v64, v64
    v_mfma_f32_16x16x32_bf16 v[228:231], a[188:191], v[148:151], v[228:231]
    v_exp_f32 v65, v65
    v_mfma_f32_16x16x32_bf16 v[228:231], a[220:223], v[152:155], v[228:231]
    ds_read_b128 v[136:139], v5 offset:6144
    v_cvt_pk_bf16_f32 v116, v64, v65
    v_mfma_f32_16x16x32_bf16 v[228:231], a[252:255], v[156:159], v[228:231]
    v_exp_f32 v66, v66
    v_mfma_f32_16x16x32_bf16 v[72:75], a[96:99], v[32:35], -4.0
    v_exp_f32 v68, v68
    v_mfma_f32_16x16x32_bf16 v[72:75], a[100:103], v[36:39], v[72:75]
    v_exp_f32 v67, v67
    v_mfma_f32_16x16x32_bf16 v[72:75], a[104:107], v[40:43], v[72:75]
    v_exp_f32 v69, v69
    v_mfma_f32_16x16x32_bf16 v[72:75], a[108:111], v[44:47], v[72:75]
    ds_read_b128 v[140:143], v6 offset:6144
    v_mul_f32 v228, v228, v14
    v_mul_f32 v229, v229, v14
    v_cvt_pk_bf16_f32 v198, v228, v229
    v_mul_f32 v230, v230, v14
    v_mul_f32 v231, v231, v14
    v_cvt_pk_bf16_f32 v199, v230, v231
    v_cvt_pk_bf16_f32 v117, v66, v67
    v_cvt_pk_bf16_f32 v118, v68, v69
    v_mfma_f32_16x16x32_bf16 v[76:79], a[112:115], v[32:35], -4.0
    v_exp_f32 v70, v70
    v_mfma_f32_16x16x32_bf16 v[76:79], a[116:119], v[36:39], v[76:79]
    v_exp_f32 v71, v71
    v_mfma_f32_16x16x32_bf16 v[76:79], a[120:123], v[40:43], v[76:79]
    buffer_store_dwordx4 v[196:199], v8, s[16:19], s26 offen sc0 sc1
    s_add_u32 s26, s26, 8192
    v_mfma_f32_16x16x32_bf16 v[76:79], a[124:127], v[44:47], v[76:79]
    s_waitcnt lgkmcnt(0)
    ds_read_b128 v[32:35], v1 offset:0
    v_cvt_pk_bf16_f32 v119, v70, v71
    v_mfma_f32_16x16x32_bf16 v[160:163], a[152:155], v[128:131], v[160:163]
    ds_write_b128 v3, v[116:119] offset:38400
    v_exp_f32 v72, v72
    v_mfma_f32_16x16x32_bf16 v[160:163], a[184:187], v[132:135], v[160:163]
    v_exp_f32 v73, v73
    v_mfma_f32_16x16x32_bf16 v[160:163], a[216:219], v[136:139], v[160:163]
    ds_read_b128 v[36:39], v1 offset:256
    v_cvt_pk_bf16_f32 v120, v72, v73
    v_mfma_f32_16x16x32_bf16 v[160:163], a[248:251], v[140:143], v[160:163]
    ds_read_b128 v[40:43], v1 offset:512
    ds_read_b128 v[44:47], v1 offset:768
    v_mfma_f32_16x16x32_bf16 v[80:83], a[96:99], v[48:51], -4.0
    v_exp_f32 v74, v74
    v_exp_f32 v76, v76
    v_mfma_f32_16x16x32_bf16 v[80:83], a[100:103], v[52:55], v[80:83]
    v_exp_f32 v75, v75
    v_mfma_f32_16x16x32_bf16 v[80:83], a[104:107], v[56:59], v[80:83]
    v_exp_f32 v77, v77
    v_mfma_f32_16x16x32_bf16 v[80:83], a[108:111], v[60:63], v[80:83]
    v_cvt_pk_bf16_f32 v121, v74, v75
    v_cvt_pk_bf16_f32 v122, v76, v77
    v_mfma_f32_16x16x32_bf16 v[84:87], a[112:115], v[48:51], -4.0
    v_exp_f32 v78, v78
    v_mfma_f32_16x16x32_bf16 v[84:87], a[116:119], v[52:55], v[84:87]
    v_exp_f32 v79, v79
    v_mfma_f32_16x16x32_bf16 v[84:87], a[120:123], v[56:59], v[84:87]
    ds_read_b128 v[144:147], v3 offset:7168
    v_cvt_pk_bf16_f32 v123, v78, v79
    v_mfma_f32_16x16x32_bf16 v[84:87], a[124:127], v[60:63], v[84:87]
    v_exp_f32 v80, v80
    v_mfma_f32_16x16x32_bf16 v[164:167], a[156:159], v[128:131], v[164:167]
    ds_write_b128 v3, v[120:123] offset:39424
    v_mfma_f32_16x16x32_bf16 v[164:167], a[188:191], v[132:135], v[164:167]
    ds_read_b128 v[48:51], v1 offset:4160
    ds_read_b128 v[148:151], v4 offset:7168
    v_mfma_f32_16x16x32_bf16 v[164:167], a[220:223], v[136:139], v[164:167]
    ds_read_b128 v[52:55], v1 offset:4416
    ds_read_b128 v[152:155], v5 offset:7168
    v_exp_f32 v81, v81
    v_mfma_f32_16x16x32_bf16 v[164:167], a[252:255], v[140:143], v[164:167]
    s_waitcnt lgkmcnt(6)
    ds_read_b128 v[56:59], v1 offset:4672
    ds_read_b128 v[156:159], v6 offset:7168
    v_cvt_pk_bf16_f32 v124, v80, v81
    v_mfma_f32_16x16x32_bf16 v[88:91], a[0:3], v[32:35], -4.0
    ds_read_b128 v[60:63], v1 offset:4928
    v_exp_f32 v82, v82
    v_exp_f32 v84, v84
    v_mfma_f32_16x16x32_bf16 v[88:91], a[4:7], v[36:39], v[88:91]
    v_exp_f32 v83, v83
    v_mfma_f32_16x16x32_bf16 v[88:91], a[8:11], v[40:43], v[88:91]
    v_exp_f32 v85, v85
    v_mfma_f32_16x16x32_bf16 v[88:91], a[12:15], v[44:47], v[88:91]
    s_waitcnt lgkmcnt(1)
    v_cvt_pk_bf16_f32 v125, v82, v83
    v_cvt_pk_bf16_f32 v126, v84, v85
    v_mfma_f32_16x16x32_bf16 v[168:171], a[152:155], v[144:147], v[168:171]
    v_exp_f32 v86, v86
    v_mfma_f32_16x16x32_bf16 v[168:171], a[184:187], v[148:151], v[168:171]
    v_exp_f32 v87, v87
    v_mfma_f32_16x16x32_bf16 v[168:171], a[216:219], v[152:155], v[168:171]
    v_cvt_pk_bf16_f32 v127, v86, v87
    v_mfma_f32_16x16x32_bf16 v[168:171], a[248:251], v[156:159], v[168:171]
    v_exp_f32 v88, v88
    v_mfma_f32_16x16x32_bf16 v[92:95], a[16:19], v[32:35], -4.0
    ds_write_b128 v3, v[124:127] offset:40448
    v_mfma_f32_16x16x32_bf16 v[92:95], a[20:23], v[36:39], v[92:95]
    v_exp_f32 v89, v89
    v_mfma_f32_16x16x32_bf16 v[92:95], a[24:27], v[40:43], v[92:95]
    v_exp_f32 v90, v90
    v_mfma_f32_16x16x32_bf16 v[92:95], a[28:31], v[44:47], v[92:95]
    v_exp_f32 v91, v91
    v_mfma_f32_16x16x32_bf16 v[172:175], a[156:159], v[144:147], v[172:175]
    v_mfma_f32_16x16x32_bf16 v[172:175], a[188:191], v[148:151], v[172:175]
    v_mfma_f32_16x16x32_bf16 v[172:175], a[220:223], v[152:155], v[172:175]
    s_waitcnt vmcnt(12) lgkmcnt(0)
    v_mfma_f32_16x16x32_bf16 v[172:175], a[252:255], v[156:159], v[172:175]
    s_barrier
    s_mov_b32 s21, 17
    s_cmp_ge_u32 s20, 2
    s_cbranch_scc1 L_loop1
    s_branch L_loop0
L_xs:
    s_add_u32 s23, s30, 16640
    s_mov_b32 s22, 73728
    s_mov_b32 s24, 108160
    s_waitcnt vmcnt(5)
    ds_read_b128 a[0:3], v255 offset:0
    ds_read_b128 a[4:7], v255 offset:256
    ds_read_b128 a[8:11], v255 offset:512
    ds_read_b128 a[12:15], v255 offset:768
    ds_read_b128 a[16:19], v255 offset:4160
    ds_read_b128 a[20:23], v255 offset:4416
    ds_read_b128 a[24:27], v255 offset:4672
    ds_read_b128 a[28:31], v255 offset:4928
    s_waitcnt lgkmcnt(7)
    v_mfma_f32_16x16x32_bf16 v[192:195], a[152:155], a[0:3], 0
    s_nop 1
    v_mfma_f32_16x16x32_bf16 v[192:195], a[184:187], a[0:3], v[192:195]
    s_nop 1
    v_mfma_f32_16x16x32_bf16 v[196:199], a[156:159], a[0:3], 0
    s_waitcnt vmcnt(3)
    s_add_u32 m0, s30, 16640
    s_mov_b32 s46, 16384
    buffer_load_dwordx4 v7, s[4:7], s46 offen offset:0 nt lds
    s_nop 1
    v_mfma_f32_16x16x32_bf16 v[196:199], a[188:191], a[0:3], v[196:199]
    s_nop 1
    s_waitcnt lgkmcnt(6)
    v_mfma_f32_16x16x32_bf16 v[16:19], a[152:155], a[4:7], 0
    v_cvt_pk_bf16_f32 v192, v192, v193
    v_cvt_pk_bf16_f32 v193, v194, v195
    v_mfma_f32_16x16x32_bf16 v[16:19], a[184:187], a[4:7], v[16:19]
    v_accvgpr_write_b32 a0, v192
    v_accvgpr_write_b32 a1, v193
    v_mfma_f32_16x16x32_bf16 v[192:195], a[156:159], a[4:7], 0
    s_waitcnt vmcnt(3)
    buffer_load_dwordx4 v7, s[4:7], s46 offen offset:1024 nt lds
    v_cvt_pk_bf16_f32 v196, v196, v197
    v_cvt_pk_bf16_f32 v197, v198, v199
    v_mfma_f32_16x16x32_bf16 v[192:195], a[188:191], a[4:7], v[192:195]
    v_accvgpr_write_b32 a2, v196
    v_accvgpr_write_b32 a3, v197
    s_waitcnt lgkmcnt(5)
    v_mfma_f32_16x16x32_bf16 v[196:199], a[152:155], a[8:11], 0
    v_cvt_pk_bf16_f32 v16, v16, v17
    v_cvt_pk_bf16_f32 v17, v18, v19
    v_mfma_f32_16x16x32_bf16 v[196:199], a[184:187], a[8:11], v[196:199]
    v_accvgpr_write_b32 a4, v16
    v_accvgpr_write_b32 a5, v17
    v_mfma_f32_16x16x32_bf16 v[16:19], a[156:159], a[8:11], 0
    s_waitcnt vmcnt(3)
    s_add_u32 m0, s72, 124800
    s_nop 0
    buffer_load_dwordx4 v0, s[12:15], s64 offen offset:0 nt lds
    v_cvt_pk_bf16_f32 v192, v192, v193
    v_cvt_pk_bf16_f32 v193, v194, v195
    v_mfma_f32_16x16x32_bf16 v[16:19], a[188:191], a[8:11], v[16:19]
    v_accvgpr_write_b32 a6, v192
    v_accvgpr_write_b32 a7, v193
    s_waitcnt lgkmcnt(4)
    v_mfma_f32_16x16x32_bf16 v[192:195], a[152:155], a[12:15], 0
    v_cvt_pk_bf16_f32 v196, v196, v197
    v_cvt_pk_bf16_f32 v197, v198, v199
    v_mfma_f32_16x16x32_bf16 v[192:195], a[184:187], a[12:15], v[192:195]
    v_accvgpr_write_b32 a8, v196
    v_accvgpr_write_b32 a9, v197
    v_mfma_f32_16x16x32_bf16 v[196:199], a[156:159], a[12:15], 0
    s_waitcnt vmcnt(3)
    buffer_load_dwordx4 v0, s[12:15], s64 offen offset:1024 nt lds
    v_cvt_pk_bf16_f32 v16, v16, v17
    v_cvt_pk_bf16_f32 v17, v18, v19
    v_mfma_f32_16x16x32_bf16 v[196:199], a[188:191], a[12:15], v[196:199]
    v_accvgpr_write_b32 a10, v16
    v_accvgpr_write_b32 a11, v17
    s_waitcnt lgkmcnt(3)
    v_mfma_f32_16x16x32_bf16 v[16:19], a[152:155], a[16:19], 0
    v_cvt_pk_bf16_f32 v192, v192, v193
    v_cvt_pk_bf16_f32 v193, v194, v195
    v_mfma_f32_16x16x32_bf16 v[16:19], a[184:187], a[16:19], v[16:19]
    v_accvgpr_write_b32 a12, v192
    v_accvgpr_write_b32 a13, v193
    v_mfma_f32_16x16x32_bf16 v[192:195], a[156:159], a[16:19], 0
    s_waitcnt vmcnt(3)
    buffer_load_dwordx4 v0, s[12:15], s64 offen offset:2048 nt lds
    s_barrier
    v_cvt_pk_bf16_f32 v196, v196, v197
    v_cvt_pk_bf16_f32 v197, v198, v199
    v_mfma_f32_16x16x32_bf16 v[192:195], a[188:191], a[16:19], v[192:195]
    v_accvgpr_write_b32 a14, v196
    v_accvgpr_write_b32 a15, v197
    s_waitcnt lgkmcnt(2)
    v_mfma_f32_16x16x32_bf16 v[196:199], a[152:155], a[20:23], 0
    ds_read_b128 v[32:35], v1 offset:0
    ds_read_b128 v[36:39], v1 offset:256
    v_cvt_pk_bf16_f32 v16, v16, v17
    v_cvt_pk_bf16_f32 v17, v18, v19
    v_mfma_f32_16x16x32_bf16 v[196:199], a[184:187], a[20:23], v[196:199]
    v_accvgpr_write_b32 a16, v16
    v_accvgpr_write_b32 a17, v17
    v_mfma_f32_16x16x32_bf16 v[16:19], a[156:159], a[20:23], 0
    s_waitcnt vmcnt(3)
    buffer_load_dwordx4 v0, s[12:15], s64 offen offset:3072 nt lds
    ds_read_b128 v[40:43], v1 offset:512
    ds_read_b128 v[44:47], v1 offset:768
    v_cvt_pk_bf16_f32 v192, v192, v193
    v_cvt_pk_bf16_f32 v193, v194, v195
    v_mfma_f32_16x16x32_bf16 v[16:19], a[188:191], a[20:23], v[16:19]
    v_accvgpr_write_b32 a18, v192
    v_accvgpr_write_b32 a19, v193
    s_waitcnt lgkmcnt(5)
    v_mfma_f32_16x16x32_bf16 v[192:195], a[152:155], a[24:27], 0
    ds_read_b128 v[48:51], v1 offset:4160
    ds_read_b128 v[52:55], v1 offset:4416
    v_cvt_pk_bf16_f32 v196, v196, v197
    v_cvt_pk_bf16_f32 v197, v198, v199
    v_mfma_f32_16x16x32_bf16 v[192:195], a[184:187], a[24:27], v[192:195]
    v_accvgpr_write_b32 a20, v196
    v_accvgpr_write_b32 a21, v197
    v_mfma_f32_16x16x32_bf16 v[196:199], a[156:159], a[24:27], 0
    s_waitcnt vmcnt(3)
    s_add_u32 m0, s72, 141184
    s_nop 0
    buffer_load_dwordx4 v0, s[12:15], s65 offen offset:0 nt lds
    ds_read_b128 v[56:59], v1 offset:4672
    ds_read_b128 v[60:63], v1 offset:4928
    v_cvt_pk_bf16_f32 v16, v16, v17
    v_cvt_pk_bf16_f32 v17, v18, v19
    v_mfma_f32_16x16x32_bf16 v[196:199], a[188:191], a[24:27], v[196:199]
    v_accvgpr_write_b32 a22, v16
    v_accvgpr_write_b32 a23, v17
    s_waitcnt lgkmcnt(8)
    v_mfma_f32_16x16x32_bf16 v[16:19], a[152:155], a[28:31], 0
    v_cvt_pk_bf16_f32 v192, v192, v193
    v_cvt_pk_bf16_f32 v193, v194, v195
    v_mfma_f32_16x16x32_bf16 v[16:19], a[184:187], a[28:31], v[16:19]
    v_accvgpr_write_b32 a24, v192
    v_accvgpr_write_b32 a25, v193
    v_mfma_f32_16x16x32_bf16 v[192:195], a[156:159], a[28:31], 0
    s_waitcnt vmcnt(3)
    buffer_load_dwordx4 v0, s[12:15], s65 offen offset:1024 nt lds
    v_cvt_pk_bf16_f32 v196, v196, v197
    v_cvt_pk_bf16_f32 v197, v198, v199
    v_mfma_f32_16x16x32_bf16 v[192:195], a[188:191], a[28:31], v[192:195]
    v_accvgpr_write_b32 a26, v196
    v_accvgpr_write_b32 a27, v197
    s_waitcnt lgkmcnt(4)
    v_mfma_f32_16x16x32_bf16 v[64:67], a[0:3], v[32:35], -4.0
    s_waitcnt vmcnt(3)
    v_cvt_pk_bf16_f32 v16, v16, v17
    v_cvt_pk_bf16_f32 v17, v18, v19
    v_accvgpr_write_b32 a28, v16
    v_accvgpr_write_b32 a29, v17
    v_cvt_pk_bf16_f32 v192, v192, v193
    v_cvt_pk_bf16_f32 v193, v194, v195
    v_accvgpr_write_b32 a30, v192
    v_accvgpr_write_b32 a31, v193
    v_mfma_f32_16x16x32_bf16 v[64:67], a[4:7], v[36:39], v[64:67]
    buffer_load_dwordx4 v0, s[12:15], s65 offen offset:2048 nt lds
    v_mfma_f32_16x16x32_bf16 v[64:67], a[8:11], v[40:43], v[64:67]
    s_waitcnt vmcnt(3)
    v_mfma_f32_16x16x32_bf16 v[64:67], a[12:15], v[44:47], v[64:67]
    s_nop 1
    v_mfma_f32_16x16x32_bf16 v[68:71], a[16:19], v[32:35], -4.0
    ds_read_b128 v[32:35], v1 offset:8320
    s_nop 0
    v_mfma_f32_16x16x32_bf16 v[68:71], a[20:23], v[36:39], v[68:71]
    buffer_load_dwordx4 v0, s[12:15], s65 offen offset:3072 nt lds
    v_mfma_f32_16x16x32_bf16 v[68:71], a[24:27], v[40:43], v[68:71]
    s_waitcnt vmcnt(3)
    v_exp_f32 v64, v64
    v_mfma_f32_16x16x32_bf16 v[68:71], a[28:31], v[44:47], v[68:71]
    s_waitcnt lgkmcnt(1)
    ds_read_b128 v[36:39], v1 offset:8576
    ds_read_b128 v[40:43], v1 offset:8832
    v_mfma_f32_16x16x32_bf16 v[72:75], a[0:3], v[48:51], -4.0
    s_add_u32 m0, s30, 24960
    v_exp_f32 v65, v65
    v_mfma_f32_16x16x32_bf16 v[72:75], a[4:7], v[52:55], v[72:75]
    s_mov_b32 s46, 24576
    ds_read_b128 v[44:47], v1 offset:9088
    v_cvt_pk_bf16_f32 v96, v64, v65
    v_mfma_f32_16x16x32_bf16 v[72:75], a[8:11], v[56:59], v[72:75]
    buffer_load_dwordx4 v7, s[4:7], s46 offen offset:0 nt lds
    v_mfma_f32_16x16x32_bf16 v[72:75], a[12:15], v[60:63], v[72:75]
    v_exp_f32 v66, v66
    v_mfma_f32_16x16x32_bf16 v[76:79], a[16:19], v[48:51], -4.0
    s_waitcnt vmcnt(3)
    v_exp_f32 v68, v68
    v_mfma_f32_16x16x32_bf16 v[76:79], a[20:23], v[52:55], v[76:79]
    v_exp_f32 v67, v67
    v_mfma_f32_16x16x32_bf16 v[76:79], a[24:27], v[56:59], v[76:79]
    s_waitcnt lgkmcnt(0)
    v_exp_f32 v69, v69
    v_mfma_f32_16x16x32_bf16 v[76:79], a[28:31], v[60:63], v[76:79]
    v_cvt_pk_bf16_f32 v97, v66, v67
    v_cvt_pk_bf16_f32 v98, v68, v69
    v_mfma_f32_16x16x32_bf16 v[64:67], a[0:3], v[32:35], -4.0
    ds_read_b128 v[48:51], v1 offset:12480
    ds_read_b128 v[52:55], v1 offset:12736
    v_mfma_f32_16x16x32_bf16 v[64:67], a[4:7], v[36:39], v[64:67]
    buffer_load_dwordx4 v7, s[4:7], s46 offen offset:1024 nt lds
    v_mfma_f32_16x16x32_bf16 v[64:67], a[8:11], v[40:43], v[64:67]
    s_waitcnt vmcnt(3)
    v_exp_f32 v70, v70
    v_exp_f32 v72, v72
    v_mfma_f32_16x16x32_bf16 v[64:67], a[12:15], v[44:47], v[64:67]
    ds_read_b128 v[56:59], v1 offset:12992
    ds_read_b128 v[60:63], v1 offset:13248
    v_exp_f32 v71, v71
    s_nop 0
    v_cvt_pk_bf16_f32 v99, v70, v71
    v_mfma_f32_16x16x32_bf16 v[68:71], a[16:19], v[32:35], -4.0
    s_barrier
    s_add_u32 m0, s30, 33280
    v_exp_f32 v73, v73
    v_add_u32 v192, s50, v15
    v_mfma_f32_16x16x32_bf16 v[68:71], a[20:23], v[36:39], v[68:71]
    s_mov_b32 s46, 32768
    v_cvt_pk_bf16_f32 v100, v72, v73
    v_add_u32 v193, s51, v15
    v_mfma_f32_16x16x32_bf16 v[68:71], a[24:27], v[40:43], v[68:71]
    ds_write_b128 v3, v[96:99] offset:0
    v_exp_f32 v74, v74
    v_exp_f32 v76, v76
    v_add_u32 v194, s52, v15
    v_mfma_f32_16x16x32_bf16 v[68:71], a[28:31], v[44:47], v[68:71]
    ds_read_b128 v[32:35], v1 offset:16640
    v_add_u32 v195, s53, v15
    v_exp_f32 v75, v75
    s_nop 0
    v_cvt_pk_bf16_f32 v101, v74, v75
    s_waitcnt lgkmcnt(2)
    v_mfma_f32_16x16x32_bf16 v[72:75], a[0:3], v[48:51], -4.0
    v_exp_f32 v77, v77
    v_mfma_f32_16x16x32_bf16 v[72:75], a[4:7], v[52:55], v[72:75]
    buffer_load_dwordx4 v7, s[4:7], s46 offen offset:0 nt lds
    s_waitcnt vmcnt(3)
    buffer_load_dwordx4 v7, s[4:7], s46 offen offset:1024 nt lds
    s_waitcnt vmcnt(3)
    s_add_u32 m0, s54, 0
    s_add_u32 s45, s44, 8192
    v_cvt_pk_bf16_f32 v102, v76, v77
    v_mfma_f32_16x16x32_bf16 v[72:75], a[8:11], v[56:59], v[72:75]
    ds_read_b128 v[36:39], v1 offset:16896
    buffer_load_dwordx4 v7, s[8:11], s45 offen offset:0 nt lds
    s_waitcnt vmcnt(3)
    v_exp_f32 v78, v78
    v_exp_f32 v64, v64
    v_mfma_f32_16x16x32_bf16 v[72:75], a[12:15], v[60:63], v[72:75]
    ds_read_b128 v[40:43], v1 offset:17152
    buffer_load_dwordx4 v7, s[8:11], s45 offen offset:1024 nt lds
    s_waitcnt vmcnt(3)
    s_add_u32 m0, s54, 2080
    s_add_u32 s45, s44, 10240
    v_exp_f32 v79, v79
    s_nop 0
    v_cvt_pk_bf16_f32 v103, v78, v79
    v_mfma_f32_16x16x32_bf16 v[20:23], v[24:27], v[96:99], 0
    ds_read_b128 v[44:47], v1 offset:17408
    buffer_load_dwordx4 v7, s[8:11], s45 offen offset:0 nt lds
    s_waitcnt vmcnt(3)
    v_exp_f32 v65, v65
    v_mfma_f32_16x16x32_bf16 v[20:23], v[28:31], v[100:103], v[20:23]
    buffer_load_dwordx4 v7, s[8:11], s45 offen offset:1024 nt lds
    s_waitcnt vmcnt(3)
    s_add_u32 m0, s54, 4160
    s_add_u32 s45, s44, 12288
    v_cvt_pk_bf16_f32 v104, v64, v65
    v_mfma_f32_16x16x32_bf16 v[76:79], a[16:19], v[48:51], -4.0
    ds_write_b128 v3, v[100:103] offset:1024
    buffer_load_dwordx4 v7, s[8:11], s45 offen offset:0 nt lds
    s_waitcnt vmcnt(3)
    v_exp_f32 v66, v66
    v_exp_f32 v68, v68
    v_mfma_f32_16x16x32_bf16 v[76:79], a[20:23], v[52:55], v[76:79]
    buffer_load_dwordx4 v7, s[8:11], s45 offen offset:1024 nt lds
    s_waitcnt vmcnt(3)
    s_add_u32 m0, s54, 6240
    s_add_u32 s45, s44, 14336
    buffer_load_dwordx4 v7, s[8:11], s45 offen offset:0 nt lds
    s_waitcnt vmcnt(3)
    v_mfma_f32_16x16x32_bf16 v[76:79], a[24:27], v[56:59], v[76:79]
    s_waitcnt lgkmcnt(4)
    buffer_load_dwordx4 v7, s[8:11], s45 offen offset:1024 nt lds
    v_exp_f32 v67, v67
    v_exp_f32 v69, v69
    v_mfma_f32_16x16x32_bf16 v[76:79], a[28:31], v[60:63], v[76:79]
    s_waitcnt vmcnt(3)
    v_cvt_pk_bf16_f32 v105, v66, v67
    v_cvt_pk_bf16_f32 v106, v68, v69
    v_mfma_f32_16x16x32_bf16 v[64:67], a[0:3], v[32:35], -4.0
    s_waitcnt lgkmcnt(0)
    s_barrier
    v_exp_f32 v70, v70
    v_exp_f32 v72, v72
    v_mfma_f32_16x16x32_bf16 v[64:67], a[4:7], v[36:39], v[64:67]
    s_add_u32 m0, s72, 108160
    ds_read_b128 v[48:51], v1 offset:20800
    ds_read_b128 v[52:55], v1 offset:21056
    v_mfma_f32_16x16x32_bf16 v[64:67], a[8:11], v[40:43], v[64:67]
    v_exp_f32 v71, v71
    v_exp_f32 v73, v73
    v_mfma_f32_16x16x32_bf16 v[64:67], a[12:15], v[44:47], v[64:67]
    ds_read_b128 v[56:59], v1 offset:21312
    v_cvt_pk_bf16_f32 v107, v70, v71
    v_cvt_pk_bf16_f32 v108, v72, v73
    v_mfma_f32_16x16x32_bf16 v[68:71], a[16:19], v[32:35], -4.0
    ds_write_b128 v3, v[104:107] offset:2048
    ds_read_b128 v[60:63], v1 offset:21568
    ds_read_b64_tr_b16 a[128:129], v192 offset:16640
    v_exp_f32 v74, v74
    v_mov_b32 v248, v20
    v_mfma_f32_16x16x32_bf16 v[68:71], a[20:23], v[36:39], v[68:71]
    ds_read_b64_tr_b16 a[130:131], v192 offset:33024
    ds_read_b64_tr_b16 a[132:133], v192 offset:16648
    v_mfma_f32_16x16x32_bf16 v[68:71], a[24:27], v[40:43], v[68:71]
    v_exp_f32 v75, v75
    v_exp_f32 v76, v76
    v_mfma_f32_16x16x32_bf16 v[68:71], a[28:31], v[44:47], v[68:71]
    s_waitcnt lgkmcnt(3)
    ds_read_b64_tr_b16 a[134:135], v192 offset:33032
    v_cvt_pk_bf16_f32 v109, v74, v75
    v_mfma_f32_16x16x32_bf16 v[72:75], a[0:3], v[48:51], -4.0
    buffer_load_dwordx4 v0, s[12:15], s66 offen offset:0 nt lds
    ds_read_b64_tr_b16 a[160:161], v193 offset:16640
    v_exp_f32 v77, v77
    v_mfma_f32_16x16x32_bf16 v[72:75], a[4:7], v[52:55], v[72:75]
    s_waitcnt vmcnt(3)
    ds_read_b128 v[32:35], v1 offset:24960
    ds_read_b64_tr_b16 a[162:163], v193 offset:33024
    v_cvt_pk_bf16_f32 v110, v76, v77
    v_mfma_f32_16x16x32_bf16 v[72:75], a[8:11], v[56:59], v[72:75]
    ds_read_b128 v[36:39], v1 offset:25216
    ds_read_b64_tr_b16 a[164:165], v193 offset:16648
    v_exp_f32 v78, v78
    v_exp_f32 v64, v64
    v_mfma_f32_16x16x32_bf16 v[72:75], a[12:15], v[60:63], v[72:75]
    ds_read_b128 v[40:43], v1 offset:25472
    ds_read_b64_tr_b16 a[166:167], v193 offset:33032
    v_exp_f32 v79, v79
    s_nop 0
    v_cvt_pk_bf16_f32 v111, v78, v79
    v_mfma_f32_16x16x32_bf16 v[20:23], v[24:27], v[104:107], 0
    ds_read_b128 v[44:47], v1 offset:25728
    ds_read_b64_tr_b16 a[192:193], v194 offset:16640
    v_exp_f32 v65, v65
    v_mfma_f32_16x16x32_bf16 v[20:23], v[28:31], v[108:111], v[20:23]
    ds_read_b64_tr_b16 a[194:195], v194 offset:33024
    v_cvt_pk_bf16_f32 v112, v64, v65
    v_mfma_f32_16x16x32_bf16 v[76:79], a[16:19], v[48:51], -4.0
    ds_write_b128 v3, v[108:111] offset:3072
    ds_read_b64_tr_b16 a[196:197], v194 offset:16648
    v_exp_f32 v66, v66
    v_exp_f32 v68, v68
    v_mfma_f32_16x16x32_bf16 v[76:79], a[20:23], v[52:55], v[76:79]
    ds_read_b128 v[132:135], v4 offset:0
    ds_read_b64_tr_b16 a[198:199], v194 offset:33032
    v_mfma_f32_16x16x32_bf16 v[76:79], a[24:27], v[56:59], v[76:79]
    s_waitcnt lgkmcnt(6)
    ds_read_b128 v[136:139], v5 offset:0
    buffer_load_dwordx4 v0, s[12:15], s66 offen offset:1024 nt lds
    ds_read_b64_tr_b16 a[224:225], v195 offset:16640
    v_exp_f32 v67, v67
    v_exp_f32 v69, v69
    v_mfma_f32_16x16x32_bf16 v[76:79], a[28:31], v[60:63], v[76:79]
    ds_read_b128 v[140:143], v6 offset:0
    ds_read_b64_tr_b16 a[226:227], v195 offset:33024
    v_cvt_pk_bf16_f32 v113, v66, v67
    v_cvt_pk_bf16_f32 v114, v68, v69
    v_mfma_f32_16x16x32_bf16 v[64:67], a[0:3], v[32:35], -4.0
    ds_read_b64_tr_b16 a[228:229], v195 offset:16648
    v_exp_f32 v70, v70
    v_exp_f32 v72, v72
    v_mfma_f32_16x16x32_bf16 v[64:67], a[4:7], v[36:39], v[64:67]
    ds_read_b128 v[48:51], v1 offset:29120
    ds_read_b64_tr_b16 a[230:231], v195 offset:33032
    v_mfma_f32_16x16x32_bf16 v[64:67], a[8:11], v[40:43], v[64:67]
    ds_read_b128 v[52:55], v1 offset:29376
    v_exp_f32 v71, v71
    v_exp_f32 v73, v73
    v_mfma_f32_16x16x32_bf16 v[64:67], a[12:15], v[44:47], v[64:67]
    s_waitcnt lgkmcnt(1)
    ds_read_b128 v[56:59], v1 offset:29632
    v_cvt_pk_bf16_f32 v115, v70, v71
    v_cvt_pk_bf16_f32 v116, v72, v73
    v_mfma_f32_16x16x32_bf16 v[80:83], a[128:131], v[96:99], 0
    s_barrier
    ds_write_b128 v3, v[112:115] offset:4096
    ds_read_b128 v[60:63], v1 offset:29888
    v_exp_f32 v74, v74
    v_mov_b32 v249, v20
    v_mfma_f32_16x16x32_bf16 v[80:83], a[160:163], v[132:135], v[80:83]
    s_waitcnt vmcnt(3)
    v_exp_f32 v75, v75
    v_mfma_f32_16x16x32_bf16 v[80:83], a[192:195], v[136:139], v[80:83]
    v_exp_f32 v76, v76
    v_accvgpr_read_b32 v232, a128
    v_mfma_f32_16x16x32_bf16 v[80:83], a[224:227], v[140:143], v[80:83]
    v_cvt_pk_bf16_f32 v117, v74, v75
    v_accvgpr_read_b32 v233, a129
    v_mfma_f32_16x16x32_bf16 v[68:71], a[16:19], v[32:35], -4.0
    v_exp_f32 v77, v77
    v_mfma_f32_16x16x32_bf16 v[68:71], a[20:23], v[36:39], v[68:71]
    v_cvt_pk_bf16_f32 v118, v76, v77
    v_accvgpr_read_b32 v234, a130
    v_mfma_f32_16x16x32_bf16 v[68:71], a[24:27], v[40:43], v[68:71]
    v_exp_f32 v78, v78
    v_exp_f32 v64, v64
    v_mfma_f32_16x16x32_bf16 v[68:71], a[28:31], v[44:47], v[68:71]
    v_exp_f32 v79, v79
    v_mfma_f32_16x16x32_bf16 v[84:87], a[132:135], v[96:99], 0
    buffer_load_dwordx4 v0, s[12:15], s66 offen offset:2048 nt lds
    v_exp_f32 v65, v65
    v_accvgpr_read_b32 v235, a131
    v_mfma_f32_16x16x32_bf16 v[84:87], a[164:167], v[132:135], v[84:87]
    ds_read_b128 v[148:151], v4 offset:1024
    ds_read_b128 v[32:35], v1 offset:33280
    v_cvt_pk_bf16_f32 v119, v78, v79
    v_cvt_pk_bf16_f32 v120, v64, v65
    v_mfma_f32_16x16x32_bf16 v[84:87], a[196:199], v[136:139], v[84:87]
    ds_write_b128 v3, v[116:119] offset:5120
    ds_read_b128 v[152:155], v5 offset:1024
    ds_read_b128 v[36:39], v1 offset:33536
    v_exp_f32 v66, v66
    v_max3_f32 v236, |v232|, |v233|, |v234|
    v_mfma_f32_16x16x32_bf16 v[84:87], a[228:231], v[140:143], v[84:87]
    s_waitcnt lgkmcnt(5)
    ds_read_b128 v[156:159], v6 offset:1024
    ds_read_b128 v[40:43], v1 offset:33792
    v_mfma_f32_16x16x32_bf16 v[72:75], a[0:3], v[48:51], -4.0
    ds_read_b128 v[44:47], v1 offset:34048
    v_exp_f32 v67, v67
    v_max_f32 v236, v236, |v235|
    v_mfma_f32_16x16x32_bf16 v[72:75], a[4:7], v[52:55], v[72:75]
    v_cvt_pk_bf16_f32 v121, v66, v67
    v_mov_b32 v238, v236
    v_mfma_f32_16x16x32_bf16 v[72:75], a[8:11], v[56:59], v[72:75]
    v_exp_f32 v68, v68
    v_mfma_f32_16x16x32_bf16 v[72:75], a[12:15], v[60:63], v[72:75]
    s_waitcnt lgkmcnt(2)
    v_exp_f32 v69, v69
    v_mfma_f32_16x16x32_bf16 v[88:91], a[128:131], v[100:103], 0
    s_waitcnt vmcnt(3)
    v_permlane32_swap_b32 v236, v238
    v_cvt_pk_bf16_f32 v122, v68, v69
    v_mfma_f32_16x16x32_bf16 v[88:91], a[160:163], v[148:151], v[88:91]
    v_exp_f32 v70, v70
    v_mfma_f32_16x16x32_bf16 v[88:91], a[192:195], v[152:155], v[88:91]
    ds_read_b128 v[132:135], v4 offset:2048
    v_max_f32 v236, v236, v238
    v_mfma_f32_16x16x32_bf16 v[88:91], a[224:227], v[156:159], v[88:91]
    v_exp_f32 v71, v71
    v_mfma_f32_16x16x32_bf16 v[20:23], v[24:27], v[112:115], 0
    v_mov_b32 v238, v236
    v_cvt_pk_bf16_f32 v123, v70, v71
    v_mfma_f32_16x16x32_bf16 v[20:23], v[28:31], v[116:119], v[20:23]
    ds_write_b128 v3, v[120:123] offset:6144
    v_mfma_f32_16x16x32_bf16 v[76:79], a[16:19], v[48:51], -4.0
    v_exp_f32 v72, v72
    v_permlane16_swap_b32 v236, v238
    v_mfma_f32_16x16x32_bf16 v[76:79], a[20:23], v[52:55], v[76:79]
    v_exp_f32 v73, v73
    v_mfma_f32_16x16x32_bf16 v[76:79], a[24:27], v[56:59], v[76:79]
    buffer_load_dwordx4 v0, s[12:15], s66 offen offset:3072 nt lds
    s_add_u32 m0, s72, 124800
    v_max_f32 v236, v236, v238
    v_mfma_f32_16x16x32_bf16 v[76:79], a[28:31], v[60:63], v[76:79]
    buffer_load_dwordx4 v0, s[12:15], s67 offen offset:0 nt lds
    buffer_load_dwordx4 v0, s[12:15], s67 offen offset:1024 nt lds
    buffer_load_dwordx4 v0, s[12:15], s67 offen offset:2048 nt lds
    buffer_load_dwordx4 v0, s[12:15], s67 offen offset:3072 nt lds
    v_cvt_pk_bf16_f32 v124, v72, v73
    v_mfma_f32_16x16x32_bf16 v[92:95], a[132:135], v[100:103], 0
    v_exp_f32 v74, v74
    v_accvgpr_read_b32 v232, a132
    v_mfma_f32_16x16x32_bf16 v[92:95], a[164:167], v[148:151], v[92:95]
    ds_read_b128 v[48:51], v1 offset:37440
    ds_read_b128 v[136:139], v5 offset:2048
    v_mfma_f32_16x16x32_bf16 v[92:95], a[196:199], v[152:155], v[92:95]
    s_waitcnt lgkmcnt(4)
    ds_read_b128 v[52:55], v1 offset:37696
    v_exp_f32 v75, v75
    v_accvgpr_read_b32 v233, a133
    v_mfma_f32_16x16x32_bf16 v[92:95], a[228:231], v[156:159], v[92:95]
    s_barrier
    ds_read_b128 v[140:143], v6 offset:2048
    ds_read_b128 v[56:59], v1 offset:37952
    v_cvt_pk_bf16_f32 v125, v74, v75
    v_mfma_f32_16x16x32_bf16 v[64:67], a[0:3], v[32:35], -4.0
    ds_read_b128 v[60:63], v1 offset:38208
    v_mov_b32 v250, v20
    v_accvgpr_read_b32 v234, a134
    v_mfma_f32_16x16x32_bf16 v[64:67], a[4:7], v[36:39], v[64:67]
    v_exp_f32 v76, v76
    v_mfma_f32_16x16x32_bf16 v[64:67], a[8:11], v[40:43], v[64:67]
    ds_read_b128 v[148:151], v4 offset:3072
    v_accvgpr_read_b32 v235, a135
    v_mfma_f32_16x16x32_bf16 v[64:67], a[12:15], v[44:47], v[64:67]
    s_waitcnt lgkmcnt(3)
    v_exp_f32 v77, v77
    v_mfma_f32_16x16x32_bf16 v[176:179], a[128:131], v[104:107], 0
    v_max3_f32 v237, |v232|, |v233|, |v234|
    v_cvt_pk_bf16_f32 v126, v76, v77
    v_mfma_f32_16x16x32_bf16 v[176:179], a[160:163], v[132:135], v[176:179]
    v_exp_f32 v78, v78
    v_mfma_f32_16x16x32_bf16 v[176:179], a[192:195], v[136:139], v[176:179]
    ds_read_b128 v[152:155], v5 offset:3072
    v_max_f32 v237, v237, |v235|
    v_mfma_f32_16x16x32_bf16 v[176:179], a[224:227], v[140:143], v[176:179]
    v_exp_f32 v79, v79
    v_mfma_f32_16x16x32_bf16 v[68:71], a[16:19], v[32:35], -4.0
    v_mov_b32 v238, v237
    v_cvt_pk_bf16_f32 v127, v78, v79
    v_mfma_f32_16x16x32_bf16 v[68:71], a[20:23], v[36:39], v[68:71]
    ds_write_b128 v3, v[124:127] offset:7168
    v_mfma_f32_16x16x32_bf16 v[68:71], a[24:27], v[40:43], v[68:71]
    v_exp_f32 v64, v64
    v_permlane32_swap_b32 v237, v238
    v_mfma_f32_16x16x32_bf16 v[68:71], a[28:31], v[44:47], v[68:71]
    v_exp_f32 v65, v65
    v_mfma_f32_16x16x32_bf16 v[180:183], a[132:135], v[104:107], 0
    v_max_f32 v237, v237, v238
    v_cvt_pk_bf16_f32 v96, v64, v65
    v_mfma_f32_16x16x32_bf16 v[180:183], a[164:167], v[132:135], v[180:183]
    ds_read_b128 v[32:35], v1 offset:0
    ds_read_b128 v[36:39], v1 offset:256
    v_mfma_f32_16x16x32_bf16 v[180:183], a[196:199], v[136:139], v[180:183]
    v_exp_f32 v66, v66
    v_mov_b32 v238, v237
    v_mfma_f32_16x16x32_bf16 v[180:183], a[228:231], v[140:143], v[180:183]
    s_waitcnt lgkmcnt(5)
    ds_read_b128 v[156:159], v6 offset:3072
    ds_read_b128 v[40:43], v1 offset:512
    v_mfma_f32_16x16x32_bf16 v[72:75], a[0:3], v[48:51], -4.0
    ds_read_b128 v[44:47], v1 offset:768
    v_exp_f32 v67, v67
    v_permlane16_swap_b32 v237, v238
    v_mfma_f32_16x16x32_bf16 v[72:75], a[4:7], v[52:55], v[72:75]
    v_cvt_pk_bf16_f32 v97, v66, v67
    v_max_f32 v237, v237, v238
    v_mfma_f32_16x16x32_bf16 v[72:75], a[8:11], v[56:59], v[72:75]
    v_exp_f32 v68, v68
    v_mfma_f32_16x16x32_bf16 v[72:75], a[12:15], v[60:63], v[72:75]
    s_waitcnt lgkmcnt(2)
    v_exp_f32 v69, v69
    v_mfma_f32_16x16x32_bf16 v[184:187], a[128:131], v[108:111], 0
    v_min_f32 v238, v236, v237
    v_cvt_pk_bf16_f32 v98, v68, v69
    v_mfma_f32_16x16x32_bf16 v[184:187], a[160:163], v[148:151], v[184:187]
    v_exp_f32 v70, v70
    v_mfma_f32_16x16x32_bf16 v[184:187], a[192:195], v[152:155], v[184:187]
    ds_read_b128 a[32:35], v255 offset:0
    v_min_f32_dpp v238, v238, v238 row_ror:8 row_mask:0xf bank_mask:0xf
    v_mfma_f32_16x16x32_bf16 v[184:187], a[224:227], v[156:159], v[184:187]
    v_exp_f32 v71, v71
    v_mfma_f32_16x16x32_bf16 v[20:23], v[24:27], v[120:123], 0
    v_min_f32_dpp v238, v238, v238 row_ror:4 row_mask:0xf bank_mask:0xf
    v_cvt_pk_bf16_f32 v99, v70, v71
    v_mfma_f32_16x16x32_bf16 v[20:23], v[28:31], v[124:127], v[20:23]
    ds_read_b128 a[36:39], v255 offset:256
    v_min_f32_dpp v238, v238, v238 row_ror:2 row_mask:0xf bank_mask:0xf
    v_mfma_f32_16x16x32_bf16 v[76:79], a[16:19], v[48:51], -4.0
    ds_write_b128 v3, v[96:99] offset:0
    ds_read_b128 a[40:43], v255 offset:512
    v_exp_f32 v72, v72
    v_mfma_f32_16x16x32_bf16 v[76:79], a[20:23], v[52:55], v[76:79]
    ds_read_b128 a[44:47], v255 offset:768
    v_min_f32_dpp v238, v238, v238 row_ror:1 row_mask:0xf bank_mask:0xf
    v_mfma_f32_16x16x32_bf16 v[76:79], a[24:27], v[56:59], v[76:79]
    ds_read_b128 a[48:51], v255 offset:4160
    v_exp_f32 v73, v73
    v_mfma_f32_16x16x32_bf16 v[76:79], a[28:31], v[60:63], v[76:79]
    ds_read_b128 a[52:55], v255 offset:4416
    v_cvt_pk_bf16_f32 v100, v72, v73
    v_mfma_f32_16x16x32_bf16 v[188:191], a[132:135], v[108:111], 0
    ds_read_b128 a[56:59], v255 offset:4672
    v_exp_f32 v74, v74
    v_min_f32 v238, 0x5d800000, v238
    v_mfma_f32_16x16x32_bf16 v[188:191], a[164:167], v[148:151], v[188:191]
    ds_read_b128 v[132:135], v4 offset:4096
    ds_read_b128 v[48:51], v1 offset:4160
    ds_read_b128 a[60:63], v255 offset:4928
    v_mfma_f32_16x16x32_bf16 v[188:191], a[196:199], v[152:155], v[188:191]
    ds_read_b128 v[136:139], v5 offset:4096
    ds_read_b128 v[52:55], v1 offset:4416
    v_exp_f32 v75, v75
    v_and_b32 v238, 0x7f800000, v238
    v_mfma_f32_16x16x32_bf16 v[188:191], a[228:231], v[156:159], v[188:191]
    s_barrier
    ds_read_b128 v[140:143], v6 offset:4096
    ds_read_b128 v[56:59], v1 offset:4672
    v_cvt_pk_bf16_f32 v101, v74, v75
    s_waitcnt lgkmcnt(0)
    v_mfma_f32_16x16x32_bf16 v[192:195], a[152:155], a[32:35], 0
    s_add_u32 m0, s54, 0
    s_add_u32 s45, s44, 16384
    buffer_load_dwordx4 v7, s[8:11], s45 offen offset:0 nt lds
    s_nop 1
    v_mfma_f32_16x16x32_bf16 v[192:195], a[184:187], a[32:35], v[192:195]
    s_nop 1
    v_mfma_f32_16x16x32_bf16 v[196:199], a[156:159], a[32:35], 0
    s_nop 1
    v_mfma_f32_16x16x32_bf16 v[196:199], a[188:191], a[32:35], v[196:199]
    s_nop 1
    v_mfma_f32_16x16x32_bf16 v[16:19], a[152:155], a[36:39], 0
    buffer_load_dwordx4 v7, s[8:11], s45 offen offset:1024 nt lds
    v_cvt_pk_bf16_f32 v192, v192, v193
    v_cvt_pk_bf16_f32 v193, v194, v195
    v_mfma_f32_16x16x32_bf16 v[16:19], a[184:187], a[36:39], v[16:19]
    v_accvgpr_write_b32 a32, v192
    v_accvgpr_write_b32 a33, v193
    v_mfma_f32_16x16x32_bf16 v[192:195], a[156:159], a[36:39], 0
    v_cvt_pk_bf16_f32 v196, v196, v197
    v_cvt_pk_bf16_f32 v197, v198, v199
    v_mfma_f32_16x16x32_bf16 v[192:195], a[188:191], a[36:39], v[192:195]
    v_accvgpr_write_b32 a34, v196
    v_accvgpr_write_b32 a35, v197
    v_mfma_f32_16x16x32_bf16 v[196:199], a[152:155], a[40:43], 0
    s_add_u32 m0, s54, 2080
    s_add_u32 s45, s44, 18432
    buffer_load_dwordx4 v7, s[8:11], s45 offen offset:0 nt lds
    v_cvt_pk_bf16_f32 v16, v16, v17
    v_cvt_pk_bf16_f32 v17, v18, v19
    v_mfma_f32_16x16x32_bf16 v[196:199], a[184:187], a[40:43], v[196:199]
    v_accvgpr_write_b32 a36, v16
    v_accvgpr_write_b32 a37, v17
    v_mfma_f32_16x16x32_bf16 v[16:19], a[156:159], a[40:43], 0
    v_cvt_pk_bf16_f32 v192, v192, v193
    v_cvt_pk_bf16_f32 v193, v194, v195
    v_mfma_f32_16x16x32_bf16 v[16:19], a[188:191], a[40:43], v[16:19]
    v_accvgpr_write_b32 a38, v192
    v_accvgpr_write_b32 a39, v193
    v_mfma_f32_16x16x32_bf16 v[192:195], a[152:155], a[44:47], 0
    buffer_load_dwordx4 v7, s[8:11], s45 offen offset:1024 nt lds
    v_cvt_pk_bf16_f32 v196, v196, v197
    v_cvt_pk_bf16_f32 v197, v198, v199
    v_mfma_f32_16x16x32_bf16 v[192:195], a[184:187], a[44:47], v[192:195]
    v_accvgpr_write_b32 a40, v196
    v_accvgpr_write_b32 a41, v197
    v_mfma_f32_16x16x32_bf16 v[196:199], a[156:159], a[44:47], 0
    v_cvt_pk_bf16_f32 v16, v16, v17
    v_cvt_pk_bf16_f32 v17, v18, v19
    v_mfma_f32_16x16x32_bf16 v[196:199], a[188:191], a[44:47], v[196:199]
    v_accvgpr_write_b32 a42, v16
    v_accvgpr_write_b32 a43, v17
    v_mfma_f32_16x16x32_bf16 v[16:19], a[152:155], a[48:51], 0
    s_add_u32 m0, s54, 4160
    s_add_u32 s45, s44, 20480
    buffer_load_dwordx4 v7, s[8:11], s45 offen offset:0 nt lds
    v_cvt_pk_bf16_f32 v192, v192, v193
    v_cvt_pk_bf16_f32 v193, v194, v195
    v_mfma_f32_16x16x32_bf16 v[16:19], a[184:187], a[48:51], v[16:19]
    v_accvgpr_write_b32 a44, v192
    v_accvgpr_write_b32 a45, v193
    v_mfma_f32_16x16x32_bf16 v[192:195], a[156:159], a[48:51], 0
    v_cvt_pk_bf16_f32 v196, v196, v197
    v_cvt_pk_bf16_f32 v197, v198, v199
    v_mfma_f32_16x16x32_bf16 v[192:195], a[188:191], a[48:51], v[192:195]
    v_accvgpr_write_b32 a46, v196
    v_accvgpr_write_b32 a47, v197
    v_mfma_f32_16x16x32_bf16 v[196:199], a[152:155], a[52:55], 0
    buffer_load_dwordx4 v7, s[8:11], s45 offen offset:1024 nt lds
    v_cvt_pk_bf16_f32 v16, v16, v17
    v_cvt_pk_bf16_f32 v17, v18, v19
    v_mfma_f32_16x16x32_bf16 v[196:199], a[184:187], a[52:55], v[196:199]
    v_accvgpr_write_b32 a48, v16
    v_accvgpr_write_b32 a49, v17
    v_mfma_f32_16x16x32_bf16 v[16:19], a[156:159], a[52:55], 0
    v_cvt_pk_bf16_f32 v192, v192, v193
    v_cvt_pk_bf16_f32 v193, v194, v195
    v_mfma_f32_16x16x32_bf16 v[16:19], a[188:191], a[52:55], v[16:19]
    v_accvgpr_write_b32 a50, v192
    v_accvgpr_write_b32 a51, v193
    v_mfma_f32_16x16x32_bf16 v[192:195], a[152:155], a[56:59], 0
    s_add_u32 m0, s54, 6240
    s_add_u32 s45, s44, 22528
    buffer_load_dwordx4 v7, s[8:11], s45 offen offset:0 nt lds
    v_cvt_pk_bf16_f32 v196, v196, v197
    v_cvt_pk_bf16_f32 v197, v198, v199
    v_mfma_f32_16x16x32_bf16 v[192:195], a[184:187], a[56:59], v[192:195]
    v_accvgpr_write_b32 a52, v196
    v_accvgpr_write_b32 a53, v197
    v_mfma_f32_16x16x32_bf16 v[196:199], a[156:159], a[56:59], 0
    v_cvt_pk_bf16_f32 v16, v16, v17
    v_cvt_pk_bf16_f32 v17, v18, v19
    v_mfma_f32_16x16x32_bf16 v[196:199], a[188:191], a[56:59], v[196:199]
    v_accvgpr_write_b32 a54, v16
    v_accvgpr_write_b32 a55, v17
    v_mfma_f32_16x16x32_bf16 v[16:19], a[152:155], a[60:63], 0
    buffer_load_dwordx4 v7, s[8:11], s45 offen offset:1024 nt lds
    v_cvt_pk_bf16_f32 v192, v192, v193
    v_cvt_pk_bf16_f32 v193, v194, v195
    v_mfma_f32_16x16x32_bf16 v[16:19], a[184:187], a[60:63], v[16:19]
    v_accvgpr_write_b32 a56, v192
    v_accvgpr_write_b32 a57, v193
    v_mfma_f32_16x16x32_bf16 v[192:195], a[156:159], a[60:63], 0
    v_cvt_pk_bf16_f32 v196, v196, v197
    v_cvt_pk_bf16_f32 v197, v198, v199
    v_mfma_f32_16x16x32_bf16 v[192:195], a[188:191], a[60:63], v[192:195]
    v_accvgpr_write_b32 a58, v196
    v_accvgpr_write_b32 a59, v197
    v_mfma_f32_16x16x32_bf16 v[64:67], a[32:35], v[32:35], -4.0
    ds_read_b128 v[60:63], v1 offset:4928
    v_cvt_pk_bf16_f32 v16, v16, v17
    v_cvt_pk_bf16_f32 v17, v18, v19
    v_accvgpr_write_b32 a60, v16
    v_accvgpr_write_b32 a61, v17
    v_cvt_pk_bf16_f32 v192, v192, v193
    v_cvt_pk_bf16_f32 v193, v194, v195
    v_accvgpr_write_b32 a62, v192
    v_accvgpr_write_b32 a63, v193
    v_mov_b32 v251, v20
    v_add_u32 v240, 0x1400000, v238
    v_mfma_f32_16x16x32_bf16 v[64:67], a[36:39], v[36:39], v[64:67]
    v_exp_f32 v76, v76
    v_mfma_f32_16x16x32_bf16 v[64:67], a[40:43], v[40:43], v[64:67]
    ds_read_b128 v[148:151], v4 offset:5120
    v_add_u32 v241, 0x1400000, v238
    v_mfma_f32_16x16x32_bf16 v[64:67], a[44:47], v[44:47], v[64:67]
    v_exp_f32 v77, v77
    v_mfma_f32_16x16x32_bf16 v[200:203], a[128:131], v[112:115], 0
    v_add_u32 v242, 0x1400000, v238
    v_cvt_pk_bf16_f32 v102, v76, v77
    v_mfma_f32_16x16x32_bf16 v[200:203], a[160:163], v[132:135], v[200:203]
    v_exp_f32 v78, v78
    v_mfma_f32_16x16x32_bf16 v[200:203], a[192:195], v[136:139], v[200:203]
    ds_read_b128 v[152:155], v5 offset:5120
    v_add_u32 v243, 0x1400000, v238
    v_mfma_f32_16x16x32_bf16 v[200:203], a[224:227], v[140:143], v[200:203]
    v_exp_f32 v79, v79
    v_mfma_f32_16x16x32_bf16 v[68:71], a[48:51], v[32:35], -4.0
    ds_read_b128 v[32:35], v1 offset:8320
    v_cvt_pk_bf16_f32 v103, v78, v79
    v_mfma_f32_16x16x32_bf16 v[68:71], a[52:55], v[36:39], v[68:71]
    ds_write_b128 v3, v[100:103] offset:1024
    v_mfma_f32_16x16x32_bf16 v[68:71], a[56:59], v[40:43], v[68:71]
    v_exp_f32 v64, v64
    v_mfma_f32_16x16x32_bf16 v[68:71], a[60:63], v[44:47], v[68:71]
    v_exp_f32 v65, v65
    v_mfma_f32_16x16x32_bf16 v[204:207], a[132:135], v[112:115], 0
    ds_read_b128 v[36:39], v1 offset:8576
    v_cvt_pk_bf16_f32 v104, v64, v65
    v_mfma_f32_16x16x32_bf16 v[204:207], a[164:167], v[132:135], v[204:207]
    v_exp_f32 v66, v66
    v_mfma_f32_16x16x32_bf16 v[204:207], a[196:199], v[136:139], v[204:207]
    ds_read_b128 v[156:159], v6 offset:5120
    ds_read_b128 v[40:43], v1 offset:8832
    v_mfma_f32_16x16x32_bf16 v[204:207], a[228:231], v[140:143], v[204:207]
    s_waitcnt lgkmcnt(7)
    v_exp_f32 v67, v67
    v_mfma_f32_16x16x32_bf16 v[72:75], a[32:35], v[48:51], -4.0
    ds_read_b128 v[44:47], v1 offset:9088
    v_cvt_pk_bf16_f32 v105, v66, v67
    v_mfma_f32_16x16x32_bf16 v[72:75], a[36:39], v[52:55], v[72:75]
    v_exp_f32 v68, v68
    v_mfma_f32_16x16x32_bf16 v[72:75], a[40:43], v[56:59], v[72:75]
    v_exp_f32 v69, v69
    v_mfma_f32_16x16x32_bf16 v[72:75], a[44:47], v[60:63], v[72:75]
    s_waitcnt lgkmcnt(2)
    ds_read_b128 v[132:135], v4 offset:6144
    v_cvt_pk_bf16_f32 v106, v68, v69
    v_mfma_f32_16x16x32_bf16 v[208:211], a[128:131], v[116:119], 0
    v_exp_f32 v70, v70
    v_mfma_f32_16x16x32_bf16 v[208:211], a[160:163], v[148:151], v[208:211]
    v_exp_f32 v71, v71
    v_mfma_f32_16x16x32_bf16 v[208:211], a[192:195], v[152:155], v[208:211]
    ds_read_b128 v[136:139], v5 offset:6144
    v_cvt_pk_bf16_f32 v107, v70, v71
    v_mfma_f32_16x16x32_bf16 v[208:211], a[224:227], v[156:159], v[208:211]
    ds_write_b128 v3, v[104:107] offset:2048
    v_mfma_f32_16x16x32_bf16 v[20:23], v[24:27], v[96:99], 0
    v_exp_f32 v72, v72
    v_mfma_f32_16x16x32_bf16 v[20:23], v[28:31], v[100:103], v[20:23]
    v_exp_f32 v73, v73
    v_mfma_f32_16x16x32_bf16 v[76:79], a[48:51], v[48:51], -4.0
    s_add_u32 m0, s72, 141184
    ds_read_b128 v[48:51], v1 offset:12480
    v_cvt_pk_bf16_f32 v108, v72, v73
    v_mfma_f32_16x16x32_bf16 v[76:79], a[52:55], v[52:55], v[76:79]
    v_exp_f32 v74, v74
    v_mfma_f32_16x16x32_bf16 v[76:79], a[56:59], v[56:59], v[76:79]
    v_exp_f32 v75, v75
    v_mfma_f32_16x16x32_bf16 v[76:79], a[60:63], v[60:63], v[76:79]
    ds_read_b128 v[52:55], v1 offset:12736
    v_cvt_pk_bf16_f32 v109, v74, v75
    v_mfma_f32_16x16x32_bf16 v[212:215], a[132:135], v[116:119], 0
    ds_read_b128 v[140:143], v6 offset:6144
    ds_read_b128 v[56:59], v1 offset:12992
    v_mfma_f32_16x16x32_bf16 v[212:215], a[164:167], v[148:151], v[212:215]
    ds_read_b128 v[60:63], v1 offset:13248
    v_mov_b32 v252, v20
    v_mfma_f32_16x16x32_bf16 v[212:215], a[196:199], v[152:155], v[212:215]
    s_waitcnt lgkmcnt(8)
    buffer_load_dwordx4 v0, s[12:15], s68 offen offset:0 nt lds
    v_mfma_f32_16x16x32_bf16 v[212:215], a[228:231], v[156:159], v[212:215]
    s_barrier
    v_exp_f32 v76, v76
    v_mfma_f32_16x16x32_bf16 v[64:67], a[32:35], v[32:35], -4.0
    v_exp_f32 v77, v77
    v_mfma_f32_16x16x32_bf16 v[64:67], a[36:39], v[36:39], v[64:67]
    v_add_u32 v192, s50, v15
    v_cvt_pk_bf16_f32 v110, v76, v77
    v_mfma_f32_16x16x32_bf16 v[64:67], a[40:43], v[40:43], v[64:67]
    v_add_u32 v193, s51, v15
    v_add_u32 v194, s52, v15
    v_mfma_f32_16x16x32_bf16 v[64:67], a[44:47], v[44:47], v[64:67]
    s_waitcnt lgkmcnt(2)
    v_exp_f32 v78, v78
    v_mfma_f32_16x16x32_bf16 v[216:219], a[128:131], v[120:123], 0
    ds_read_b128 v[148:151], v4 offset:7168
    v_add_u32 v195, s53, v15
    v_mfma_f32_16x16x32_bf16 v[216:219], a[160:163], v[132:135], v[216:219]
    v_exp_f32 v79, v79
    v_mfma_f32_16x16x32_bf16 v[216:219], a[192:195], v[136:139], v[216:219]
    ds_read_b128 v[152:155], v5 offset:7168
    v_cvt_pk_bf16_f32 v111, v78, v79
    v_mfma_f32_16x16x32_bf16 v[216:219], a[224:227], v[140:143], v[216:219]
    buffer_load_dwordx4 v0, s[12:15], s68 offen offset:1024 nt lds
    v_mfma_f32_16x16x32_bf16 v[68:71], a[48:51], v[32:35], -4.0
    ds_write_b128 v3, v[108:111] offset:3072
    v_mfma_f32_16x16x32_bf16 v[68:71], a[52:55], v[36:39], v[68:71]
    v_exp_f32 v64, v64
    v_mfma_f32_16x16x32_bf16 v[68:71], a[56:59], v[40:43], v[68:71]
    v_exp_f32 v65, v65
    v_mfma_f32_16x16x32_bf16 v[68:71], a[60:63], v[44:47], v[68:71]
    ds_read_b128 v[32:35], v1 offset:16640
    v_cvt_pk_bf16_f32 v112, v64, v65
    v_mfma_f32_16x16x32_bf16 v[220:223], a[132:135], v[120:123], 0
    v_exp_f32 v66, v66
    v_mfma_f32_16x16x32_bf16 v[220:223], a[164:167], v[132:135], v[220:223]
    ds_read_b128 v[36:39], v1 offset:16896
    ds_read_b128 v[156:159], v6 offset:7168
    v_mfma_f32_16x16x32_bf16 v[220:223], a[196:199], v[136:139], v[220:223]
    ds_read_b128 v[40:43], v1 offset:17152
    ds_read_b128 v[44:47], v1 offset:17408
    v_mfma_f32_16x16x32_bf16 v[220:223], a[228:231], v[140:143], v[220:223]
    s_waitcnt lgkmcnt(8)
    v_exp_f32 v67, v67
    v_mfma_f32_16x16x32_bf16 v[72:75], a[32:35], v[48:51], -4.0
    ds_read_b128 v[132:135], v4 offset:0
    v_cvt_pk_bf16_f32 v113, v66, v67
    v_mfma_f32_16x16x32_bf16 v[72:75], a[36:39], v[52:55], v[72:75]
    v_exp_f32 v68, v68
    v_mfma_f32_16x16x32_bf16 v[72:75], a[40:43], v[56:59], v[72:75]
    buffer_load_dwordx4 v0, s[12:15], s68 offen offset:2048 nt lds
    v_mfma_f32_16x16x32_bf16 v[72:75], a[44:47], v[60:63], v[72:75]
    s_waitcnt lgkmcnt(3)
    v_exp_f32 v69, v69
    v_mfma_f32_16x16x32_bf16 v[224:227], a[128:131], v[124:127], 0
    ds_read_b128 v[136:139], v5 offset:0
    v_cvt_pk_bf16_f32 v114, v68, v69
    v_mfma_f32_16x16x32_bf16 v[224:227], a[160:163], v[148:151], v[224:227]
    v_exp_f32 v70, v70
    v_mfma_f32_16x16x32_bf16 v[224:227], a[192:195], v[152:155], v[224:227]
    v_exp_f32 v71, v71
    v_mfma_f32_16x16x32_bf16 v[224:227], a[224:227], v[156:159], v[224:227]
    ds_read_b128 v[140:143], v6 offset:0
    v_cvt_pk_bf16_f32 v115, v70, v71
    v_mfma_f32_16x16x32_bf16 v[20:23], v[24:27], v[104:107], 0
    ds_write_b128 v3, v[112:115] offset:4096
    v_mfma_f32_16x16x32_bf16 v[20:23], v[28:31], v[108:111], v[20:23]
    v_exp_f32 v72, v72
    v_mfma_f32_16x16x32_bf16 v[76:79], a[48:51], v[48:51], -4.0
    buffer_load_dwordx4 v0, s[12:15], s68 offen offset:3072 nt lds
    v_mfma_f32_16x16x32_bf16 v[76:79], a[52:55], v[52:55], v[76:79]
    v_exp_f32 v73, v73
    v_mfma_f32_16x16x32_bf16 v[76:79], a[56:59], v[56:59], v[76:79]
    ds_read_b128 v[48:51], v1 offset:20800
    v_cvt_pk_bf16_f32 v116, v72, v73
    v_mfma_f32_16x16x32_bf16 v[76:79], a[60:63], v[60:63], v[76:79]
    v_exp_f32 v74, v74
    v_mfma_f32_16x16x32_bf16 v[228:231], a[132:135], v[124:127], 0
    v_exp_f32 v75, v75
    v_mfma_f32_16x16x32_bf16 v[228:231], a[164:167], v[148:151], v[228:231]
    ds_read_b128 v[52:55], v1 offset:21056
    v_cvt_pk_bf16_f32 v117, v74, v75
    v_mfma_f32_16x16x32_bf16 v[228:231], a[196:199], v[152:155], v[228:231]
    s_waitcnt vmcnt(12) lgkmcnt(6)
    ds_read_b128 v[56:59], v1 offset:21312
    v_add_f32 v248, v248, v20
    v_mfma_f32_16x16x32_bf16 v[228:231], a[228:231], v[156:159], v[228:231]
    s_barrier
    ds_read_b128 v[60:63], v1 offset:21568
    ds_read_b64_tr_b16 a[136:137], v192 offset:0
    v_mfma_f32_16x16x32_bf16 v[64:67], a[32:35], v[32:35], -4.0
    v_exp_f32 v76, v76
    v_mfma_f32_16x16x32_bf16 v[64:67], a[36:39], v[36:39], v[64:67]
    v_exp_f32 v77, v77
    v_mfma_f32_16x16x32_bf16 v[64:67], a[40:43], v[40:43], v[64:67]
    ds_read_b64_tr_b16 a[138:139], v192 offset:16640
    v_cvt_pk_bf16_f32 v118, v76, v77
    v_mfma_f32_16x16x32_bf16 v[64:67], a[44:47], v[44:47], v[64:67]
    s_waitcnt lgkmcnt(7)
    v_exp_f32 v78, v78
    v_mfma_f32_16x16x32_bf16 v[160:163], a[128:131], v[96:99], v[240:243]
    ds_read_b64_tr_b16 a[140:141], v192 offset:8
    ds_read_b64_tr_b16 a[142:143], v192 offset:16648
    v_mfma_f32_16x16x32_bf16 v[160:163], a[160:163], v[132:135], v[160:163]
    v_exp_f32 v79, v79
    v_mfma_f32_16x16x32_bf16 v[160:163], a[192:195], v[136:139], v[160:163]
    ds_read_b64_tr_b16 a[168:169], v193 offset:0
    v_cvt_pk_bf16_f32 v119, v78, v79
    v_mfma_f32_16x16x32_bf16 v[160:163], a[224:227], v[140:143], v[160:163]
    ds_read_b64_tr_b16 a[170:171], v193 offset:16640
    ds_read_b64_tr_b16 a[172:173], v193 offset:8
    v_mfma_f32_16x16x32_bf16 v[68:71], a[48:51], v[32:35], -4.0
    ds_write_b128 v3, v[116:119] offset:5120
    v_mfma_f32_16x16x32_bf16 v[68:71], a[52:55], v[36:39], v[68:71]
    v_exp_f32 v64, v64
    v_mfma_f32_16x16x32_bf16 v[68:71], a[56:59], v[40:43], v[68:71]
    ds_read_b64_tr_b16 a[174:175], v193 offset:16648
    ds_read_b64_tr_b16 a[200:201], v194 offset:0
    v_mfma_f32_16x16x32_bf16 v[68:71], a[60:63], v[44:47], v[68:71]
    v_exp_f32 v65, v65
    v_mfma_f32_16x16x32_bf16 v[164:167], a[132:135], v[96:99], v[240:243]
    ds_read_b128 v[148:151], v4 offset:1024
    v_cvt_pk_bf16_f32 v120, v64, v65
    v_mfma_f32_16x16x32_bf16 v[164:167], a[164:167], v[132:135], v[164:167]
    ds_read_b128 v[32:35], v1 offset:24960
    ds_read_b64_tr_b16 a[202:203], v194 offset:16640
    v_mfma_f32_16x16x32_bf16 v[164:167], a[196:199], v[136:139], v[164:167]
    ds_read_b128 v[152:155], v5 offset:1024
    ds_read_b128 v[36:39], v1 offset:25216
    ds_read_b64_tr_b16 a[204:205], v194 offset:8
    v_exp_f32 v66, v66
    v_mfma_f32_16x16x32_bf16 v[164:167], a[228:231], v[140:143], v[164:167]
    s_waitcnt lgkmcnt(14)
    ds_read_b128 v[156:159], v6 offset:1024
    ds_read_b128 v[40:43], v1 offset:25472
    ds_read_b64_tr_b16 a[206:207], v194 offset:16648
    v_mfma_f32_16x16x32_bf16 v[72:75], a[32:35], v[48:51], -4.0
    ds_read_b128 v[44:47], v1 offset:25728
    ds_read_b64_tr_b16 a[232:233], v195 offset:0
    v_exp_f32 v67, v67
    v_mfma_f32_16x16x32_bf16 v[72:75], a[36:39], v[52:55], v[72:75]
    ds_read_b64_tr_b16 a[234:235], v195 offset:16640
    v_cvt_pk_bf16_f32 v121, v66, v67
    v_mfma_f32_16x16x32_bf16 v[72:75], a[40:43], v[56:59], v[72:75]
    ds_read_b64_tr_b16 a[236:237], v195 offset:8
    v_exp_f32 v68, v68
    v_mfma_f32_16x16x32_bf16 v[72:75], a[44:47], v[60:63], v[72:75]
    s_waitcnt lgkmcnt(6)
    ds_read_b64_tr_b16 a[238:239], v195 offset:16648
    ds_read_b128 v[132:135], v4 offset:2048
    v_mfma_f32_16x16x32_bf16 v[168:171], a[128:131], v[100:103], v[240:243]
    v_exp_f32 v69, v69
    v_mfma_f32_16x16x32_bf16 v[168:171], a[160:163], v[148:151], v[168:171]
    ds_read_b128 v[136:139], v5 offset:2048
    v_cvt_pk_bf16_f32 v122, v68, v69
    v_mfma_f32_16x16x32_bf16 v[168:171], a[192:195], v[152:155], v[168:171]
    v_exp_f32 v70, v70
    v_mfma_f32_16x16x32_bf16 v[168:171], a[224:227], v[156:159], v[168:171]
    v_exp_f32 v71, v71
    v_mfma_f32_16x16x32_bf16 v[20:23], v[24:27], v[112:115], 0
    ds_read_b128 v[140:143], v6 offset:2048
    v_cvt_pk_bf16_f32 v123, v70, v71
    v_mfma_f32_16x16x32_bf16 v[20:23], v[28:31], v[116:119], v[20:23]
    ds_write_b128 v3, v[120:123] offset:6144
    v_mfma_f32_16x16x32_bf16 v[76:79], a[48:51], v[48:51], -4.0
    v_exp_f32 v72, v72
    v_mfma_f32_16x16x32_bf16 v[76:79], a[52:55], v[52:55], v[76:79]
    v_exp_f32 v73, v73
    v_mfma_f32_16x16x32_bf16 v[76:79], a[56:59], v[56:59], v[76:79]
    ds_read_b128 v[48:51], v1 offset:29120
    v_cvt_pk_bf16_f32 v124, v72, v73
    v_mfma_f32_16x16x32_bf16 v[76:79], a[60:63], v[60:63], v[76:79]
    v_exp_f32 v74, v74
    v_mfma_f32_16x16x32_bf16 v[172:175], a[132:135], v[100:103], v[240:243]
    v_exp_f32 v75, v75
    v_mfma_f32_16x16x32_bf16 v[172:175], a[164:167], v[148:151], v[172:175]
    ds_read_b128 v[52:55], v1 offset:29376
    v_cvt_pk_bf16_f32 v125, v74, v75
    v_mfma_f32_16x16x32_bf16 v[172:175], a[196:199], v[152:155], v[172:175]
    s_waitcnt lgkmcnt(6)
    ds_read_b128 v[56:59], v1 offset:29632
    v_add_f32 v249, v249, v20
    v_mfma_f32_16x16x32_bf16 v[172:175], a[228:231], v[156:159], v[172:175]
    s_barrier
    ds_read_b128 v[60:63], v1 offset:29888
    ds_read_b128 v[148:151], v4 offset:3072
    v_mfma_f32_16x16x32_bf16 v[64:67], a[32:35], v[32:35], -4.0
    s_add_u32 m0, s72, 108160
    v_exp_f32 v76, v76
    v_mfma_f32_16x16x32_bf16 v[64:67], a[36:39], v[36:39], v[64:67]
    v_exp_f32 v77, v77
    v_mfma_f32_16x16x32_bf16 v[64:67], a[40:43], v[40:43], v[64:67]
    ds_read_b128 v[152:155], v5 offset:3072
    v_cvt_pk_bf16_f32 v126, v76, v77
    v_mfma_f32_16x16x32_bf16 v[64:67], a[44:47], v[44:47], v[64:67]
    s_waitcnt lgkmcnt(7)
    v_exp_f32 v78, v78
    v_mfma_f32_16x16x32_bf16 v[80:83], a[136:139], v[104:107], v[80:83]
    buffer_load_dwordx4 v0, s[12:15], s69 offen offset:0 nt lds
    v_mfma_f32_16x16x32_bf16 v[80:83], a[168:171], v[132:135], v[80:83]
    v_exp_f32 v79, v79
    v_mfma_f32_16x16x32_bf16 v[80:83], a[200:203], v[136:139], v[80:83]
    ds_read_b128 v[156:159], v6 offset:3072
    v_cvt_pk_bf16_f32 v127, v78, v79
    v_mfma_f32_16x16x32_bf16 v[80:83], a[232:235], v[140:143], v[80:83]
    ds_write_b128 v3, v[124:127] offset:7168
    v_mfma_f32_16x16x32_bf16 v[68:71], a[48:51], v[32:35], -4.0
    v_exp_f32 v64, v64
    v_mfma_f32_16x16x32_bf16 v[68:71], a[52:55], v[36:39], v[68:71]
    v_exp_f32 v65, v65
    v_mfma_f32_16x16x32_bf16 v[68:71], a[56:59], v[40:43], v[68:71]
    buffer_load_dwordx4 v0, s[12:15], s69 offen offset:1024 nt lds
    v_mfma_f32_16x16x32_bf16 v[68:71], a[60:63], v[44:47], v[68:71]
    ds_read_b128 v[32:35], v1 offset:33280
    v_cvt_pk_bf16_f32 v96, v64, v65
    v_mfma_f32_16x16x32_bf16 v[84:87], a[140:143], v[104:107], v[84:87]
    v_exp_f32 v66, v66
    v_mfma_f32_16x16x32_bf16 v[84:87], a[172:175], v[132:135], v[84:87]
    ds_read_b128 v[36:39], v1 offset:33536
    ds_read_b128 v[40:43], v1 offset:33792
    v_mfma_f32_16x16x32_bf16 v[84:87], a[204:207], v[136:139], v[84:87]
    v_exp_f32 v67, v67
    v_mfma_f32_16x16x32_bf16 v[84:87], a[236:239], v[140:143], v[84:87]
    s_waitcnt lgkmcnt(7)
    ds_read_b128 v[44:47], v1 offset:34048
    v_cvt_pk_bf16_f32 v97, v66, v67
    v_mfma_f32_16x16x32_bf16 v[72:75], a[32:35], v[48:51], -4.0
    buffer_load_dwordx4 v0, s[12:15], s69 offen offset:2048 nt lds
    v_mfma_f32_16x16x32_bf16 v[72:75], a[36:39], v[52:55], v[72:75]
    v_exp_f32 v68, v68
    v_mfma_f32_16x16x32_bf16 v[72:75], a[40:43], v[56:59], v[72:75]
    v_exp_f32 v69, v69
    v_mfma_f32_16x16x32_bf16 v[72:75], a[44:47], v[60:63], v[72:75]
    s_waitcnt lgkmcnt(5)
    ds_read_b128 v[132:135], v4 offset:4096
    v_cvt_pk_bf16_f32 v98, v68, v69
    v_mfma_f32_16x16x32_bf16 v[88:91], a[136:139], v[108:111], v[88:91]
    v_exp_f32 v70, v70
    v_mfma_f32_16x16x32_bf16 v[88:91], a[168:171], v[148:151], v[88:91]
    buffer_load_dwordx4 v0, s[12:15], s69 offen offset:3072 nt lds
    v_mfma_f32_16x16x32_bf16 v[88:91], a[200:203], v[152:155], v[88:91]
    v_exp_f32 v71, v71
    v_mfma_f32_16x16x32_bf16 v[88:91], a[232:235], v[156:159], v[88:91]
    ds_read_b128 v[136:139], v5 offset:4096
    v_cvt_pk_bf16_f32 v99, v70, v71
    v_mfma_f32_16x16x32_bf16 v[20:23], v[24:27], v[120:123], 0
    ds_write_b128 v3, v[96:99] offset:0
    v_mfma_f32_16x16x32_bf16 v[20:23], v[28:31], v[124:127], v[20:23]
    v_exp_f32 v72, v72
    v_mfma_f32_16x16x32_bf16 v[76:79], a[48:51], v[48:51], -4.0
    v_exp_f32 v73, v73
    v_mfma_f32_16x16x32_bf16 v[76:79], a[52:55], v[52:55], v[76:79]
    ds_read_b128 v[48:51], v1 offset:37440
    v_cvt_pk_bf16_f32 v100, v72, v73
    v_mfma_f32_16x16x32_bf16 v[76:79], a[56:59], v[56:59], v[76:79]
    v_exp_f32 v74, v74
    v_mfma_f32_16x16x32_bf16 v[76:79], a[60:63], v[60:63], v[76:79]
    v_exp_f32 v75, v75
    v_mfma_f32_16x16x32_bf16 v[92:95], a[140:143], v[108:111], v[92:95]
    ds_read_b128 v[52:55], v1 offset:37696
    v_cvt_pk_bf16_f32 v101, v74, v75
    v_mfma_f32_16x16x32_bf16 v[92:95], a[172:175], v[148:151], v[92:95]
    ds_read_b128 v[140:143], v6 offset:4096
    ds_read_b128 v[56:59], v1 offset:37952
    v_mfma_f32_16x16x32_bf16 v[92:95], a[204:207], v[152:155], v[92:95]
    s_waitcnt lgkmcnt(7)
    ds_read_b128 v[60:63], v1 offset:38208
    v_add_f32 v250, v250, v20
    v_mfma_f32_16x16x32_bf16 v[92:95], a[236:239], v[156:159], v[92:95]
    s_barrier
    v_exp_f32 v76, v76
    v_mfma_f32_16x16x32_bf16 v[64:67], a[32:35], v[32:35], -4.0
    v_exp_f32 v77, v77
    v_mfma_f32_16x16x32_bf16 v[64:67], a[36:39], v[36:39], v[64:67]
    ds_read_b128 v[148:151], v4 offset:5120
    v_cvt_pk_bf16_f32 v102, v76, v77
    v_mfma_f32_16x16x32_bf16 v[64:67], a[40:43], v[40:43], v[64:67]
    v_exp_f32 v78, v78
    v_mfma_f32_16x16x32_bf16 v[64:67], a[44:47], v[44:47], v[64:67]
    s_waitcnt lgkmcnt(3)
    v_exp_f32 v79, v79
    v_mfma_f32_16x16x32_bf16 v[176:179], a[136:139], v[112:115], v[176:179]
    ds_read_b128 v[152:155], v5 offset:5120
    v_cvt_pk_bf16_f32 v103, v78, v79
    v_mfma_f32_16x16x32_bf16 v[176:179], a[168:171], v[132:135], v[176:179]
    ds_write_b128 v3, v[100:103] offset:1024
    v_mfma_f32_16x16x32_bf16 v[176:179], a[200:203], v[136:139], v[176:179]
    ds_read_b128 v[156:159], v6 offset:5120
    v_mfma_f32_16x16x32_bf16 v[176:179], a[232:235], v[140:143], v[176:179]
    v_exp_f32 v64, v64
    v_mfma_f32_16x16x32_bf16 v[68:71], a[48:51], v[32:35], -4.0
    v_exp_f32 v65, v65
    v_mfma_f32_16x16x32_bf16 v[68:71], a[52:55], v[36:39], v[68:71]
    ds_read_b128 v[32:35], v1 offset:0
    v_cvt_pk_bf16_f32 v104, v64, v65
    v_mfma_f32_16x16x32_bf16 v[68:71], a[56:59], v[40:43], v[68:71]
    v_exp_f32 v66, v66
    v_mfma_f32_16x16x32_bf16 v[68:71], a[60:63], v[44:47], v[68:71]
    ds_read_b128 v[36:39], v1 offset:256
    ds_read_b128 v[40:43], v1 offset:512
    v_mfma_f32_16x16x32_bf16 v[180:183], a[140:143], v[112:115], v[180:183]
    v_exp_f32 v67, v67
    v_mfma_f32_16x16x32_bf16 v[180:183], a[172:175], v[132:135], v[180:183]
    ds_read_b128 v[44:47], v1 offset:768
    v_cvt_pk_bf16_f32 v105, v66, v67
    v_mfma_f32_16x16x32_bf16 v[180:183], a[204:207], v[136:139], v[180:183]
    v_exp_f32 v68, v68
    v_mfma_f32_16x16x32_bf16 v[180:183], a[236:239], v[140:143], v[180:183]
    s_waitcnt lgkmcnt(8)
    v_exp_f32 v69, v69
    v_mfma_f32_16x16x32_bf16 v[72:75], a[32:35], v[48:51], -4.0
    ds_read_b128 v[132:135], v4 offset:6144
    v_cvt_pk_bf16_f32 v106, v68, v69
    v_mfma_f32_16x16x32_bf16 v[72:75], a[36:39], v[52:55], v[72:75]
    v_exp_f32 v70, v70
    v_mfma_f32_16x16x32_bf16 v[72:75], a[40:43], v[56:59], v[72:75]
    v_exp_f32 v71, v71
    v_mfma_f32_16x16x32_bf16 v[72:75], a[44:47], v[60:63], v[72:75]
    s_waitcnt vmcnt(8) lgkmcnt(5)
    ds_read_b128 a[64:67], v255 offset:0
    v_cvt_pk_bf16_f32 v107, v70, v71
    v_mfma_f32_16x16x32_bf16 v[184:187], a[136:139], v[116:119], v[184:187]
    ds_read_b128 a[68:71], v255 offset:256
    ds_read_b128 a[72:75], v255 offset:512
    v_mfma_f32_16x16x32_bf16 v[184:187], a[168:171], v[148:151], v[184:187]
    ds_write_b128 v3, v[104:107] offset:2048
    v_mfma_f32_16x16x32_bf16 v[184:187], a[200:203], v[152:155], v[184:187]
    v_exp_f32 v72, v72
    v_mfma_f32_16x16x32_bf16 v[184:187], a[232:235], v[156:159], v[184:187]
    ds_read_b128 a[76:79], v255 offset:768
    ds_read_b128 a[80:83], v255 offset:4160
    v_mfma_f32_16x16x32_bf16 v[20:23], v[24:27], v[96:99], 0
    v_exp_f32 v73, v73
    v_mfma_f32_16x16x32_bf16 v[20:23], v[28:31], v[100:103], v[20:23]
    ds_read_b128 a[84:87], v255 offset:4416
    v_cvt_pk_bf16_f32 v108, v72, v73
    v_mfma_f32_16x16x32_bf16 v[76:79], a[48:51], v[48:51], -4.0
    v_exp_f32 v74, v74
    v_mfma_f32_16x16x32_bf16 v[76:79], a[52:55], v[52:55], v[76:79]
    ds_read_b128 a[88:91], v255 offset:4672
    ds_read_b128 v[48:51], v1 offset:4160
    v_mfma_f32_16x16x32_bf16 v[76:79], a[56:59], v[56:59], v[76:79]
    ds_read_b128 a[92:95], v255 offset:4928
    ds_read_b128 v[136:139], v5 offset:6144
    v_mfma_f32_16x16x32_bf16 v[76:79], a[60:63], v[60:63], v[76:79]
    v_exp_f32 v75, v75
    v_mfma_f32_16x16x32_bf16 v[188:191], a[140:143], v[116:119], v[188:191]
    ds_read_b128 v[52:55], v1 offset:4416
    v_cvt_pk_bf16_f32 v109, v74, v75
    v_mfma_f32_16x16x32_bf16 v[188:191], a[172:175], v[148:151], v[188:191]
    ds_read_b128 v[140:143], v6 offset:6144
    ds_read_b128 v[56:59], v1 offset:4672
    v_mfma_f32_16x16x32_bf16 v[188:191], a[204:207], v[152:155], v[188:191]
    ds_read_b128 v[60:63], v1 offset:4928
    v_add_f32 v251, v251, v20
    v_mfma_f32_16x16x32_bf16 v[188:191], a[236:239], v[156:159], v[188:191]
    s_barrier
    v_exp_f32 v76, v76
    s_waitcnt lgkmcnt(0)
    v_mfma_f32_16x16x32_bf16 v[192:195], a[152:155], a[64:67], 0
    s_add_u32 m0, s54, 0
    s_add_u32 s45, s44, 24576
    buffer_load_dwordx4 v7, s[8:11], s45 offen offset:0 nt lds
    s_nop 1
    v_mfma_f32_16x16x32_bf16 v[192:195], a[184:187], a[64:67], v[192:195]
    s_nop 1
    v_mfma_f32_16x16x32_bf16 v[196:199], a[156:159], a[64:67], 0
    s_nop 1
    v_mfma_f32_16x16x32_bf16 v[196:199], a[188:191], a[64:67], v[196:199]
    s_nop 1
    v_mfma_f32_16x16x32_bf16 v[16:19], a[152:155], a[68:71], 0
    buffer_load_dwordx4 v7, s[8:11], s45 offen offset:1024 nt lds
    v_cvt_pk_bf16_f32 v192, v192, v193
    v_cvt_pk_bf16_f32 v193, v194, v195
    v_mfma_f32_16x16x32_bf16 v[16:19], a[184:187], a[68:71], v[16:19]
    v_accvgpr_write_b32 a64, v192
    v_accvgpr_write_b32 a65, v193
    v_mfma_f32_16x16x32_bf16 v[192:195], a[156:159], a[68:71], 0
    v_cvt_pk_bf16_f32 v196, v196, v197
    v_cvt_pk_bf16_f32 v197, v198, v199
    v_mfma_f32_16x16x32_bf16 v[192:195], a[188:191], a[68:71], v[192:195]
    v_accvgpr_write_b32 a66, v196
    v_accvgpr_write_b32 a67, v197
    v_mfma_f32_16x16x32_bf16 v[196:199], a[152:155], a[72:75], 0
    s_add_u32 m0, s54, 2080
    s_add_u32 s45, s44, 26624
    buffer_load_dwordx4 v7, s[8:11], s45 offen offset:0 nt lds
    v_cvt_pk_bf16_f32 v16, v16, v17
    v_cvt_pk_bf16_f32 v17, v18, v19
    v_mfma_f32_16x16x32_bf16 v[196:199], a[184:187], a[72:75], v[196:199]
    v_accvgpr_write_b32 a68, v16
    v_accvgpr_write_b32 a69, v17
    v_mfma_f32_16x16x32_bf16 v[16:19], a[156:159], a[72:75], 0
    v_cvt_pk_bf16_f32 v192, v192, v193
    v_cvt_pk_bf16_f32 v193, v194, v195
    v_mfma_f32_16x16x32_bf16 v[16:19], a[188:191], a[72:75], v[16:19]
    v_accvgpr_write_b32 a70, v192
    v_accvgpr_write_b32 a71, v193
    v_mfma_f32_16x16x32_bf16 v[192:195], a[152:155], a[76:79], 0
    buffer_load_dwordx4 v7, s[8:11], s45 offen offset:1024 nt lds
    v_cvt_pk_bf16_f32 v196, v196, v197
    v_cvt_pk_bf16_f32 v197, v198, v199
    v_mfma_f32_16x16x32_bf16 v[192:195], a[184:187], a[76:79], v[192:195]
    v_accvgpr_write_b32 a72, v196
    v_accvgpr_write_b32 a73, v197
    v_mfma_f32_16x16x32_bf16 v[196:199], a[156:159], a[76:79], 0
    v_cvt_pk_bf16_f32 v16, v16, v17
    v_cvt_pk_bf16_f32 v17, v18, v19
    v_mfma_f32_16x16x32_bf16 v[196:199], a[188:191], a[76:79], v[196:199]
    v_accvgpr_write_b32 a74, v16
    v_accvgpr_write_b32 a75, v17
    v_mfma_f32_16x16x32_bf16 v[16:19], a[152:155], a[80:83], 0
    s_add_u32 m0, s54, 4160
    s_add_u32 s45, s44, 28672
    buffer_load_dwordx4 v7, s[8:11], s45 offen offset:0 nt lds
    v_cvt_pk_bf16_f32 v192, v192, v193
    v_cvt_pk_bf16_f32 v193, v194, v195
    v_mfma_f32_16x16x32_bf16 v[16:19], a[184:187], a[80:83], v[16:19]
    v_accvgpr_write_b32 a76, v192
    v_accvgpr_write_b32 a77, v193
    v_mfma_f32_16x16x32_bf16 v[192:195], a[156:159], a[80:83], 0
    v_cvt_pk_bf16_f32 v196, v196, v197
    v_cvt_pk_bf16_f32 v197, v198, v199
    v_mfma_f32_16x16x32_bf16 v[192:195], a[188:191], a[80:83], v[192:195]
    v_accvgpr_write_b32 a78, v196
    v_accvgpr_write_b32 a79, v197
    v_mfma_f32_16x16x32_bf16 v[196:199], a[152:155], a[84:87], 0
    buffer_load_dwordx4 v7, s[8:11], s45 offen offset:1024 nt lds
    v_cvt_pk_bf16_f32 v16, v16, v17
    v_cvt_pk_bf16_f32 v17, v18, v19
    v_mfma_f32_16x16x32_bf16 v[196:199], a[184:187], a[84:87], v[196:199]
    v_accvgpr_write_b32 a80, v16
    v_accvgpr_write_b32 a81, v17
    v_mfma_f32_16x16x32_bf16 v[16:19], a[156:159], a[84:87], 0
    v_cvt_pk_bf16_f32 v192, v192, v193
    v_cvt_pk_bf16_f32 v193, v194, v195
    v_mfma_f32_16x16x32_bf16 v[16:19], a[188:191], a[84:87], v[16:19]
    v_accvgpr_write_b32 a82, v192
    v_accvgpr_write_b32 a83, v193
    v_mfma_f32_16x16x32_bf16 v[192:195], a[152:155], a[88:91], 0
    s_add_u32 m0, s54, 6240
    s_add_u32 s45, s44, 30720
    buffer_load_dwordx4 v7, s[8:11], s45 offen offset:0 nt lds
    v_cvt_pk_bf16_f32 v196, v196, v197
    v_cvt_pk_bf16_f32 v197, v198, v199
    v_mfma_f32_16x16x32_bf16 v[192:195], a[184:187], a[88:91], v[192:195]
    v_accvgpr_write_b32 a84, v196
    v_accvgpr_write_b32 a85, v197
    v_mfma_f32_16x16x32_bf16 v[196:199], a[156:159], a[88:91], 0
    v_cvt_pk_bf16_f32 v16, v16, v17
    v_cvt_pk_bf16_f32 v17, v18, v19
    v_mfma_f32_16x16x32_bf16 v[196:199], a[188:191], a[88:91], v[196:199]
    v_accvgpr_write_b32 a86, v16
    v_accvgpr_write_b32 a87, v17
    v_mfma_f32_16x16x32_bf16 v[16:19], a[152:155], a[92:95], 0
    buffer_load_dwordx4 v7, s[8:11], s45 offen offset:1024 nt lds
    v_cvt_pk_bf16_f32 v192, v192, v193
    v_cvt_pk_bf16_f32 v193, v194, v195
    v_mfma_f32_16x16x32_bf16 v[16:19], a[184:187], a[92:95], v[16:19]
    v_accvgpr_write_b32 a88, v192
    v_accvgpr_write_b32 a89, v193
    v_mfma_f32_16x16x32_bf16 v[192:195], a[156:159], a[92:95], 0
    v_cvt_pk_bf16_f32 v196, v196, v197
    v_cvt_pk_bf16_f32 v197, v198, v199
    v_mfma_f32_16x16x32_bf16 v[192:195], a[188:191], a[92:95], v[192:195]
    v_accvgpr_write_b32 a90, v196
    v_accvgpr_write_b32 a91, v197
    v_mfma_f32_16x16x32_bf16 v[64:67], a[64:67], v[32:35], -4.0
    ds_read_b128 v[148:151], v4 offset:7168
    v_cvt_pk_bf16_f32 v16, v16, v17
    v_cvt_pk_bf16_f32 v17, v18, v19
    v_accvgpr_write_b32 a92, v16
    v_accvgpr_write_b32 a93, v17
    v_cvt_pk_bf16_f32 v192, v192, v193
    v_cvt_pk_bf16_f32 v193, v194, v195
    v_accvgpr_write_b32 a94, v192
    v_accvgpr_write_b32 a95, v193
    v_mfma_f32_16x16x32_bf16 v[64:67], a[68:71], v[36:39], v[64:67]
    v_exp_f32 v77, v77
    v_mfma_f32_16x16x32_bf16 v[64:67], a[72:75], v[40:43], v[64:67]
    ds_read_b128 v[152:155], v5 offset:7168
    v_cvt_pk_bf16_f32 v110, v76, v77
    v_mfma_f32_16x16x32_bf16 v[64:67], a[76:79], v[44:47], v[64:67]
    v_exp_f32 v78, v78
    v_mfma_f32_16x16x32_bf16 v[200:203], a[136:139], v[120:123], v[200:203]
    v_exp_f32 v79, v79
    v_mfma_f32_16x16x32_bf16 v[200:203], a[168:171], v[132:135], v[200:203]
    ds_read_b128 v[156:159], v6 offset:7168
    v_cvt_pk_bf16_f32 v111, v78, v79
    v_mfma_f32_16x16x32_bf16 v[200:203], a[200:203], v[136:139], v[200:203]
    ds_write_b128 v3, v[108:111] offset:3072
    v_mfma_f32_16x16x32_bf16 v[200:203], a[232:235], v[140:143], v[200:203]
    v_exp_f32 v64, v64
    v_mfma_f32_16x16x32_bf16 v[68:71], a[80:83], v[32:35], -4.0
    v_exp_f32 v65, v65
    v_mfma_f32_16x16x32_bf16 v[68:71], a[84:87], v[36:39], v[68:71]
    ds_read_b128 v[32:35], v1 offset:8320
    v_cvt_pk_bf16_f32 v112, v64, v65
    v_mfma_f32_16x16x32_bf16 v[68:71], a[88:91], v[40:43], v[68:71]
    v_exp_f32 v66, v66
    v_mfma_f32_16x16x32_bf16 v[68:71], a[92:95], v[44:47], v[68:71]
    ds_read_b128 v[36:39], v1 offset:8576
    ds_read_b128 v[40:43], v1 offset:8832
    v_mfma_f32_16x16x32_bf16 v[204:207], a[140:143], v[120:123], v[204:207]
    v_exp_f32 v67, v67
    v_mfma_f32_16x16x32_bf16 v[204:207], a[172:175], v[132:135], v[204:207]
    ds_read_b128 v[44:47], v1 offset:9088
    v_cvt_pk_bf16_f32 v113, v66, v67
    v_mfma_f32_16x16x32_bf16 v[204:207], a[204:207], v[136:139], v[204:207]
    v_exp_f32 v68, v68
    v_mfma_f32_16x16x32_bf16 v[204:207], a[236:239], v[140:143], v[204:207]
    v_exp_f32 v69, v69
    v_mfma_f32_16x16x32_bf16 v[72:75], a[64:67], v[48:51], -4.0
    ds_read_b128 v[132:135], v4 offset:0
    v_cvt_pk_bf16_f32 v114, v68, v69
    v_mfma_f32_16x16x32_bf16 v[72:75], a[68:71], v[52:55], v[72:75]
    v_exp_f32 v70, v70
    v_mfma_f32_16x16x32_bf16 v[72:75], a[72:75], v[56:59], v[72:75]
    v_exp_f32 v71, v71
    v_mfma_f32_16x16x32_bf16 v[72:75], a[76:79], v[60:63], v[72:75]
    s_waitcnt lgkmcnt(6)
    ds_read_b128 v[136:139], v5 offset:0
    v_cvt_pk_bf16_f32 v115, v70, v71
    v_mfma_f32_16x16x32_bf16 v[208:211], a[136:139], v[124:127], v[208:211]
    ds_write_b128 v3, v[112:115] offset:4096
    v_mfma_f32_16x16x32_bf16 v[208:211], a[168:171], v[148:151], v[208:211]
    ds_read_b128 v[140:143], v6 offset:0
    s_nop 0
    v_mfma_f32_16x16x32_bf16 v[208:211], a[200:203], v[152:155], v[208:211]
    v_exp_f32 v72, v72
    v_mfma_f32_16x16x32_bf16 v[208:211], a[232:235], v[156:159], v[208:211]
    v_exp_f32 v73, v73
    v_mfma_f32_16x16x32_bf16 v[20:23], v[24:27], v[104:107], 0
    v_exp_f32 v74, v74
    v_mfma_f32_16x16x32_bf16 v[20:23], v[28:31], v[108:111], v[20:23]
    v_cvt_pk_bf16_f32 v116, v72, v73
    s_nop 0
    v_mfma_f32_16x16x32_bf16 v[76:79], a[80:83], v[48:51], -4.0
    s_add_u32 m0, s72, 124800
    v_exp_f32 v75, v75
    v_mfma_f32_16x16x32_bf16 v[76:79], a[84:87], v[52:55], v[76:79]
    ds_read_b128 v[48:51], v1 offset:12480
    ds_read_b128 v[52:55], v1 offset:12736
    v_mfma_f32_16x16x32_bf16 v[76:79], a[88:91], v[56:59], v[76:79]
    ds_read_b128 v[56:59], v1 offset:12992
    v_cvt_pk_bf16_f32 v117, v74, v75
    v_mfma_f32_16x16x32_bf16 v[76:79], a[92:95], v[60:63], v[76:79]
    ds_read_b128 v[60:63], v1 offset:13248
    v_add_f32 v252, v252, v20
    v_mfma_f32_16x16x32_bf16 v[212:215], a[140:143], v[124:127], v[212:215]
    buffer_load_dwordx4 v0, s[12:15], s70 offen offset:0 nt lds
    v_mfma_f32_16x16x32_bf16 v[212:215], a[172:175], v[148:151], v[212:215]
    ds_read_b128 v[148:151], v4 offset:1024
    s_nop 0
    v_mfma_f32_16x16x32_bf16 v[212:215], a[204:207], v[152:155], v[212:215]
    s_waitcnt lgkmcnt(9)
    v_exp_f32 v76, v76
    v_mfma_f32_16x16x32_bf16 v[212:215], a[236:239], v[156:159], v[212:215]
    s_barrier
    v_exp_f32 v77, v77
    v_mfma_f32_16x16x32_bf16 v[64:67], a[64:67], v[32:35], -4.0
    v_add_u32 v192, s50, v15
    v_cvt_pk_bf16_f32 v118, v76, v77
    v_mfma_f32_16x16x32_bf16 v[64:67], a[68:71], v[36:39], v[64:67]
    v_add_u32 v193, s51, v15
    v_add_u32 v194, s52, v15
    v_mfma_f32_16x16x32_bf16 v[64:67], a[72:75], v[40:43], v[64:67]
    v_exp_f32 v78, v78
    v_mfma_f32_16x16x32_bf16 v[64:67], a[76:79], v[44:47], v[64:67]
    s_waitcnt lgkmcnt(5)
    ds_read_b128 v[152:155], v5 offset:1024
    v_add_u32 v195, s53, v15
    v_mfma_f32_16x16x32_bf16 v[216:219], a[136:139], v[96:99], v[216:219]
    v_exp_f32 v79, v79
    v_mfma_f32_16x16x32_bf16 v[216:219], a[168:171], v[132:135], v[216:219]
    ds_read_b128 v[156:159], v6 offset:1024
    v_cvt_pk_bf16_f32 v119, v78, v79
    v_mfma_f32_16x16x32_bf16 v[216:219], a[200:203], v[136:139], v[216:219]
    buffer_load_dwordx4 v0, s[12:15], s70 offen offset:1024 nt lds
    v_mfma_f32_16x16x32_bf16 v[216:219], a[232:235], v[140:143], v[216:219]
    ds_write_b128 v3, v[116:119] offset:5120
    v_mfma_f32_16x16x32_bf16 v[68:71], a[80:83], v[32:35], -4.0
    v_exp_f32 v64, v64
    v_mfma_f32_16x16x32_bf16 v[68:71], a[84:87], v[36:39], v[68:71]
    v_exp_f32 v65, v65
    v_mfma_f32_16x16x32_bf16 v[68:71], a[88:91], v[40:43], v[68:71]
    ds_read_b128 v[32:35], v1 offset:16640
    v_cvt_pk_bf16_f32 v120, v64, v65
    v_mfma_f32_16x16x32_bf16 v[68:71], a[92:95], v[44:47], v[68:71]
    v_exp_f32 v66, v66
    v_mfma_f32_16x16x32_bf16 v[220:223], a[140:143], v[96:99], v[220:223]
    ds_read_b128 v[36:39], v1 offset:16896
    ds_read_b128 v[40:43], v1 offset:17152
    v_mfma_f32_16x16x32_bf16 v[220:223], a[172:175], v[132:135], v[220:223]
    v_exp_f32 v67, v67
    v_mfma_f32_16x16x32_bf16 v[220:223], a[204:207], v[136:139], v[220:223]
    ds_read_b128 v[44:47], v1 offset:17408
    v_cvt_pk_bf16_f32 v121, v66, v67
    v_mfma_f32_16x16x32_bf16 v[220:223], a[236:239], v[140:143], v[220:223]
    s_waitcnt lgkmcnt(8)
    v_exp_f32 v68, v68
    v_mfma_f32_16x16x32_bf16 v[72:75], a[64:67], v[48:51], -4.0
    buffer_load_dwordx4 v0, s[12:15], s70 offen offset:2048 nt lds
    v_mfma_f32_16x16x32_bf16 v[72:75], a[68:71], v[52:55], v[72:75]
    v_exp_f32 v69, v69
    v_mfma_f32_16x16x32_bf16 v[72:75], a[72:75], v[56:59], v[72:75]
    ds_read_b128 v[132:135], v4 offset:2048
    v_cvt_pk_bf16_f32 v122, v68, v69
    v_mfma_f32_16x16x32_bf16 v[72:75], a[76:79], v[60:63], v[72:75]
    s_waitcnt lgkmcnt(6)
    v_exp_f32 v70, v70
    v_mfma_f32_16x16x32_bf16 v[224:227], a[136:139], v[100:103], v[224:227]
    v_exp_f32 v71, v71
    v_mfma_f32_16x16x32_bf16 v[224:227], a[168:171], v[148:151], v[224:227]
    ds_read_b128 v[136:139], v5 offset:2048
    v_cvt_pk_bf16_f32 v123, v70, v71
    v_mfma_f32_16x16x32_bf16 v[224:227], a[200:203], v[152:155], v[224:227]
    ds_write_b128 v3, v[120:123] offset:6144
    v_mfma_f32_16x16x32_bf16 v[224:227], a[232:235], v[156:159], v[224:227]
    v_exp_f32 v72, v72
    v_mfma_f32_16x16x32_bf16 v[20:23], v[24:27], v[112:115], 0
    buffer_load_dwordx4 v0, s[12:15], s70 offen offset:3072 nt lds
    v_mfma_f32_16x16x32_bf16 v[20:23], v[28:31], v[116:119], v[20:23]
    v_exp_f32 v73, v73
    v_mfma_f32_16x16x32_bf16 v[76:79], a[80:83], v[48:51], -4.0
    ds_read_b128 v[48:51], v1 offset:20800
    v_cvt_pk_bf16_f32 v124, v72, v73
    v_mfma_f32_16x16x32_bf16 v[76:79], a[84:87], v[52:55], v[76:79]
    v_exp_f32 v74, v74
    v_mfma_f32_16x16x32_bf16 v[76:79], a[88:91], v[56:59], v[76:79]
    v_exp_f32 v75, v75
    v_mfma_f32_16x16x32_bf16 v[76:79], a[92:95], v[60:63], v[76:79]
    ds_read_b128 v[52:55], v1 offset:21056
    v_cvt_pk_bf16_f32 v125, v74, v75
    v_mfma_f32_16x16x32_bf16 v[228:231], a[140:143], v[100:103], v[228:231]
    ds_read_b128 v[140:143], v6 offset:2048
    ds_read_b128 v[56:59], v1 offset:21312
    v_mfma_f32_16x16x32_bf16 v[228:231], a[172:175], v[148:151], v[228:231]
    ds_read_b128 v[60:63], v1 offset:21568
    v_add_f32 v248, v248, v20
    v_mfma_f32_16x16x32_bf16 v[228:231], a[204:207], v[152:155], v[228:231]
    s_waitcnt vmcnt(12) lgkmcnt(8)
    v_exp_f32 v76, v76
    v_mfma_f32_16x16x32_bf16 v[228:231], a[236:239], v[156:159], v[228:231]
    s_barrier
    v_exp_f32 v77, v77
    v_mfma_f32_16x16x32_bf16 v[64:67], a[64:67], v[32:35], -4.0
    ds_read_b64_tr_b16 a[144:145], v192 offset:33024
    v_cvt_pk_bf16_f32 v126, v76, v77
    v_mfma_f32_16x16x32_bf16 v[64:67], a[68:71], v[36:39], v[64:67]
    ds_read_b64_tr_b16 a[146:147], v192 offset:0
    ds_read_b64_tr_b16 a[148:149], v192 offset:33032
    v_mfma_f32_16x16x32_bf16 v[64:67], a[72:75], v[40:43], v[64:67]
    v_exp_f32 v78, v78
    v_mfma_f32_16x16x32_bf16 v[64:67], a[76:79], v[44:47], v[64:67]
    s_waitcnt lgkmcnt(5)
    ds_read_b64_tr_b16 a[150:151], v192 offset:8
    ds_read_b64_tr_b16 a[176:177], v193 offset:33024
    v_mfma_f32_16x16x32_bf16 v[160:163], a[136:139], v[104:107], v[160:163]
    v_exp_f32 v79, v79
    v_mfma_f32_16x16x32_bf16 v[160:163], a[168:171], v[132:135], v[160:163]
    ds_read_b64_tr_b16 a[178:179], v193 offset:0
    v_cvt_pk_bf16_f32 v127, v78, v79
    v_mfma_f32_16x16x32_bf16 v[160:163], a[200:203], v[136:139], v[160:163]
    ds_write_b128 v3, v[124:127] offset:7168
    v_mfma_f32_16x16x32_bf16 v[160:163], a[232:235], v[140:143], v[160:163]
    v_exp_f32 v64, v64
    v_mfma_f32_16x16x32_bf16 v[68:71], a[80:83], v[32:35], -4.0
    ds_read_b64_tr_b16 a[180:181], v193 offset:33032
    ds_read_b64_tr_b16 a[182:183], v193 offset:8
    v_mfma_f32_16x16x32_bf16 v[68:71], a[84:87], v[36:39], v[68:71]
    v_exp_f32 v65, v65
    v_mfma_f32_16x16x32_bf16 v[68:71], a[88:91], v[40:43], v[68:71]
    ds_read_b64_tr_b16 a[208:209], v194 offset:33024
    v_cvt_pk_bf16_f32 v96, v64, v65
    v_mfma_f32_16x16x32_bf16 v[68:71], a[92:95], v[44:47], v[68:71]
    ds_read_b128 v[148:151], v4 offset:3072
    ds_read_b128 v[32:35], v1 offset:24960
    v_mfma_f32_16x16x32_bf16 v[164:167], a[140:143], v[104:107], v[164:167]
    ds_read_b64_tr_b16 a[210:211], v194 offset:0
    ds_read_b128 v[152:155], v5 offset:3072
    v_mfma_f32_16x16x32_bf16 v[164:167], a[172:175], v[132:135], v[164:167]
    v_exp_f32 v66, v66
    v_mfma_f32_16x16x32_bf16 v[164:167], a[204:207], v[136:139], v[164:167]
    ds_read_b128 v[36:39], v1 offset:25216
    ds_read_b64_tr_b16 a[212:213], v194 offset:33032
    v_mfma_f32_16x16x32_bf16 v[164:167], a[236:239], v[140:143], v[164:167]
    s_waitcnt lgkmcnt(14)
    ds_read_b128 v[156:159], v6 offset:3072
    ds_read_b128 v[40:43], v1 offset:25472
    ds_read_b64_tr_b16 a[214:215], v194 offset:8
    v_mfma_f32_16x16x32_bf16 v[72:75], a[64:67], v[48:51], -4.0
    ds_read_b128 v[44:47], v1 offset:25728
    ds_read_b64_tr_b16 a[240:241], v195 offset:33024
    v_exp_f32 v67, v67
    v_mfma_f32_16x16x32_bf16 v[72:75], a[68:71], v[52:55], v[72:75]
    ds_read_b64_tr_b16 a[242:243], v195 offset:0
    v_cvt_pk_bf16_f32 v97, v66, v67
    v_mfma_f32_16x16x32_bf16 v[72:75], a[72:75], v[56:59], v[72:75]
    ds_read_b64_tr_b16 a[244:245], v195 offset:33032
    v_exp_f32 v68, v68
    v_mfma_f32_16x16x32_bf16 v[72:75], a[76:79], v[60:63], v[72:75]
    s_waitcnt lgkmcnt(6)
    ds_read_b64_tr_b16 a[246:247], v195 offset:8
    ds_read_b128 v[132:135], v4 offset:4096
    v_mfma_f32_16x16x32_bf16 v[168:171], a[136:139], v[108:111], v[168:171]
    v_exp_f32 v69, v69
    v_mfma_f32_16x16x32_bf16 v[168:171], a[168:171], v[148:151], v[168:171]
    ds_read_b128 v[136:139], v5 offset:4096
    v_cvt_pk_bf16_f32 v98, v68, v69
    v_mfma_f32_16x16x32_bf16 v[168:171], a[200:203], v[152:155], v[168:171]
    v_exp_f32 v70, v70
    v_mfma_f32_16x16x32_bf16 v[168:171], a[232:235], v[156:159], v[168:171]
    v_exp_f32 v71, v71
    v_mfma_f32_16x16x32_bf16 v[20:23], v[24:27], v[120:123], 0
    ds_read_b128 v[140:143], v6 offset:4096
    v_cvt_pk_bf16_f32 v99, v70, v71
    v_mfma_f32_16x16x32_bf16 v[20:23], v[28:31], v[124:127], v[20:23]
    ds_write_b128 v3, v[96:99] offset:0
    v_mfma_f32_16x16x32_bf16 v[76:79], a[80:83], v[48:51], -4.0
    v_exp_f32 v72, v72
    v_mfma_f32_16x16x32_bf16 v[76:79], a[84:87], v[52:55], v[76:79]
    v_exp_f32 v73, v73
    v_mfma_f32_16x16x32_bf16 v[76:79], a[88:91], v[56:59], v[76:79]
    ds_read_b128 v[48:51], v1 offset:29120
    v_cvt_pk_bf16_f32 v100, v72, v73
    v_mfma_f32_16x16x32_bf16 v[76:79], a[92:95], v[60:63], v[76:79]
    v_exp_f32 v74, v74
    v_mfma_f32_16x16x32_bf16 v[172:175], a[140:143], v[108:111], v[172:175]
    v_exp_f32 v75, v75
    v_mfma_f32_16x16x32_bf16 v[172:175], a[172:175], v[148:151], v[172:175]
    ds_read_b128 v[52:55], v1 offset:29376
    v_cvt_pk_bf16_f32 v101, v74, v75
    v_mfma_f32_16x16x32_bf16 v[172:175], a[204:207], v[152:155], v[172:175]
    s_waitcnt lgkmcnt(6)
    ds_read_b128 v[56:59], v1 offset:29632
    v_add_f32 v249, v249, v20
    v_mfma_f32_16x16x32_bf16 v[172:175], a[236:239], v[156:159], v[172:175]
    s_barrier
    ds_read_b128 v[60:63], v1 offset:29888
    ds_read_b128 v[148:151], v4 offset:5120
    v_mfma_f32_16x16x32_bf16 v[64:67], a[64:67], v[32:35], -4.0
    s_add_u32 m0, s72, 141184
    v_exp_f32 v76, v76
    v_mfma_f32_16x16x32_bf16 v[64:67], a[68:71], v[36:39], v[64:67]
    v_exp_f32 v77, v77
    v_mfma_f32_16x16x32_bf16 v[64:67], a[72:75], v[40:43], v[64:67]
    ds_read_b128 v[152:155], v5 offset:5120
    v_cvt_pk_bf16_f32 v102, v76, v77
    v_mfma_f32_16x16x32_bf16 v[64:67], a[76:79], v[44:47], v[64:67]
    s_waitcnt lgkmcnt(7)
    v_exp_f32 v78, v78
    v_mfma_f32_16x16x32_bf16 v[80:83], a[144:147], v[112:115], v[80:83]
    buffer_load_dwordx4 v0, s[12:15], s71 offen offset:0 nt lds
    v_mfma_f32_16x16x32_bf16 v[80:83], a[176:179], v[132:135], v[80:83]
    v_exp_f32 v79, v79
    v_mfma_f32_16x16x32_bf16 v[80:83], a[208:211], v[136:139], v[80:83]
    ds_read_b128 v[156:159], v6 offset:5120
    v_cvt_pk_bf16_f32 v103, v78, v79
    v_mfma_f32_16x16x32_bf16 v[80:83], a[240:243], v[140:143], v[80:83]
    ds_write_b128 v3, v[100:103] offset:1024
    v_mfma_f32_16x16x32_bf16 v[68:71], a[80:83], v[32:35], -4.0
    v_exp_f32 v64, v64
    v_mfma_f32_16x16x32_bf16 v[68:71], a[84:87], v[36:39], v[68:71]
    v_exp_f32 v65, v65
    v_mfma_f32_16x16x32_bf16 v[68:71], a[88:91], v[40:43], v[68:71]
    buffer_load_dwordx4 v0, s[12:15], s71 offen offset:1024 nt lds
    v_mfma_f32_16x16x32_bf16 v[68:71], a[92:95], v[44:47], v[68:71]
    ds_read_b128 v[32:35], v1 offset:33280
    v_cvt_pk_bf16_f32 v104, v64, v65
    v_mfma_f32_16x16x32_bf16 v[84:87], a[148:151], v[112:115], v[84:87]
    v_exp_f32 v66, v66
    v_mfma_f32_16x16x32_bf16 v[84:87], a[180:183], v[132:135], v[84:87]
    ds_read_b128 v[36:39], v1 offset:33536
    ds_read_b128 v[40:43], v1 offset:33792
    v_mfma_f32_16x16x32_bf16 v[84:87], a[212:215], v[136:139], v[84:87]
    v_exp_f32 v67, v67
    v_mfma_f32_16x16x32_bf16 v[84:87], a[244:247], v[140:143], v[84:87]
    s_waitcnt lgkmcnt(7)
    ds_read_b128 v[44:47], v1 offset:34048
    v_cvt_pk_bf16_f32 v105, v66, v67
    v_mfma_f32_16x16x32_bf16 v[72:75], a[64:67], v[48:51], -4.0
    buffer_load_dwordx4 v0, s[12:15], s71 offen offset:2048 nt lds
    v_mfma_f32_16x16x32_bf16 v[72:75], a[68:71], v[52:55], v[72:75]
    v_exp_f32 v68, v68
    v_mfma_f32_16x16x32_bf16 v[72:75], a[72:75], v[56:59], v[72:75]
    v_exp_f32 v69, v69
    v_mfma_f32_16x16x32_bf16 v[72:75], a[76:79], v[60:63], v[72:75]
    s_waitcnt lgkmcnt(5)
    ds_read_b128 v[132:135], v4 offset:6144
    v_cvt_pk_bf16_f32 v106, v68, v69
    v_mfma_f32_16x16x32_bf16 v[88:91], a[144:147], v[116:119], v[88:91]
    v_exp_f32 v70, v70
    v_mfma_f32_16x16x32_bf16 v[88:91], a[176:179], v[148:151], v[88:91]
    buffer_load_dwordx4 v0, s[12:15], s71 offen offset:3072 nt lds
    v_mfma_f32_16x16x32_bf16 v[88:91], a[208:211], v[152:155], v[88:91]
    v_exp_f32 v71, v71
    v_mfma_f32_16x16x32_bf16 v[88:91], a[240:243], v[156:159], v[88:91]
    ds_read_b128 v[136:139], v5 offset:6144
    v_cvt_pk_bf16_f32 v107, v70, v71
    v_mfma_f32_16x16x32_bf16 v[20:23], v[24:27], v[96:99], 0
    ds_write_b128 v3, v[104:107] offset:2048
    v_mfma_f32_16x16x32_bf16 v[20:23], v[28:31], v[100:103], v[20:23]
    v_exp_f32 v72, v72
    v_mfma_f32_16x16x32_bf16 v[76:79], a[80:83], v[48:51], -4.0
    v_exp_f32 v73, v73
    v_mfma_f32_16x16x32_bf16 v[76:79], a[84:87], v[52:55], v[76:79]
    ds_read_b128 v[48:51], v1 offset:37440
    v_cvt_pk_bf16_f32 v108, v72, v73
    v_mfma_f32_16x16x32_bf16 v[76:79], a[88:91], v[56:59], v[76:79]
    v_exp_f32 v74, v74
    v_mfma_f32_16x16x32_bf16 v[76:79], a[92:95], v[60:63], v[76:79]
    v_exp_f32 v75, v75
    v_mfma_f32_16x16x32_bf16 v[92:95], a[148:151], v[116:119], v[92:95]
    ds_read_b128 v[52:55], v1 offset:37696
    v_cvt_pk_bf16_f32 v109, v74, v75
    v_mfma_f32_16x16x32_bf16 v[92:95], a[180:183], v[148:151], v[92:95]
    ds_read_b128 v[140:143], v6 offset:6144
    ds_read_b128 v[56:59], v1 offset:37952
    v_mfma_f32_16x16x32_bf16 v[92:95], a[212:215], v[152:155], v[92:95]
    s_waitcnt lgkmcnt(7)
    ds_read_b128 v[60:63], v1 offset:38208
    v_add_f32 v250, v250, v20
    v_mfma_f32_16x16x32_bf16 v[92:95], a[244:247], v[156:159], v[92:95]
    s_barrier
    v_exp_f32 v76, v76
    v_mfma_f32_16x16x32_bf16 v[64:67], a[64:67], v[32:35], -4.0
    v_exp_f32 v77, v77
    v_mfma_f32_16x16x32_bf16 v[64:67], a[68:71], v[36:39], v[64:67]
    ds_read_b128 v[148:151], v4 offset:7168
    v_cvt_pk_bf16_f32 v110, v76, v77
    v_mfma_f32_16x16x32_bf16 v[64:67], a[72:75], v[40:43], v[64:67]
    v_exp_f32 v78, v78
    v_mfma_f32_16x16x32_bf16 v[64:67], a[76:79], v[44:47], v[64:67]
    s_waitcnt lgkmcnt(3)
    v_exp_f32 v79, v79
    v_mfma_f32_16x16x32_bf16 v[176:179], a[144:147], v[120:123], v[176:179]
    s_add_u32 m0, s30, 41600
    ds_read_b128 v[152:155], v5 offset:7168
    v_cvt_pk_bf16_f32 v111, v78, v79
    v_mfma_f32_16x16x32_bf16 v[176:179], a[176:179], v[132:135], v[176:179]
    s_mov_b32 s46, 40960
    ds_write_b128 v3, v[108:111] offset:3072
    v_mfma_f32_16x16x32_bf16 v[176:179], a[208:211], v[136:139], v[176:179]
    v_exp_f32 v64, v64
    v_mfma_f32_16x16x32_bf16 v[176:179], a[240:243], v[140:143], v[176:179]
    v_exp_f32 v65, v65
    v_mfma_f32_16x16x32_bf16 v[68:71], a[80:83], v[32:35], -4.0
    buffer_load_dwordx4 v7, s[4:7], s46 offen offset:0 nt lds
    v_mfma_f32_16x16x32_bf16 v[68:71], a[84:87], v[36:39], v[68:71]
    ds_read_b128 v[32:35], v1 offset:0
    v_cvt_pk_bf16_f32 v112, v64, v65
    v_mfma_f32_16x16x32_bf16 v[68:71], a[88:91], v[40:43], v[68:71]
    v_exp_f32 v66, v66
    v_mfma_f32_16x16x32_bf16 v[68:71], a[92:95], v[44:47], v[68:71]
    ds_read_b128 v[36:39], v1 offset:256
    ds_read_b128 v[156:159], v6 offset:7168
    v_mfma_f32_16x16x32_bf16 v[180:183], a[148:151], v[120:123], v[180:183]
    ds_read_b128 v[40:43], v1 offset:512
    ds_read_b128 v[44:47], v1 offset:768
    v_mfma_f32_16x16x32_bf16 v[180:183], a[180:183], v[132:135], v[180:183]
    v_exp_f32 v67, v67
    v_mfma_f32_16x16x32_bf16 v[180:183], a[212:215], v[136:139], v[180:183]
    ds_read_b128 v[132:135], v4 offset:0
    v_cvt_pk_bf16_f32 v113, v66, v67
    v_mfma_f32_16x16x32_bf16 v[180:183], a[244:247], v[140:143], v[180:183]
    s_waitcnt lgkmcnt(9)
    v_exp_f32 v68, v68
    v_mfma_f32_16x16x32_bf16 v[72:75], a[64:67], v[48:51], -4.0
    v_exp_f32 v69, v69
    v_mfma_f32_16x16x32_bf16 v[72:75], a[68:71], v[52:55], v[72:75]
    ds_read_b128 v[136:139], v5 offset:0
    v_cvt_pk_bf16_f32 v114, v68, v69
    v_mfma_f32_16x16x32_bf16 v[72:75], a[72:75], v[56:59], v[72:75]
    v_exp_f32 v70, v70
    v_mfma_f32_16x16x32_bf16 v[72:75], a[76:79], v[60:63], v[72:75]
    s_waitcnt vmcnt(9) lgkmcnt(4)
    buffer_load_dwordx4 v7, s[4:7], s46 offen offset:1024 nt lds
    v_mfma_f32_16x16x32_bf16 v[184:187], a[144:147], v[124:127], v[184:187]
    v_exp_f32 v71, v71
    v_mfma_f32_16x16x32_bf16 v[184:187], a[176:179], v[148:151], v[184:187]
    ds_read_b128 a[96:99], v255 offset:0
    v_cvt_pk_bf16_f32 v115, v70, v71
    v_mfma_f32_16x16x32_bf16 v[184:187], a[208:211], v[152:155], v[184:187]
    ds_read_b128 a[100:103], v255 offset:256
    ds_read_b128 a[104:107], v255 offset:512
    v_mfma_f32_16x16x32_bf16 v[184:187], a[240:243], v[156:159], v[184:187]
    ds_write_b128 v3, v[112:115] offset:4096
    v_mfma_f32_16x16x32_bf16 v[20:23], v[24:27], v[104:107], 0
    v_exp_f32 v72, v72
    v_mfma_f32_16x16x32_bf16 v[20:23], v[28:31], v[108:111], v[20:23]
    ds_read_b128 a[108:111], v255 offset:768
    ds_read_b128 a[112:115], v255 offset:4160
    v_mfma_f32_16x16x32_bf16 v[76:79], a[80:83], v[48:51], -4.0
    v_exp_f32 v73, v73
    v_mfma_f32_16x16x32_bf16 v[76:79], a[84:87], v[52:55], v[76:79]
    ds_read_b128 a[116:119], v255 offset:4416
    v_cvt_pk_bf16_f32 v116, v72, v73
    v_mfma_f32_16x16x32_bf16 v[76:79], a[88:91], v[56:59], v[76:79]
    v_exp_f32 v74, v74
    v_mfma_f32_16x16x32_bf16 v[76:79], a[92:95], v[60:63], v[76:79]
    ds_read_b128 a[120:123], v255 offset:4672
    ds_read_b128 v[48:51], v1 offset:4160
    v_mfma_f32_16x16x32_bf16 v[188:191], a[148:151], v[124:127], v[188:191]
    ds_read_b128 a[124:127], v255 offset:4928
    ds_read_b128 v[52:55], v1 offset:4416
    v_mfma_f32_16x16x32_bf16 v[188:191], a[180:183], v[148:151], v[188:191]
    v_exp_f32 v75, v75
    v_mfma_f32_16x16x32_bf16 v[188:191], a[212:215], v[152:155], v[188:191]
    ds_read_b128 v[140:143], v6 offset:0
    v_cvt_pk_bf16_f32 v117, v74, v75
    v_mfma_f32_16x16x32_bf16 v[188:191], a[244:247], v[156:159], v[188:191]
    s_barrier
    ds_read_b128 v[56:59], v1 offset:4672
    v_add_f32 v251, v251, v20
    s_waitcnt lgkmcnt(12)
    v_mfma_f32_16x16x32_bf16 v[192:195], a[152:155], a[96:99], 0
    s_nop 1
    v_mfma_f32_16x16x32_bf16 v[192:195], a[184:187], a[96:99], v[192:195]
    s_nop 1
    v_mfma_f32_16x16x32_bf16 v[196:199], a[156:159], a[96:99], 0
    s_nop 1
    v_mfma_f32_16x16x32_bf16 v[196:199], a[188:191], a[96:99], v[196:199]
    s_nop 1
    s_waitcnt lgkmcnt(11)
    v_mfma_f32_16x16x32_bf16 v[16:19], a[152:155], a[100:103], 0
    v_cvt_pk_bf16_f32 v192, v192, v193
    v_cvt_pk_bf16_f32 v193, v194, v195
    v_mfma_f32_16x16x32_bf16 v[16:19], a[184:187], a[100:103], v[16:19]
    v_accvgpr_write_b32 a96, v192
    v_accvgpr_write_b32 a97, v193
    v_mfma_f32_16x16x32_bf16 v[192:195], a[156:159], a[100:103], 0
    v_cvt_pk_bf16_f32 v196, v196, v197
    v_cvt_pk_bf16_f32 v197, v198, v199
    v_mfma_f32_16x16x32_bf16 v[192:195], a[188:191], a[100:103], v[192:195]
    v_accvgpr_write_b32 a98, v196
    v_accvgpr_write_b32 a99, v197
    s_waitcnt lgkmcnt(10)
    v_mfma_f32_16x16x32_bf16 v[196:199], a[152:155], a[104:107], 0
    v_cvt_pk_bf16_f32 v16, v16, v17
    v_cvt_pk_bf16_f32 v17, v18, v19
    v_mfma_f32_16x16x32_bf16 v[196:199], a[184:187], a[104:107], v[196:199]
    v_accvgpr_write_b32 a100, v16
    v_accvgpr_write_b32 a101, v17
    v_mfma_f32_16x16x32_bf16 v[16:19], a[156:159], a[104:107], 0
    v_cvt_pk_bf16_f32 v192, v192, v193
    v_cvt_pk_bf16_f32 v193, v194, v195
    v_mfma_f32_16x16x32_bf16 v[16:19], a[188:191], a[104:107], v[16:19]
    v_accvgpr_write_b32 a102, v192
    v_accvgpr_write_b32 a103, v193
    s_waitcnt lgkmcnt(8)
    v_mfma_f32_16x16x32_bf16 v[192:195], a[152:155], a[108:111], 0
    v_cvt_pk_bf16_f32 v196, v196, v197
    v_cvt_pk_bf16_f32 v197, v198, v199
    v_mfma_f32_16x16x32_bf16 v[192:195], a[184:187], a[108:111], v[192:195]
    v_accvgpr_write_b32 a104, v196
    v_accvgpr_write_b32 a105, v197
    v_mfma_f32_16x16x32_bf16 v[196:199], a[156:159], a[108:111], 0
    v_cvt_pk_bf16_f32 v16, v16, v17
    v_cvt_pk_bf16_f32 v17, v18, v19
    v_mfma_f32_16x16x32_bf16 v[196:199], a[188:191], a[108:111], v[196:199]
    v_accvgpr_write_b32 a106, v16
    v_accvgpr_write_b32 a107, v17
    s_waitcnt lgkmcnt(7)
    v_mfma_f32_16x16x32_bf16 v[16:19], a[152:155], a[112:115], 0
    v_cvt_pk_bf16_f32 v192, v192, v193
    v_cvt_pk_bf16_f32 v193, v194, v195
    v_mfma_f32_16x16x32_bf16 v[16:19], a[184:187], a[112:115], v[16:19]
    v_accvgpr_write_b32 a108, v192
    v_accvgpr_write_b32 a109, v193
    v_mfma_f32_16x16x32_bf16 v[192:195], a[156:159], a[112:115], 0
    v_cvt_pk_bf16_f32 v196, v196, v197
    v_cvt_pk_bf16_f32 v197, v198, v199
    v_mfma_f32_16x16x32_bf16 v[192:195], a[188:191], a[112:115], v[192:195]
    v_accvgpr_write_b32 a110, v196
    v_accvgpr_write_b32 a111, v197
    s_waitcnt lgkmcnt(6)
    v_mfma_f32_16x16x32_bf16 v[196:199], a[152:155], a[116:119], 0
    v_cvt_pk_bf16_f32 v16, v16, v17
    v_cvt_pk_bf16_f32 v17, v18, v19
    v_mfma_f32_16x16x32_bf16 v[196:199], a[184:187], a[116:119], v[196:199]
    v_accvgpr_write_b32 a112, v16
    v_accvgpr_write_b32 a113, v17
    v_mfma_f32_16x16x32_bf16 v[16:19], a[156:159], a[116:119], 0
    v_cvt_pk_bf16_f32 v192, v192, v193
    v_cvt_pk_bf16_f32 v193, v194, v195
    v_mfma_f32_16x16x32_bf16 v[16:19], a[188:191], a[116:119], v[16:19]
    v_accvgpr_write_b32 a114, v192
    v_accvgpr_write_b32 a115, v193
    s_waitcnt lgkmcnt(5)
    v_mfma_f32_16x16x32_bf16 v[192:195], a[152:155], a[120:123], 0
    v_cvt_pk_bf16_f32 v196, v196, v197
    v_cvt_pk_bf16_f32 v197, v198, v199
    v_mfma_f32_16x16x32_bf16 v[192:195], a[184:187], a[120:123], v[192:195]
    v_accvgpr_write_b32 a116, v196
    v_accvgpr_write_b32 a117, v197
    v_mfma_f32_16x16x32_bf16 v[196:199], a[156:159], a[120:123], 0
    v_cvt_pk_bf16_f32 v16, v16, v17
    v_cvt_pk_bf16_f32 v17, v18, v19
    v_mfma_f32_16x16x32_bf16 v[196:199], a[188:191], a[120:123], v[196:199]
    v_accvgpr_write_b32 a118, v16
    v_accvgpr_write_b32 a119, v17
    s_waitcnt lgkmcnt(3)
    v_mfma_f32_16x16x32_bf16 v[16:19], a[152:155], a[124:127], 0
    v_cvt_pk_bf16_f32 v192, v192, v193
    v_cvt_pk_bf16_f32 v193, v194, v195
    v_mfma_f32_16x16x32_bf16 v[16:19], a[184:187], a[124:127], v[16:19]
    v_accvgpr_write_b32 a120, v192
    v_accvgpr_write_b32 a121, v193
    v_mfma_f32_16x16x32_bf16 v[192:195], a[156:159], a[124:127], 0
    v_cvt_pk_bf16_f32 v196, v196, v197
    v_cvt_pk_bf16_f32 v197, v198, v199
    v_mfma_f32_16x16x32_bf16 v[192:195], a[188:191], a[124:127], v[192:195]
    v_accvgpr_write_b32 a122, v196
    v_accvgpr_write_b32 a123, v197
    v_mfma_f32_16x16x32_bf16 v[64:67], a[96:99], v[32:35], -4.0
    ds_read_b128 v[60:63], v1 offset:4928
    v_cvt_pk_bf16_f32 v16, v16, v17
    v_cvt_pk_bf16_f32 v17, v18, v19
    v_accvgpr_write_b32 a124, v16
    v_accvgpr_write_b32 a125, v17
    v_cvt_pk_bf16_f32 v192, v192, v193
    v_cvt_pk_bf16_f32 v193, v194, v195
    v_accvgpr_write_b32 a126, v192
    v_accvgpr_write_b32 a127, v193
    v_mfma_f32_16x16x32_bf16 v[64:67], a[100:103], v[36:39], v[64:67]
    v_exp_f32 v76, v76
    v_mfma_f32_16x16x32_bf16 v[64:67], a[104:107], v[40:43], v[64:67]
    v_exp_f32 v77, v77
    v_mfma_f32_16x16x32_bf16 v[64:67], a[108:111], v[44:47], v[64:67]
    s_waitcnt lgkmcnt(2)
    ds_read_b128 v[148:151], v4 offset:1024
    v_cvt_pk_bf16_f32 v118, v76, v77
    v_mfma_f32_16x16x32_bf16 v[200:203], a[144:147], v[96:99], v[200:203]
    s_add_u32 m0, s30, 49920
    v_exp_f32 v78, v78
    v_mfma_f32_16x16x32_bf16 v[200:203], a[176:179], v[132:135], v[200:203]
    s_mov_b32 s46, 49152
    v_exp_f32 v79, v79
    v_mfma_f32_16x16x32_bf16 v[200:203], a[208:211], v[136:139], v[200:203]
    ds_read_b128 v[152:155], v5 offset:1024
    v_cvt_pk_bf16_f32 v119, v78, v79
    v_mfma_f32_16x16x32_bf16 v[200:203], a[240:243], v[140:143], v[200:203]
    ds_write_b128 v3, v[116:119] offset:5120
    v_mfma_f32_16x16x32_bf16 v[68:71], a[112:115], v[32:35], -4.0
    v_exp_f32 v64, v64
    v_mfma_f32_16x16x32_bf16 v[68:71], a[116:119], v[36:39], v[68:71]
    v_exp_f32 v65, v65
    v_mfma_f32_16x16x32_bf16 v[68:71], a[120:123], v[40:43], v[68:71]
    buffer_load_dwordx4 v7, s[4:7], s46 offen offset:0 nt lds
    v_mfma_f32_16x16x32_bf16 v[68:71], a[124:127], v[44:47], v[68:71]
    ds_read_b128 v[32:35], v1 offset:8320
    v_cvt_pk_bf16_f32 v120, v64, v65
    v_mfma_f32_16x16x32_bf16 v[204:207], a[148:151], v[96:99], v[204:207]
    v_exp_f32 v66, v66
    v_mfma_f32_16x16x32_bf16 v[204:207], a[180:183], v[132:135], v[204:207]
    ds_read_b128 v[36:39], v1 offset:8576
    ds_read_b128 v[156:159], v6 offset:1024
    v_mfma_f32_16x16x32_bf16 v[204:207], a[212:215], v[136:139], v[204:207]
    ds_read_b128 v[40:43], v1 offset:8832
    ds_read_b128 v[44:47], v1 offset:9088
    v_mfma_f32_16x16x32_bf16 v[204:207], a[244:247], v[140:143], v[204:207]
    s_waitcnt lgkmcnt(8)
    v_exp_f32 v67, v67
    v_mfma_f32_16x16x32_bf16 v[72:75], a[96:99], v[48:51], -4.0
    ds_read_b128 v[132:135], v4 offset:2048
    v_cvt_pk_bf16_f32 v121, v66, v67
    v_mfma_f32_16x16x32_bf16 v[72:75], a[100:103], v[52:55], v[72:75]
    v_exp_f32 v68, v68
    v_mfma_f32_16x16x32_bf16 v[72:75], a[104:107], v[56:59], v[72:75]
    v_exp_f32 v69, v69
    v_mfma_f32_16x16x32_bf16 v[72:75], a[108:111], v[60:63], v[72:75]
    s_waitcnt lgkmcnt(3)
    ds_read_b128 v[136:139], v5 offset:2048
    v_cvt_pk_bf16_f32 v122, v68, v69
    v_mfma_f32_16x16x32_bf16 v[208:211], a[144:147], v[100:103], v[208:211]
    v_exp_f32 v70, v70
    v_mfma_f32_16x16x32_bf16 v[208:211], a[176:179], v[148:151], v[208:211]
    buffer_load_dwordx4 v7, s[4:7], s46 offen offset:1024 nt lds
    v_mfma_f32_16x16x32_bf16 v[208:211], a[208:211], v[152:155], v[208:211]
    v_exp_f32 v71, v71
    v_mfma_f32_16x16x32_bf16 v[208:211], a[240:243], v[156:159], v[208:211]
    ds_read_b128 v[140:143], v6 offset:2048
    v_cvt_pk_bf16_f32 v123, v70, v71
    v_mfma_f32_16x16x32_bf16 v[20:23], v[24:27], v[112:115], 0
    ds_write_b128 v3, v[120:123] offset:6144
    v_mfma_f32_16x16x32_bf16 v[20:23], v[28:31], v[116:119], v[20:23]
    v_exp_f32 v72, v72
    v_mfma_f32_16x16x32_bf16 v[76:79], a[112:115], v[48:51], -4.0
    v_exp_f32 v73, v73
    v_mfma_f32_16x16x32_bf16 v[76:79], a[116:119], v[52:55], v[76:79]
    ds_read_b128 v[48:51], v1 offset:12480
    v_cvt_pk_bf16_f32 v124, v72, v73
    v_mfma_f32_16x16x32_bf16 v[76:79], a[120:123], v[56:59], v[76:79]
    v_exp_f32 v74, v74
    v_mfma_f32_16x16x32_bf16 v[76:79], a[124:127], v[60:63], v[76:79]
    v_exp_f32 v75, v75
    v_mfma_f32_16x16x32_bf16 v[212:215], a[148:151], v[100:103], v[212:215]
    ds_read_b128 v[52:55], v1 offset:12736
    v_cvt_pk_bf16_f32 v125, v74, v75
    v_mfma_f32_16x16x32_bf16 v[212:215], a[180:183], v[148:151], v[212:215]
    ds_read_b128 v[56:59], v1 offset:12992
    v_add_f32 v252, v252, v20
    v_mfma_f32_16x16x32_bf16 v[212:215], a[212:215], v[152:155], v[212:215]
    s_waitcnt lgkmcnt(7)
    ds_read_b128 v[60:63], v1 offset:13248
    ds_read_b128 v[148:151], v4 offset:3072
    v_mfma_f32_16x16x32_bf16 v[212:215], a[244:247], v[156:159], v[212:215]
    s_barrier
    v_exp_f32 v76, v76
    v_mfma_f32_16x16x32_bf16 v[64:67], a[96:99], v[32:35], -4.0
    v_exp_f32 v77, v77
    v_mfma_f32_16x16x32_bf16 v[64:67], a[100:103], v[36:39], v[64:67]
    v_add_u32 v192, s50, v15
    v_cvt_pk_bf16_f32 v126, v76, v77
    v_mfma_f32_16x16x32_bf16 v[64:67], a[104:107], v[40:43], v[64:67]
    v_add_u32 v193, s51, v15
    v_add_u32 v194, s52, v15
    v_mfma_f32_16x16x32_bf16 v[64:67], a[108:111], v[44:47], v[64:67]
    s_waitcnt lgkmcnt(6)
    v_exp_f32 v78, v78
    v_mfma_f32_16x16x32_bf16 v[216:219], a[144:147], v[104:107], v[216:219]
    s_add_u32 m0, s30, 0
    ds_read_b128 v[152:155], v5 offset:3072
    v_add_u32 v195, s53, v15
    v_mfma_f32_16x16x32_bf16 v[216:219], a[176:179], v[132:135], v[216:219]
    s_mov_b32 s46, 57344
    v_exp_f32 v79, v79
    v_mfma_f32_16x16x32_bf16 v[216:219], a[208:211], v[136:139], v[216:219]
    ds_read_b128 v[156:159], v6 offset:3072
    v_cvt_pk_bf16_f32 v127, v78, v79
    v_mfma_f32_16x16x32_bf16 v[216:219], a[240:243], v[140:143], v[216:219]
    ds_write_b128 v3, v[124:127] offset:7168
    v_mfma_f32_16x16x32_bf16 v[68:71], a[112:115], v[32:35], -4.0
    v_exp_f32 v64, v64
    v_mfma_f32_16x16x32_bf16 v[68:71], a[116:119], v[36:39], v[68:71]
    v_exp_f32 v65, v65
    v_mfma_f32_16x16x32_bf16 v[68:71], a[120:123], v[40:43], v[68:71]
    buffer_load_dwordx4 v7, s[4:7], s46 offen offset:0 nt lds
    v_mfma_f32_16x16x32_bf16 v[68:71], a[124:127], v[44:47], v[68:71]
    ds_read_b128 v[32:35], v1 offset:16640
    v_cvt_pk_bf16_f32 v96, v64, v65
    v_mfma_f32_16x16x32_bf16 v[220:223], a[148:151], v[104:107], v[220:223]
    v_exp_f32 v66, v66
    v_mfma_f32_16x16x32_bf16 v[220:223], a[180:183], v[132:135], v[220:223]
    ds_read_b128 v[36:39], v1 offset:16896
    ds_read_b128 v[40:43], v1 offset:17152
    v_mfma_f32_16x16x32_bf16 v[220:223], a[212:215], v[136:139], v[220:223]
    v_exp_f32 v67, v67
    v_mfma_f32_16x16x32_bf16 v[220:223], a[244:247], v[140:143], v[220:223]
    s_waitcnt lgkmcnt(7)
    ds_read_b128 v[44:47], v1 offset:17408
    v_cvt_pk_bf16_f32 v97, v66, v67
    v_mfma_f32_16x16x32_bf16 v[72:75], a[96:99], v[48:51], -4.0
    v_exp_f32 v68, v68
    v_mfma_f32_16x16x32_bf16 v[72:75], a[100:103], v[52:55], v[72:75]
    v_exp_f32 v69, v69
    v_mfma_f32_16x16x32_bf16 v[72:75], a[104:107], v[56:59], v[72:75]
    ds_read_b128 v[132:135], v4 offset:4096
    v_cvt_pk_bf16_f32 v98, v68, v69
    v_mfma_f32_16x16x32_bf16 v[72:75], a[108:111], v[60:63], v[72:75]
    s_waitcnt lgkmcnt(6)
    v_exp_f32 v70, v70
    v_mfma_f32_16x16x32_bf16 v[224:227], a[144:147], v[108:111], v[224:227]
    buffer_load_dwordx4 v7, s[4:7], s46 offen offset:1024 nt lds
    v_mfma_f32_16x16x32_bf16 v[224:227], a[176:179], v[148:151], v[224:227]
    v_exp_f32 v71, v71
    v_mfma_f32_16x16x32_bf16 v[224:227], a[208:211], v[152:155], v[224:227]
    ds_read_b128 v[136:139], v5 offset:4096
    v_cvt_pk_bf16_f32 v99, v70, v71
    v_mfma_f32_16x16x32_bf16 v[224:227], a[240:243], v[156:159], v[224:227]
    ds_write_b128 v3, v[96:99] offset:0
    v_mfma_f32_16x16x32_bf16 v[20:23], v[24:27], v[120:123], 0
    v_exp_f32 v72, v72
    v_mfma_f32_16x16x32_bf16 v[20:23], v[28:31], v[124:127], v[20:23]
    v_exp_f32 v73, v73
    v_mfma_f32_16x16x32_bf16 v[76:79], a[112:115], v[48:51], -4.0
    ds_read_b128 v[48:51], v1 offset:20800
    v_cvt_pk_bf16_f32 v100, v72, v73
    v_mfma_f32_16x16x32_bf16 v[76:79], a[116:119], v[52:55], v[76:79]
    v_exp_f32 v74, v74
    v_mfma_f32_16x16x32_bf16 v[76:79], a[120:123], v[56:59], v[76:79]
    v_exp_f32 v75, v75
    v_mfma_f32_16x16x32_bf16 v[76:79], a[124:127], v[60:63], v[76:79]
    ds_read_b128 v[52:55], v1 offset:21056
    v_cvt_pk_bf16_f32 v101, v74, v75
    v_mfma_f32_16x16x32_bf16 v[228:231], a[148:151], v[108:111], v[228:231]
    ds_read_b128 v[140:143], v6 offset:4096
    ds_read_b128 v[56:59], v1 offset:21312
    v_mfma_f32_16x16x32_bf16 v[228:231], a[180:183], v[148:151], v[228:231]
    ds_read_b128 v[60:63], v1 offset:21568
    v_add_f32 v248, v248, v20
    v_mfma_f32_16x16x32_bf16 v[228:231], a[212:215], v[152:155], v[228:231]
    s_waitcnt lgkmcnt(10)
    v_exp_f32 v76, v76
    v_mfma_f32_16x16x32_bf16 v[228:231], a[244:247], v[156:159], v[228:231]
    ds_write_b32 v9, v248 offset:1024
    v_mfma_f32_16x16x32_bf16 v[64:67], a[96:99], v[32:35], -4.0
    v_exp_f32 v77, v77
    v_mfma_f32_16x16x32_bf16 v[64:67], a[100:103], v[36:39], v[64:67]
    s_waitcnt vmcnt(6) lgkmcnt(0)
    s_barrier
    ds_read_b64_tr_b16 a[152:153], v192 offset:16640
    v_cvt_pk_bf16_f32 v102, v76, v77
    v_mfma_f32_16x16x32_bf16 v[64:67], a[104:107], v[40:43], v[64:67]
    ds_read_b64_tr_b16 a[154:155], v192 offset:33024
    ds_read_b64_tr_b16 a[156:157], v192 offset:16648
    v_mfma_f32_16x16x32_bf16 v[64:67], a[108:111], v[44:47], v[64:67]
    v_exp_f32 v78, v78
    v_mfma_f32_16x16x32_bf16 v[160:163], a[144:147], v[112:115], v[160:163]
    s_add_u32 m0, s30, 8320
    ds_read_b64_tr_b16 a[158:159], v192 offset:33032
    ds_read_b64_tr_b16 a[184:185], v193 offset:16640
    v_mfma_f32_16x16x32_bf16 v[160:163], a[176:179], v[132:135], v[160:163]
    s_mov_b32 s46, 65536
    v_exp_f32 v79, v79
    v_mfma_f32_16x16x32_bf16 v[160:163], a[208:211], v[136:139], v[160:163]
    ds_read_b64_tr_b16 a[186:187], v193 offset:33024
    v_cvt_pk_bf16_f32 v103, v78, v79
    v_mfma_f32_16x16x32_bf16 v[160:163], a[240:243], v[140:143], v[160:163]
    ds_write_b128 v3, v[100:103] offset:1024
    v_mfma_f32_16x16x32_bf16 v[68:71], a[112:115], v[32:35], -4.0
    v_exp_f32 v64, v64
    v_mfma_f32_16x16x32_bf16 v[68:71], a[116:119], v[36:39], v[68:71]
    ds_read_b64_tr_b16 a[188:189], v193 offset:16648
    ds_read_b64_tr_b16 a[190:191], v193 offset:33032
    v_mfma_f32_16x16x32_bf16 v[68:71], a[120:123], v[40:43], v[68:71]
    v_exp_f32 v65, v65
    v_mfma_f32_16x16x32_bf16 v[68:71], a[124:127], v[44:47], v[68:71]
    ds_read_b64_tr_b16 a[216:217], v194 offset:16640
    v_cvt_pk_bf16_f32 v104, v64, v65
    v_mfma_f32_16x16x32_bf16 v[164:167], a[148:151], v[112:115], v[164:167]
    buffer_load_dwordx4 v7, s[4:7], s46 offen offset:0 nt lds
    v_mfma_f32_16x16x32_bf16 v[164:167], a[180:183], v[132:135], v[164:167]
    ds_read_b128 v[148:151], v4 offset:5120
    ds_read_b128 v[32:35], v1 offset:24960
    ds_read_b64_tr_b16 a[218:219], v194 offset:33024
    v_mfma_f32_16x16x32_bf16 v[164:167], a[212:215], v[136:139], v[164:167]
    ds_read_b128 v[152:155], v5 offset:5120
    ds_read_b128 v[36:39], v1 offset:25216
    ds_read_b64_tr_b16 a[220:221], v194 offset:16648
    v_exp_f32 v66, v66
    v_mfma_f32_16x16x32_bf16 v[164:167], a[244:247], v[140:143], v[164:167]
    ds_read_b128 v[156:159], v6 offset:5120
    ds_read_b128 v[40:43], v1 offset:25472
    ds_read_b64_tr_b16 a[222:223], v194 offset:33032
    v_mfma_f32_16x16x32_bf16 v[72:75], a[96:99], v[48:51], -4.0
    ds_read_b128 v[44:47], v1 offset:25728
    ds_read_b64_tr_b16 a[248:249], v195 offset:16640
    v_exp_f32 v67, v67
    v_mfma_f32_16x16x32_bf16 v[72:75], a[100:103], v[52:55], v[72:75]
    ds_read_b64_tr_b16 a[250:251], v195 offset:33024
    v_cvt_pk_bf16_f32 v105, v66, v67
    v_mfma_f32_16x16x32_bf16 v[72:75], a[104:107], v[56:59], v[72:75]
    ds_read_b64_tr_b16 a[252:253], v195 offset:16648
    v_exp_f32 v68, v68
    v_mfma_f32_16x16x32_bf16 v[72:75], a[108:111], v[60:63], v[72:75]
    s_waitcnt lgkmcnt(6)
    ds_read_b64_tr_b16 a[254:255], v195 offset:33032
    ds_read_b128 v[132:135], v4 offset:6144
    v_mfma_f32_16x16x32_bf16 v[168:171], a[144:147], v[116:119], v[168:171]
    v_exp_f32 v69, v69
    v_mfma_f32_16x16x32_bf16 v[168:171], a[176:179], v[148:151], v[168:171]
    ds_read_b128 v[136:139], v5 offset:6144
    v_cvt_pk_bf16_f32 v106, v68, v69
    v_mfma_f32_16x16x32_bf16 v[168:171], a[208:211], v[152:155], v[168:171]
    v_exp_f32 v70, v70
    v_mfma_f32_16x16x32_bf16 v[168:171], a[240:243], v[156:159], v[168:171]
    buffer_load_dwordx4 v7, s[4:7], s46 offen offset:1024 nt lds
    v_mfma_f32_16x16x32_bf16 v[20:23], v[24:27], v[96:99], 0
    v_exp_f32 v71, v71
    v_mfma_f32_16x16x32_bf16 v[20:23], v[28:31], v[100:103], v[20:23]
    ds_read_b128 v[140:143], v6 offset:6144
    v_cvt_pk_bf16_f32 v107, v70, v71
    v_mfma_f32_16x16x32_bf16 v[76:79], a[112:115], v[48:51], -4.0
    ds_write_b128 v3, v[104:107] offset:2048
    v_exp_f32 v72, v72
    v_mfma_f32_16x16x32_bf16 v[76:79], a[116:119], v[52:55], v[76:79]
    v_exp_f32 v73, v73
    v_mfma_f32_16x16x32_bf16 v[76:79], a[120:123], v[56:59], v[76:79]
    ds_read_b128 v[48:51], v1 offset:29120
    v_cvt_pk_bf16_f32 v108, v72, v73
    v_mfma_f32_16x16x32_bf16 v[76:79], a[124:127], v[60:63], v[76:79]
    v_exp_f32 v74, v74
    v_mfma_f32_16x16x32_bf16 v[172:175], a[148:151], v[116:119], v[172:175]
    v_exp_f32 v75, v75
    v_mfma_f32_16x16x32_bf16 v[172:175], a[180:183], v[148:151], v[172:175]
    ds_read_b128 v[52:55], v1 offset:29376
    v_cvt_pk_bf16_f32 v109, v74, v75
    v_mfma_f32_16x16x32_bf16 v[172:175], a[212:215], v[152:155], v[172:175]
    s_waitcnt lgkmcnt(10)
    ds_read_b128 v[56:59], v1 offset:29632
    v_add_f32 v249, v249, v20
    v_mfma_f32_16x16x32_bf16 v[172:175], a[244:247], v[156:159], v[172:175]
    ds_read_b128 v[60:63], v1 offset:29888
    ds_read_b128 v[16:19], v10 offset:1024
    v_mfma_f32_16x16x32_bf16 v[64:67], a[96:99], v[32:35], -4.0
    v_exp_f32 v76, v76
    v_mfma_f32_16x16x32_bf16 v[64:67], a[100:103], v[36:39], v[64:67]
    ds_write_b32 v9, v249 offset:1536
    v_mfma_f32_16x16x32_bf16 v[64:67], a[104:107], v[40:43], v[64:67]
    v_exp_f32 v77, v77
    v_mfma_f32_16x16x32_bf16 v[64:67], a[108:111], v[44:47], v[64:67]
    s_waitcnt lgkmcnt(0)
    ds_read_b128 v[148:151], v4 offset:7168
    v_cvt_pk_bf16_f32 v110, v76, v77
    v_mfma_f32_16x16x32_bf16 v[80:83], a[152:155], v[120:123], v[80:83]
    s_barrier
L_mergedx:
    v_exp_f32 v78, v78
    v_mfma_f32_16x16x32_bf16 v[80:83], a[184:187], v[132:135], v[80:83]
    v_exp_f32 v79, v79
    v_mfma_f32_16x16x32_bf16 v[80:83], a[216:219], v[136:139], v[80:83]
    ds_read_b128 v[152:155], v5 offset:7168
    v_cvt_pk_bf16_f32 v111, v78, v79
    v_mfma_f32_16x16x32_bf16 v[80:83], a[248:251], v[140:143], v[80:83]
    ds_write_b128 v3, v[108:111] offset:3072
    v_mfma_f32_16x16x32_bf16 v[68:71], a[112:115], v[32:35], -4.0
    v_exp_f32 v64, v64
    v_mfma_f32_16x16x32_bf16 v[68:71], a[116:119], v[36:39], v[68:71]
    v_exp_f32 v65, v65
    v_mfma_f32_16x16x32_bf16 v[68:71], a[120:123], v[40:43], v[68:71]
    ds_read_b128 v[32:35], v1 offset:33280
    v_cvt_pk_bf16_f32 v112, v64, v65
    v_mfma_f32_16x16x32_bf16 v[68:71], a[124:127], v[44:47], v[68:71]
    v_exp_f32 v66, v66
    v_mfma_f32_16x16x32_bf16 v[84:87], a[156:159], v[120:123], v[84:87]
    ds_read_b128 v[36:39], v1 offset:33536
    ds_read_b128 v[156:159], v6 offset:7168
    v_mfma_f32_16x16x32_bf16 v[84:87], a[188:191], v[132:135], v[84:87]
    ds_read_b128 v[40:43], v1 offset:33792
    ds_read_b128 v[44:47], v1 offset:34048
    v_mfma_f32_16x16x32_bf16 v[84:87], a[220:223], v[136:139], v[84:87]
    v_exp_f32 v67, v67
    v_mfma_f32_16x16x32_bf16 v[84:87], a[252:255], v[140:143], v[84:87]
    v_cvt_pk_bf16_f32 v113, v66, v67
    v_add_f32 v16, v16, v17
    v_mfma_f32_16x16x32_bf16 v[72:75], a[96:99], v[48:51], -4.0
    ds_read_b128 v[132:135], v4 offset:0
    v_add_f32 v18, v18, v19
    v_mfma_f32_16x16x32_bf16 v[72:75], a[100:103], v[52:55], v[72:75]
    v_exp_f32 v68, v68
    v_mfma_f32_16x16x32_bf16 v[72:75], a[104:107], v[56:59], v[72:75]
    ds_read_b128 v[136:139], v5 offset:0
    v_add_f32 v16, v16, v18
    v_rcp_f32 v13, v16
    v_mfma_f32_16x16x32_bf16 v[72:75], a[108:111], v[60:63], v[72:75]
    s_waitcnt lgkmcnt(4)
    v_mov_b32 v14, v13
    v_max_u32 v12, v12, v13
    v_mfma_f32_16x16x32_bf16 v[88:91], a[152:155], v[124:127], v[88:91]
    v_permlane32_swap_b32 v13, v14
    v_exp_f32 v69, v69
    v_mfma_f32_16x16x32_bf16 v[88:91], a[184:187], v[148:151], v[88:91]
    v_cvt_pk_bf16_f32 v114, v68, v69
    v_mul_f32 v80, v80, v13
    v_mfma_f32_16x16x32_bf16 v[88:91], a[216:219], v[152:155], v[88:91]
    v_exp_f32 v70, v70
    v_mfma_f32_16x16x32_bf16 v[88:91], a[248:251], v[156:159], v[88:91]
    v_exp_f32 v71, v71
    v_mfma_f32_16x16x32_bf16 v[20:23], v[24:27], v[104:107], 0
    v_cvt_pk_bf16_f32 v115, v70, v71
    v_mul_f32 v81, v81, v13
    v_mfma_f32_16x16x32_bf16 v[20:23], v[28:31], v[108:111], v[20:23]
    ds_write_b128 v3, v[112:115] offset:4096
    v_mfma_f32_16x16x32_bf16 v[76:79], a[112:115], v[48:51], -4.0
    v_exp_f32 v72, v72
    v_cvt_pk_bf16_f32 v192, v80, v81
    v_mfma_f32_16x16x32_bf16 v[76:79], a[116:119], v[52:55], v[76:79]
    v_max_u32 v11, v11, v16
    v_mul_f32 v82, v82, v13
    v_mfma_f32_16x16x32_bf16 v[76:79], a[120:123], v[56:59], v[76:79]
    v_exp_f32 v73, v73
    v_mfma_f32_16x16x32_bf16 v[76:79], a[124:127], v[60:63], v[76:79]
    v_cvt_pk_bf16_f32 v116, v72, v73
    v_mul_f32 v83, v83, v13
    v_mfma_f32_16x16x32_bf16 v[92:95], a[156:159], v[124:127], v[92:95]
    v_exp_f32 v74, v74
    v_cvt_pk_bf16_f32 v193, v82, v83
    v_mfma_f32_16x16x32_bf16 v[92:95], a[188:191], v[148:151], v[92:95]
    ds_read_b128 v[48:51], v1 offset:37440
    v_mul_f32 v84, v84, v13
    v_mfma_f32_16x16x32_bf16 v[92:95], a[220:223], v[152:155], v[92:95]
    s_waitcnt lgkmcnt(4)
    ds_read_b128 v[52:55], v1 offset:37696
    v_exp_f32 v75, v75
    v_mfma_f32_16x16x32_bf16 v[92:95], a[252:255], v[156:159], v[92:95]
    ds_read_b128 v[140:143], v6 offset:0
    ds_read_b128 v[56:59], v1 offset:37952
    v_cvt_pk_bf16_f32 v117, v74, v75
    v_mul_f32 v85, v85, v13
    v_mfma_f32_16x16x32_bf16 v[64:67], a[96:99], v[32:35], -4.0
    ds_read_b128 v[60:63], v1 offset:38208
    v_add_f32 v250, v250, v20
    v_cvt_pk_bf16_f32 v194, v84, v85
    v_mfma_f32_16x16x32_bf16 v[64:67], a[100:103], v[36:39], v[64:67]
    v_mul_f32 v86, v86, v13
    v_mul_f32 v87, v87, v13
    v_mfma_f32_16x16x32_bf16 v[64:67], a[104:107], v[40:43], v[64:67]
    ds_write_b32 v9, v250 offset:2048
    v_exp_f32 v76, v76
    v_mfma_f32_16x16x32_bf16 v[64:67], a[108:111], v[44:47], v[64:67]
    s_waitcnt vmcnt(6) lgkmcnt(0)
    v_exp_f32 v77, v77
    v_mfma_f32_16x16x32_bf16 v[176:179], a[152:155], v[96:99], v[176:179]
    s_barrier
    v_cvt_pk_bf16_f32 v195, v86, v87
    v_cvt_pk_bf16_f32 v118, v76, v77
    v_mfma_f32_16x16x32_bf16 v[176:179], a[184:187], v[132:135], v[176:179]
    v_mul_f32 v88, v88, v14
    v_mul_f32 v89, v89, v14
    v_mfma_f32_16x16x32_bf16 v[176:179], a[216:219], v[136:139], v[176:179]
    v_exp_f32 v78, v78
    v_mfma_f32_16x16x32_bf16 v[176:179], a[248:251], v[140:143], v[176:179]
    buffer_store_dwordx4 v[192:195], v8, s[16:19], s25 offen sc0 sc1
    v_mfma_f32_16x16x32_bf16 v[68:71], a[112:115], v[32:35], -4.0
    s_add_u32 s25, s25, 8192
    v_exp_f32 v79, v79
    v_cvt_pk_bf16_f32 v196, v88, v89
    v_mfma_f32_16x16x32_bf16 v[68:71], a[116:119], v[36:39], v[68:71]
    v_cvt_pk_bf16_f32 v119, v78, v79
    v_mul_f32 v90, v90, v14
    v_mfma_f32_16x16x32_bf16 v[68:71], a[120:123], v[40:43], v[68:71]
    ds_write_b128 v3, v[116:119] offset:5120
    v_exp_f32 v64, v64
    v_mul_f32 v91, v91, v14
    v_mfma_f32_16x16x32_bf16 v[68:71], a[124:127], v[44:47], v[68:71]
    v_exp_f32 v65, v65
    v_mfma_f32_16x16x32_bf16 v[180:183], a[156:159], v[96:99], v[180:183]
    v_cvt_pk_bf16_f32 v197, v90, v91
    v_cvt_pk_bf16_f32 v120, v64, v65
    v_mfma_f32_16x16x32_bf16 v[180:183], a[188:191], v[132:135], v[180:183]
    ds_read_b128 v[148:151], v4 offset:1024
    ds_read_b128 v[32:35], v1 offset:41600
    v_mul_f32 v92, v92, v14
    v_mfma_f32_16x16x32_bf16 v[180:183], a[220:223], v[136:139], v[180:183]
    ds_read_b128 v[152:155], v5 offset:1024
    ds_read_b128 v[36:39], v1 offset:41856
    v_exp_f32 v66, v66
    v_mul_f32 v93, v93, v14
    v_mfma_f32_16x16x32_bf16 v[180:183], a[252:255], v[140:143], v[180:183]
    ds_read_b128 v[156:159], v6 offset:1024
    ds_read_b128 v[40:43], v1 offset:42112
    v_cvt_pk_bf16_f32 v198, v92, v93
    v_mfma_f32_16x16x32_bf16 v[72:75], a[96:99], v[48:51], -4.0
    ds_read_b128 v[44:47], v1 offset:42368
    v_exp_f32 v67, v67
    v_mfma_f32_16x16x32_bf16 v[72:75], a[100:103], v[52:55], v[72:75]
    v_cvt_pk_bf16_f32 v121, v66, v67
    v_mul_f32 v94, v94, v14
    v_mfma_f32_16x16x32_bf16 v[72:75], a[104:107], v[56:59], v[72:75]
    v_exp_f32 v68, v68
    v_mul_f32 v95, v95, v14
    v_mfma_f32_16x16x32_bf16 v[72:75], a[108:111], v[60:63], v[72:75]
    s_waitcnt lgkmcnt(2)
    ds_read_b128 v[16:19], v10 offset:1536
    v_cvt_pk_bf16_f32 v199, v94, v95
    v_mfma_f32_16x16x32_bf16 v[184:187], a[152:155], v[100:103], v[184:187]
    v_exp_f32 v69, v69
    v_mfma_f32_16x16x32_bf16 v[184:187], a[184:187], v[148:151], v[184:187]
    ds_read_b128 v[132:135], v4 offset:2048
    v_cvt_pk_bf16_f32 v122, v68, v69
    v_mfma_f32_16x16x32_bf16 v[184:187], a[216:219], v[152:155], v[184:187]
    buffer_store_dwordx4 v[196:199], v8, s[16:19], s26 offen sc0 sc1
    v_exp_f32 v70, v70
    v_mfma_f32_16x16x32_bf16 v[184:187], a[248:251], v[156:159], v[184:187]
    s_add_u32 s26, s26, 8192
    ds_read_b128 v[136:139], v5 offset:2048
    v_mfma_f32_16x16x32_bf16 v[20:23], v[24:27], v[112:115], 0
    v_exp_f32 v71, v71
    v_mfma_f32_16x16x32_bf16 v[20:23], v[28:31], v[116:119], v[20:23]
    s_waitcnt lgkmcnt(2)
    v_cvt_pk_bf16_f32 v123, v70, v71
    v_add_f32 v16, v16, v17
    v_mfma_f32_16x16x32_bf16 v[76:79], a[112:115], v[48:51], -4.0
    ds_write_b128 v3, v[120:123] offset:6144
    v_exp_f32 v72, v72
    v_mfma_f32_16x16x32_bf16 v[76:79], a[116:119], v[52:55], v[76:79]
    v_exp_f32 v73, v73
    v_mfma_f32_16x16x32_bf16 v[76:79], a[120:123], v[56:59], v[76:79]
    ds_read_b128 v[48:51], v1 offset:45760
    v_cvt_pk_bf16_f32 v124, v72, v73
    v_mfma_f32_16x16x32_bf16 v[76:79], a[124:127], v[60:63], v[76:79]
    v_exp_f32 v74, v74
    v_mfma_f32_16x16x32_bf16 v[188:191], a[156:159], v[100:103], v[188:191]
    v_exp_f32 v75, v75
    v_mfma_f32_16x16x32_bf16 v[188:191], a[188:191], v[148:151], v[188:191]
    ds_read_b128 v[52:55], v1 offset:46016
    v_cvt_pk_bf16_f32 v125, v74, v75
    v_mfma_f32_16x16x32_bf16 v[188:191], a[220:223], v[152:155], v[188:191]
    ds_read_b128 v[56:59], v1 offset:46272
    v_add_f32 v251, v251, v20
    v_mfma_f32_16x16x32_bf16 v[188:191], a[252:255], v[156:159], v[188:191]
    ds_read_b128 v[60:63], v1 offset:46528
    v_add_f32 v18, v18, v19
    v_mfma_f32_16x16x32_bf16 v[88:91], a[0:3], v[32:35], -4.0
    v_exp_f32 v76, v76
    v_mfma_f32_16x16x32_bf16 v[88:91], a[4:7], v[36:39], v[88:91]
    ds_write_b32 v9, v251 offset:2560
    v_mfma_f32_16x16x32_bf16 v[88:91], a[8:11], v[40:43], v[88:91]
    ds_read_b128 v[140:143], v6 offset:2048
    v_add_f32 v16, v16, v18
    v_mfma_f32_16x16x32_bf16 v[88:91], a[12:15], v[44:47], v[88:91]
    v_rcp_f32 v13, v16
    v_mfma_f32_16x16x32_bf16 v[92:95], a[16:19], v[32:35], -4.0
    v_exp_f32 v77, v77
    v_mov_b32 v14, v13
    v_max_u32 v12, v12, v13
    v_mfma_f32_16x16x32_bf16 v[92:95], a[20:23], v[36:39], v[92:95]
    v_permlane32_swap_b32 v13, v14
    v_cvt_pk_bf16_f32 v126, v76, v77
    v_mfma_f32_16x16x32_bf16 v[92:95], a[24:27], v[40:43], v[92:95]
    s_waitcnt vmcnt(6) lgkmcnt(0)
    v_exp_f32 v78, v78
    v_mfma_f32_16x16x32_bf16 v[92:95], a[28:31], v[44:47], v[92:95]
    s_barrier
    v_exp_f32 v79, v79
    v_mfma_f32_16x16x32_bf16 v[200:203], a[152:155], v[104:107], v[200:203]
    s_mov_b32 m0, s23
    v_cvt_pk_bf16_f32 v127, v78, v79
    v_max_u32 v11, v11, v16
    v_mfma_f32_16x16x32_bf16 v[200:203], a[184:187], v[132:135], v[200:203]
    s_add_u32 s24, s24, 8320
    ds_read_b128 v[16:19], v10 offset:2048
    ds_read_b128 v[148:151], v4 offset:3072
    v_mfma_f32_16x16x32_bf16 v[200:203], a[216:219], v[136:139], v[200:203]
    s_cmp_eq_u32 s24, 124800
    ds_write_b128 v3, v[124:127] offset:7168
    v_exp_f32 v88, v88
    v_mfma_f32_16x16x32_bf16 v[200:203], a[248:251], v[140:143], v[200:203]
    v_exp_f32 v89, v89
    v_mfma_f32_16x16x32_bf16 v[204:207], a[156:159], v[104:107], v[204:207]
    s_cselect_b32 s24, 66560, s24
    v_exp_f32 v92, v92
    v_mfma_f32_16x16x32_bf16 v[204:207], a[188:191], v[132:135], v[204:207]
    s_add_u32 s23, s23, 8320
    ds_read_b128 v[152:155], v5 offset:3072
    v_mul_f32 v176, v176, v13
    v_mfma_f32_16x16x32_bf16 v[204:207], a[220:223], v[136:139], v[204:207]
    s_cmp_eq_u32 s23, s27
    v_exp_f32 v90, v90
    v_exp_f32 v93, v93
    v_mul_f32 v177, v177, v13
    v_mfma_f32_16x16x32_bf16 v[204:207], a[252:255], v[140:143], v[204:207]
    s_waitcnt lgkmcnt(3)
    ds_read_b128 v[156:159], v6 offset:3072
    v_add_f32 v16, v16, v17
    v_add_f32 v18, v18, v19
    v_add_f32 v16, v16, v18
    v_cvt_pk_bf16_f32 v98, v92, v93
    v_cvt_pk_bf16_f32 v192, v176, v177
    v_mfma_f32_16x16x32_bf16 v[64:67], a[0:3], v[48:51], -4.0
    s_cselect_b32 s23, s30, s23
    v_exp_f32 v91, v91
    v_cvt_pk_bf16_f32 v96, v88, v89
    v_cvt_pk_bf16_f32 v97, v90, v91
    v_exp_f32 v94, v94
    v_mul_f32 v178, v178, v13
    v_mfma_f32_16x16x32_bf16 v[64:67], a[4:7], v[52:55], v[64:67]
    buffer_load_dwordx4 v7, s[4:7], s22 offen offset:0 nt lds
    v_mul_f32 v179, v179, v13
    v_mfma_f32_16x16x32_bf16 v[64:67], a[8:11], v[56:59], v[64:67]
    v_exp_f32 v95, v95
    v_mfma_f32_16x16x32_bf16 v[64:67], a[12:15], v[60:63], v[64:67]
    s_waitcnt lgkmcnt(0)
    v_cvt_pk_bf16_f32 v99, v94, v95
    v_cvt_pk_bf16_f32 v193, v178, v179
    v_mfma_f32_16x16x32_bf16 v[208:211], a[152:155], v[108:111], v[208:211]
    ds_write_b128 v3, v[96:99] offset:33280
    v_mul_f32 v180, v180, v13
    v_mfma_f32_16x16x32_bf16 v[208:211], a[184:187], v[148:151], v[208:211]
    buffer_load_dwordx4 v7, s[4:7], s22 offen offset:1024 nt lds
    v_max_u32 v11, v11, v16
    v_mul_f32 v181, v181, v13
    v_mfma_f32_16x16x32_bf16 v[208:211], a[216:219], v[152:155], v[208:211]
    s_add_u32 s22, s22, 8192
    v_cvt_pk_bf16_f32 v194, v180, v181
    v_mul_f32 v182, v182, v13
    v_mfma_f32_16x16x32_bf16 v[208:211], a[248:251], v[156:159], v[208:211]
    v_exp_f32 v64, v64
    v_mfma_f32_16x16x32_bf16 v[68:71], a[16:19], v[48:51], -4.0
    v_mul_f32 v183, v183, v13
    v_cvt_pk_bf16_f32 v195, v182, v183
    v_mfma_f32_16x16x32_bf16 v[68:71], a[20:23], v[52:55], v[68:71]
    v_exp_f32 v65, v65
    v_mfma_f32_16x16x32_bf16 v[68:71], a[24:27], v[56:59], v[68:71]
    v_cvt_pk_bf16_f32 v100, v64, v65
    v_mul_f32 v184, v184, v14
    v_mfma_f32_16x16x32_bf16 v[68:71], a[28:31], v[60:63], v[68:71]
    buffer_store_dwordx4 v[192:195], v8, s[16:19], s25 offen sc0 sc1
    v_mfma_f32_16x16x32_bf16 v[20:23], v[24:27], v[120:123], 0
    s_add_u32 s25, s25, 8192
    v_exp_f32 v66, v66
    v_mul_f32 v185, v185, v14
    v_mfma_f32_16x16x32_bf16 v[20:23], v[28:31], v[124:127], v[20:23]
    v_cvt_pk_bf16_f32 v196, v184, v185
    v_mul_f32 v186, v186, v14
    v_mfma_f32_16x16x32_bf16 v[72:75], a[32:35], v[32:35], -4.0
    v_exp_f32 v67, v67
    v_mfma_f32_16x16x32_bf16 v[72:75], a[36:39], v[36:39], v[72:75]
    v_cvt_pk_bf16_f32 v101, v66, v67
    v_mul_f32 v187, v187, v14
    v_mfma_f32_16x16x32_bf16 v[72:75], a[40:43], v[40:43], v[72:75]
    v_exp_f32 v68, v68
    v_mfma_f32_16x16x32_bf16 v[72:75], a[44:47], v[44:47], v[72:75]
    ds_read_b128 v[128:131], v3 offset:4096
    v_cvt_pk_bf16_f32 v197, v186, v187
    v_mfma_f32_16x16x32_bf16 v[212:215], a[156:159], v[108:111], v[212:215]
    s_barrier
    v_exp_f32 v69, v69
    v_mul_f32 v188, v188, v14
    v_mfma_f32_16x16x32_bf16 v[212:215], a[188:191], v[148:151], v[212:215]
    ds_read_b128 v[132:135], v4 offset:4096
    v_cvt_pk_bf16_f32 v102, v68, v69
    v_mul_f32 v189, v189, v14
    v_mfma_f32_16x16x32_bf16 v[212:215], a[220:223], v[152:155], v[212:215]
    ds_read_b128 v[136:139], v5 offset:4096
    v_exp_f32 v70, v70
    v_mfma_f32_16x16x32_bf16 v[212:215], a[252:255], v[156:159], v[212:215]
    ds_read_b128 v[140:143], v6 offset:4096
    v_cvt_pk_bf16_f32 v198, v188, v189
    v_mfma_f32_16x16x32_bf16 v[76:79], a[48:51], v[32:35], -4.0
    v_exp_f32 v71, v71
    v_exp_f32 v72, v72
    v_add_f32 v252, v252, v20
    v_mul_f32 v190, v190, v14
    v_mfma_f32_16x16x32_bf16 v[76:79], a[52:55], v[36:39], v[76:79]
    v_cvt_pk_bf16_f32 v103, v70, v71
    v_mul_f32 v191, v191, v14
    v_rcp_f32 v13, v16
    v_mfma_f32_16x16x32_bf16 v[76:79], a[56:59], v[40:43], v[76:79]
    ds_write_b128 v3, v[100:103] offset:34304
    ds_write_b32 v9, v252 offset:0
    v_mov_b32 v14, v13
    v_max_u32 v12, v12, v13
    v_exp_f32 v73, v73
    v_permlane32_swap_b32 v13, v14
    v_mul_f32 v200, v200, v13
    v_mul_f32 v201, v201, v13
    v_mul_f32 v202, v202, v13
    v_mul_f32 v203, v203, v13
    v_mul_f32 v204, v204, v13
    v_mul_f32 v205, v205, v13
    v_mul_f32 v206, v206, v13
    v_mul_f32 v207, v207, v13
    v_mul_f32 v208, v208, v14
    v_mul_f32 v209, v209, v14
    v_mul_f32 v210, v210, v14
    v_cvt_pk_bf16_f32 v199, v190, v191
    v_mfma_f32_16x16x32_bf16 v[76:79], a[60:63], v[44:47], v[76:79]
    s_waitcnt lgkmcnt(2)
    ds_read_b128 v[16:19], v10 offset:2560
    v_cvt_pk_bf16_f32 v104, v72, v73
    v_mul_f32 v211, v211, v14
    v_mfma_f32_16x16x32_bf16 v[216:219], a[152:155], v[128:131], v[216:219]
    v_exp_f32 v74, v74
    v_mfma_f32_16x16x32_bf16 v[216:219], a[184:187], v[132:135], v[216:219]
    buffer_store_dwordx4 v[196:199], v8, s[16:19], s26 offen sc0 sc1
    s_add_u32 s26, s26, 8192
    v_cvt_pk_bf16_f32 v192, v200, v201
    v_cvt_pk_bf16_f32 v193, v202, v203
    v_cvt_pk_bf16_f32 v194, v204, v205
    v_cvt_pk_bf16_f32 v195, v206, v207
    v_cvt_pk_bf16_f32 v196, v208, v209
    v_cvt_pk_bf16_f32 v197, v210, v211
    v_mul_f32 v212, v212, v14
    v_mfma_f32_16x16x32_bf16 v[216:219], a[216:219], v[136:139], v[216:219]
    v_exp_f32 v75, v75
    v_mul_f32 v213, v213, v14
    v_mfma_f32_16x16x32_bf16 v[216:219], a[248:251], v[140:143], v[216:219]
    s_waitcnt lgkmcnt(0)
    v_cvt_pk_bf16_f32 v105, v74, v75
    v_cvt_pk_bf16_f32 v198, v212, v213
    v_mfma_f32_16x16x32_bf16 v[80:83], a[32:35], v[48:51], -4.0
    buffer_store_dwordx4 v[192:195], v8, s[16:19], s25 offen sc0 sc1
    v_exp_f32 v76, v76
    v_mfma_f32_16x16x32_bf16 v[80:83], a[36:39], v[52:55], v[80:83]
    s_add_u32 s25, s25, 8192
    v_add_f32 v16, v16, v17
    v_add_f32 v18, v18, v19
    v_add_f32 v16, v16, v18
    v_mul_f32 v214, v214, v14
    v_mfma_f32_16x16x32_bf16 v[80:83], a[40:43], v[56:59], v[80:83]
    v_exp_f32 v77, v77
    v_mul_f32 v215, v215, v14
    v_rcp_f32 v13, v16
    v_mfma_f32_16x16x32_bf16 v[80:83], a[44:47], v[60:63], v[80:83]
    v_mov_b32 v14, v13
    v_max_u32 v12, v12, v13
    v_cvt_pk_bf16_f32 v106, v76, v77
    v_permlane32_swap_b32 v13, v14
    v_cvt_pk_bf16_f32 v199, v214, v215
    v_mfma_f32_16x16x32_bf16 v[84:87], a[48:51], v[48:51], -4.0
    v_exp_f32 v78, v78
    v_mfma_f32_16x16x32_bf16 v[84:87], a[52:55], v[52:55], v[84:87]
    v_exp_f32 v79, v79
    v_mfma_f32_16x16x32_bf16 v[84:87], a[56:59], v[56:59], v[84:87]
    buffer_store_dwordx4 v[196:199], v8, s[16:19], s26 offen sc0 sc1
    s_add_u32 s26, s26, 8192
    v_mfma_f32_16x16x32_bf16 v[84:87], a[60:63], v[60:63], v[84:87]
    v_cvt_pk_bf16_f32 v107, v78, v79
    v_max_u32 v11, v11, v16
    v_mfma_f32_16x16x32_bf16 v[220:223], a[156:159], v[128:131], v[220:223]
    ds_write_b128 v3, v[104:107] offset:35328
    v_exp_f32 v80, v80
    v_mfma_f32_16x16x32_bf16 v[220:223], a[188:191], v[132:135], v[220:223]
    v_exp_f32 v81, v81
    v_mfma_f32_16x16x32_bf16 v[220:223], a[220:223], v[136:139], v[220:223]
    v_mul_f32 v216, v216, v13
    v_cvt_pk_bf16_f32 v108, v80, v81
    v_mfma_f32_16x16x32_bf16 v[220:223], a[252:255], v[140:143], v[220:223]
    ds_read_b128 v[144:147], v3 offset:5120
    v_mul_f32 v217, v217, v13
    v_mfma_f32_16x16x32_bf16 v[88:91], a[64:67], v[32:35], -4.0
    v_exp_f32 v82, v82
    v_exp_f32 v84, v84
    v_cvt_pk_bf16_f32 v192, v216, v217
    v_mfma_f32_16x16x32_bf16 v[88:91], a[68:71], v[36:39], v[88:91]
    ds_read_b128 v[148:151], v4 offset:5120
    v_mul_f32 v218, v218, v13
    v_mfma_f32_16x16x32_bf16 v[88:91], a[72:75], v[40:43], v[88:91]
    ds_read_b128 v[152:155], v5 offset:5120
    v_exp_f32 v83, v83
    v_exp_f32 v85, v85
    v_mul_f32 v219, v219, v13
    v_mfma_f32_16x16x32_bf16 v[88:91], a[76:79], v[44:47], v[88:91]
    ds_read_b128 v[156:159], v6 offset:5120
    v_cvt_pk_bf16_f32 v109, v82, v83
    v_cvt_pk_bf16_f32 v110, v84, v85
    v_mfma_f32_16x16x32_bf16 v[92:95], a[80:83], v[32:35], -4.0
    v_exp_f32 v86, v86
    v_cvt_pk_bf16_f32 v193, v218, v219
    v_mfma_f32_16x16x32_bf16 v[92:95], a[84:87], v[36:39], v[92:95]
    v_mul_f32 v220, v220, v13
    v_mul_f32 v221, v221, v13
    v_mfma_f32_16x16x32_bf16 v[92:95], a[88:91], v[40:43], v[92:95]
    v_exp_f32 v87, v87
    v_mfma_f32_16x16x32_bf16 v[92:95], a[92:95], v[44:47], v[92:95]
    s_waitcnt lgkmcnt(0)
    v_cvt_pk_bf16_f32 v111, v86, v87
    v_cvt_pk_bf16_f32 v194, v220, v221
    v_mfma_f32_16x16x32_bf16 v[224:227], a[152:155], v[144:147], v[224:227]
    ds_write_b128 v3, v[108:111] offset:36352
    v_exp_f32 v88, v88
    v_mul_f32 v222, v222, v13
    v_mfma_f32_16x16x32_bf16 v[224:227], a[184:187], v[148:151], v[224:227]
    v_exp_f32 v89, v89
    v_mfma_f32_16x16x32_bf16 v[224:227], a[216:219], v[152:155], v[224:227]
    v_mul_f32 v223, v223, v13
    v_cvt_pk_bf16_f32 v112, v88, v89
    v_mfma_f32_16x16x32_bf16 v[224:227], a[248:251], v[156:159], v[224:227]
    v_cvt_pk_bf16_f32 v195, v222, v223
    v_add_u32 v1, s24, v2
    v_mfma_f32_16x16x32_bf16 v[64:67], a[64:67], v[48:51], -4.0
    v_exp_f32 v90, v90
    v_exp_f32 v92, v92
    v_mfma_f32_16x16x32_bf16 v[64:67], a[68:71], v[52:55], v[64:67]
    v_exp_f32 v91, v91
    v_mfma_f32_16x16x32_bf16 v[64:67], a[72:75], v[56:59], v[64:67]
    buffer_store_dwordx4 v[192:195], v8, s[16:19], s25 offen sc0 sc1
    v_mul_f32 v224, v224, v14
    v_mul_f32 v225, v225, v14
    v_exp_f32 v93, v93
    v_cvt_pk_bf16_f32 v196, v224, v225
    v_mfma_f32_16x16x32_bf16 v[64:67], a[76:79], v[60:63], v[64:67]
    v_cvt_pk_bf16_f32 v113, v90, v91
    v_cvt_pk_bf16_f32 v114, v92, v93
    v_mfma_f32_16x16x32_bf16 v[68:71], a[80:83], v[48:51], -4.0
    s_add_u32 s25, s25, 8192
    v_exp_f32 v94, v94
    v_mul_f32 v226, v226, v14
    v_mfma_f32_16x16x32_bf16 v[68:71], a[84:87], v[52:55], v[68:71]
    ds_read_b128 v[128:131], v3 offset:6144
    v_mul_f32 v227, v227, v14
    v_mfma_f32_16x16x32_bf16 v[68:71], a[88:91], v[56:59], v[68:71]
    v_exp_f32 v95, v95
    v_cvt_pk_bf16_f32 v197, v226, v227
    v_mfma_f32_16x16x32_bf16 v[68:71], a[92:95], v[60:63], v[68:71]
    ds_read_b128 v[132:135], v4 offset:6144
    v_cvt_pk_bf16_f32 v115, v94, v95
    v_mfma_f32_16x16x32_bf16 v[228:231], a[156:159], v[144:147], v[228:231]
    ds_write_b128 v3, v[112:115] offset:37376
    v_exp_f32 v64, v64
    v_mfma_f32_16x16x32_bf16 v[228:231], a[188:191], v[148:151], v[228:231]
    v_exp_f32 v65, v65
    v_mfma_f32_16x16x32_bf16 v[228:231], a[220:223], v[152:155], v[228:231]
    ds_read_b128 v[136:139], v5 offset:6144
    v_cvt_pk_bf16_f32 v116, v64, v65
    v_mfma_f32_16x16x32_bf16 v[228:231], a[252:255], v[156:159], v[228:231]
    v_exp_f32 v66, v66
    v_mfma_f32_16x16x32_bf16 v[72:75], a[96:99], v[32:35], -4.0
    v_exp_f32 v68, v68
    v_mfma_f32_16x16x32_bf16 v[72:75], a[100:103], v[36:39], v[72:75]
    v_exp_f32 v67, v67
    v_mfma_f32_16x16x32_bf16 v[72:75], a[104:107], v[40:43], v[72:75]
    v_exp_f32 v69, v69
    v_mfma_f32_16x16x32_bf16 v[72:75], a[108:111], v[44:47], v[72:75]
    ds_read_b128 v[140:143], v6 offset:6144
    v_mul_f32 v228, v228, v14
    v_mul_f32 v229, v229, v14
    v_cvt_pk_bf16_f32 v198, v228, v229
    v_mul_f32 v230, v230, v14
    v_mul_f32 v231, v231, v14
    v_cvt_pk_bf16_f32 v199, v230, v231
    v_cvt_pk_bf16_f32 v117, v66, v67
    v_cvt_pk_bf16_f32 v118, v68, v69
    v_mfma_f32_16x16x32_bf16 v[76:79], a[112:115], v[32:35], -4.0
    v_exp_f32 v70, v70
    v_mfma_f32_16x16x32_bf16 v[76:79], a[116:119], v[36:39], v[76:79]
    v_exp_f32 v71, v71
    v_mfma_f32_16x16x32_bf16 v[76:79], a[120:123], v[40:43], v[76:79]
    buffer_store_dwordx4 v[196:199], v8, s[16:19], s26 offen sc0 sc1
    s_add_u32 s26, s26, 8192
    v_mfma_f32_16x16x32_bf16 v[76:79], a[124:127], v[44:47], v[76:79]
    s_waitcnt lgkmcnt(0)
    ds_read_b128 v[32:35], v1 offset:0
    v_cvt_pk_bf16_f32 v119, v70, v71
    v_mfma_f32_16x16x32_bf16 v[160:163], a[152:155], v[128:131], v[160:163]
    ds_write_b128 v3, v[116:119] offset:38400
    v_exp_f32 v72, v72
    v_mfma_f32_16x16x32_bf16 v[160:163], a[184:187], v[132:135], v[160:163]
    v_exp_f32 v73, v73
    v_mfma_f32_16x16x32_bf16 v[160:163], a[216:219], v[136:139], v[160:163]
    ds_read_b128 v[36:39], v1 offset:256
    v_cvt_pk_bf16_f32 v120, v72, v73
    v_mfma_f32_16x16x32_bf16 v[160:163], a[248:251], v[140:143], v[160:163]
    ds_read_b128 v[40:43], v1 offset:512
    ds_read_b128 v[44:47], v1 offset:768
    v_mfma_f32_16x16x32_bf16 v[80:83], a[96:99], v[48:51], -4.0
    v_exp_f32 v74, v74
    v_exp_f32 v76, v76
    v_mfma_f32_16x16x32_bf16 v[80:83], a[100:103], v[52:55], v[80:83]
    v_exp_f32 v75, v75
    v_mfma_f32_16x16x32_bf16 v[80:83], a[104:107], v[56:59], v[80:83]
    v_exp_f32 v77, v77
    v_mfma_f32_16x16x32_bf16 v[80:83], a[108:111], v[60:63], v[80:83]
    v_cvt_pk_bf16_f32 v121, v74, v75
    v_cvt_pk_bf16_f32 v122, v76, v77
    v_mfma_f32_16x16x32_bf16 v[84:87], a[112:115], v[48:51], -4.0
    v_exp_f32 v78, v78
    v_mfma_f32_16x16x32_bf16 v[84:87], a[116:119], v[52:55], v[84:87]
    v_exp_f32 v79, v79
    v_mfma_f32_16x16x32_bf16 v[84:87], a[120:123], v[56:59], v[84:87]
    ds_read_b128 v[144:147], v3 offset:7168
    v_cvt_pk_bf16_f32 v123, v78, v79
    v_mfma_f32_16x16x32_bf16 v[84:87], a[124:127], v[60:63], v[84:87]
    v_exp_f32 v80, v80
    v_mfma_f32_16x16x32_bf16 v[164:167], a[156:159], v[128:131], v[164:167]
    ds_write_b128 v3, v[120:123] offset:39424
    v_mfma_f32_16x16x32_bf16 v[164:167], a[188:191], v[132:135], v[164:167]
    ds_read_b128 v[48:51], v1 offset:4160
    ds_read_b128 v[148:151], v4 offset:7168
    v_mfma_f32_16x16x32_bf16 v[164:167], a[220:223], v[136:139], v[164:167]
    ds_read_b128 v[52:55], v1 offset:4416
    ds_read_b128 v[152:155], v5 offset:7168
    v_exp_f32 v81, v81
    v_mfma_f32_16x16x32_bf16 v[164:167], a[252:255], v[140:143], v[164:167]
    s_waitcnt lgkmcnt(6)
    ds_read_b128 v[56:59], v1 offset:4672
    ds_read_b128 v[156:159], v6 offset:7168
    v_cvt_pk_bf16_f32 v124, v80, v81
    v_mfma_f32_16x16x32_bf16 v[88:91], a[0:3], v[32:35], -4.0
    ds_read_b128 v[60:63], v1 offset:4928
    v_exp_f32 v82, v82
    v_exp_f32 v84, v84
    v_mfma_f32_16x16x32_bf16 v[88:91], a[4:7], v[36:39], v[88:91]
    v_exp_f32 v83, v83
    v_mfma_f32_16x16x32_bf16 v[88:91], a[8:11], v[40:43], v[88:91]
    v_exp_f32 v85, v85
    v_mfma_f32_16x16x32_bf16 v[88:91], a[12:15], v[44:47], v[88:91]
    s_waitcnt lgkmcnt(1)
    v_cvt_pk_bf16_f32 v125, v82, v83
    v_cvt_pk_bf16_f32 v126, v84, v85
    v_mfma_f32_16x16x32_bf16 v[168:171], a[152:155], v[144:147], v[168:171]
    v_exp_f32 v86, v86
    v_mfma_f32_16x16x32_bf16 v[168:171], a[184:187], v[148:151], v[168:171]
    v_exp_f32 v87, v87
    v_mfma_f32_16x16x32_bf16 v[168:171], a[216:219], v[152:155], v[168:171]
    v_cvt_pk_bf16_f32 v127, v86, v87
    v_mfma_f32_16x16x32_bf16 v[168:171], a[248:251], v[156:159], v[168:171]
    v_exp_f32 v88, v88
    v_mfma_f32_16x16x32_bf16 v[92:95], a[16:19], v[32:35], -4.0
    ds_write_b128 v3, v[124:127] offset:40448
    v_mfma_f32_16x16x32_bf16 v[92:95], a[20:23], v[36:39], v[92:95]
    v_exp_f32 v89, v89
    v_mfma_f32_16x16x32_bf16 v[92:95], a[24:27], v[40:43], v[92:95]
    v_exp_f32 v90, v90
    v_mfma_f32_16x16x32_bf16 v[92:95], a[28:31], v[44:47], v[92:95]
    v_exp_f32 v91, v91
    v_mfma_f32_16x16x32_bf16 v[172:175], a[156:159], v[144:147], v[172:175]
    v_mfma_f32_16x16x32_bf16 v[172:175], a[188:191], v[148:151], v[172:175]
    v_mfma_f32_16x16x32_bf16 v[172:175], a[220:223], v[152:155], v[172:175]
    s_waitcnt vmcnt(12) lgkmcnt(0)
    v_mfma_f32_16x16x32_bf16 v[172:175], a[252:255], v[156:159], v[172:175]
    s_barrier
    s_mov_b32 s21, 17
    s_cmp_ge_u32 s20, 2
    s_cbranch_scc1 L_loop1
L_xj:
    .p2align 6
L_loop0:
    v_mfma_f32_16x16x32_bf16 v[176:179], a[128:131], v[96:99], v[240:243]
    s_add_u32 s24, s24, 8320
    ds_read_b128 v[16:19], v10 offset:0
    ds_read_b128 v[128:131], v4 offset:33280
    v_mfma_f32_16x16x32_bf16 v[176:179], a[136:139], v[104:107], v[176:179]
    s_cmp_eq_u32 s24, 124800
    v_exp_f32 v92, v92
    v_mfma_f32_16x16x32_bf16 v[176:179], a[144:147], v[112:115], v[176:179]
    s_cselect_b32 s24, 66560, s24
    ds_read_b128 v[132:135], v4 offset:35328
    ds_read_b128 v[136:139], v4 offset:37376
    v_mfma_f32_16x16x32_bf16 v[176:179], a[152:155], v[120:123], v[176:179]
    v_exp_f32 v93, v93
    v_mfma_f32_16x16x32_bf16 v[180:183], a[132:135], v[96:99], v[240:243]
    s_mov_b32 m0, s23
    ds_read_b128 v[140:143], v4 offset:39424
    ds_read_b128 v[144:147], v4 offset:34304
    v_mfma_f32_16x16x32_bf16 v[180:183], a[140:143], v[104:107], v[180:183]
    s_add_u32 s23, s23, 8320
    v_exp_f32 v94, v94
    v_mfma_f32_16x16x32_bf16 v[180:183], a[148:151], v[112:115], v[180:183]
    s_cmp_eq_u32 s23, s27
    ds_read_b128 v[148:151], v4 offset:36352
    ds_read_b128 v[152:155], v4 offset:38400
    v_mfma_f32_16x16x32_bf16 v[180:183], a[156:159], v[120:123], v[180:183]
    s_waitcnt lgkmcnt(7)
    v_exp_f32 v95, v95
    v_mfma_f32_16x16x32_bf16 v[64:67], a[0:3], v[48:51], -4.0
    s_cselect_b32 s23, s30, s23
    ds_read_b128 v[156:159], v4 offset:40448
    v_add_f32 v16, v16, v17
    v_mfma_f32_16x16x32_bf16 v[64:67], a[4:7], v[52:55], v[64:67]
    v_add_f32 v18, v18, v19
    v_add_f32 v16, v16, v18
    v_mfma_f32_16x16x32_bf16 v[64:67], a[8:11], v[56:59], v[64:67]
    v_rcp_f32 v13, v16
    v_mfma_f32_16x16x32_bf16 v[64:67], a[12:15], v[60:63], v[64:67]
    v_mov_b32 v14, v13
    v_max_u32 v12, v12, v13
    v_mfma_f32_16x16x32_bf16 v[20:23], v[24:27], v[96:99], 0
    v_cvt_pk_bf16_f32 v96, v88, v89
    v_cvt_pk_bf16_f32 v97, v90, v91
    v_mfma_f32_16x16x32_bf16 v[20:23], v[24:27], v[104:107], v[20:23]
    v_cvt_pk_bf16_f32 v98, v92, v93
    v_cvt_pk_bf16_f32 v99, v94, v95
    v_mfma_f32_16x16x32_bf16 v[20:23], v[24:27], v[112:115], v[20:23]
    ds_write_b128 v3, v[96:99] offset:0
    v_mfma_f32_16x16x32_bf16 v[20:23], v[24:27], v[120:123], v[20:23]
    v_exp_f32 v64, v64
    v_mfma_f32_16x16x32_bf16 v[68:71], a[16:19], v[48:51], -4.0
    v_exp_f32 v65, v65
    v_mfma_f32_16x16x32_bf16 v[68:71], a[20:23], v[52:55], v[68:71]
    v_permlane32_swap_b32 v13, v14
    v_mul_f32 v253, -v240, v13
    v_mfma_f32_16x16x32_bf16 v[68:71], a[24:27], v[56:59], v[68:71]
    v_exp_f32 v66, v66
    v_mfma_f32_16x16x32_bf16 v[68:71], a[28:31], v[60:63], v[68:71]
    v_mul_f32 v254, -v240, v14
    v_fma_f32 v160, v160, v13, v253
    v_mfma_f32_16x16x32_bf16 v[184:187], a[128:131], v[100:103], v[240:243]
    v_exp_f32 v67, v67
    v_mfma_f32_16x16x32_bf16 v[184:187], a[136:139], v[108:111], v[184:187]
    v_fma_f32 v161, v161, v13, v253
    v_max_u32 v11, v11, v16
    v_mfma_f32_16x16x32_bf16 v[184:187], a[144:147], v[116:119], v[184:187]
    v_exp_f32 v68, v68
    v_mfma_f32_16x16x32_bf16 v[184:187], a[152:155], v[124:127], v[184:187]
    v_exp_f32 v69, v69
    v_mfma_f32_16x16x32_bf16 v[72:75], a[32:35], v[32:35], -4.0
    v_exp_f32 v70, v70
    v_mfma_f32_16x16x32_bf16 v[72:75], a[36:39], v[36:39], v[72:75]
    v_exp_f32 v71, v71
    v_mfma_f32_16x16x32_bf16 v[72:75], a[40:43], v[40:43], v[72:75]
    v_cvt_pk_bf16_f32 v192, v160, v161
    v_fma_f32 v162, v162, v13, v253
    v_mfma_f32_16x16x32_bf16 v[72:75], a[44:47], v[44:47], v[72:75]
    v_fma_f32 v163, v163, v13, v253
    v_cvt_pk_bf16_f32 v193, v162, v163
    v_mfma_f32_16x16x32_bf16 v[188:191], a[132:135], v[100:103], v[240:243]
    v_fma_f32 v164, v164, v13, v253
    v_fma_f32 v165, v165, v13, v253
    v_mfma_f32_16x16x32_bf16 v[188:191], a[140:143], v[108:111], v[188:191]
    v_cvt_pk_bf16_f32 v194, v164, v165
    v_fma_f32 v166, v166, v13, v253
    v_mfma_f32_16x16x32_bf16 v[188:191], a[148:151], v[116:119], v[188:191]
    v_exp_f32 v72, v72
    v_mfma_f32_16x16x32_bf16 v[188:191], a[156:159], v[124:127], v[188:191]
    v_exp_f32 v73, v73
    v_mfma_f32_16x16x32_bf16 v[76:79], a[48:51], v[32:35], -4.0
    v_cvt_pk_bf16_f32 v104, v72, v73
    v_fma_f32 v167, v167, v13, v253
    v_mfma_f32_16x16x32_bf16 v[76:79], a[52:55], v[36:39], v[76:79]
    v_exp_f32 v74, v74
    v_mfma_f32_16x16x32_bf16 v[76:79], a[56:59], v[40:43], v[76:79]
    v_exp_f32 v75, v75
    v_mfma_f32_16x16x32_bf16 v[76:79], a[60:63], v[44:47], v[76:79]
    v_cvt_pk_bf16_f32 v105, v74, v75
    v_cvt_pk_bf16_f32 v195, v166, v167
    v_mfma_f32_16x16x32_bf16 v[20:23], v[28:31], v[100:103], v[20:23]
    v_cvt_pk_bf16_f32 v100, v64, v65
    v_cvt_pk_bf16_f32 v101, v66, v67
    v_mfma_f32_16x16x32_bf16 v[20:23], v[28:31], v[108:111], v[20:23]
    v_cvt_pk_bf16_f32 v102, v68, v69
    v_cvt_pk_bf16_f32 v103, v70, v71
    v_mfma_f32_16x16x32_bf16 v[20:23], v[28:31], v[116:119], v[20:23]
    ds_write_b128 v3, v[100:103] offset:1024
    v_mfma_f32_16x16x32_bf16 v[20:23], v[28:31], v[124:127], v[20:23]
    v_exp_f32 v76, v76
    v_mfma_f32_16x16x32_bf16 v[80:83], a[32:35], v[48:51], -4.0
    v_exp_f32 v77, v77
    v_mfma_f32_16x16x32_bf16 v[80:83], a[36:39], v[52:55], v[80:83]
    v_cvt_pk_bf16_f32 v106, v76, v77
    v_fma_f32 v168, v168, v14, v254
    v_mfma_f32_16x16x32_bf16 v[80:83], a[40:43], v[56:59], v[80:83]
    v_exp_f32 v78, v78
    v_mfma_f32_16x16x32_bf16 v[80:83], a[44:47], v[60:63], v[80:83]
    s_waitcnt lgkmcnt(6)
    v_exp_f32 v79, v79
    v_mfma_f32_16x16x32_bf16 v[176:179], a[160:163], v[128:131], v[176:179]
    v_cvt_pk_bf16_f32 v107, v78, v79
    v_fma_f32 v169, v169, v14, v254
    v_mfma_f32_16x16x32_bf16 v[176:179], a[168:171], v[132:135], v[176:179]
    ds_write_b128 v3, v[104:107] offset:2048
    v_mfma_f32_16x16x32_bf16 v[176:179], a[176:179], v[136:139], v[176:179]
    v_cvt_pk_bf16_f32 v196, v168, v169
    v_fma_f32 v170, v170, v14, v254
    v_mfma_f32_16x16x32_bf16 v[176:179], a[184:187], v[140:143], v[176:179]
    v_exp_f32 v80, v80
    v_mfma_f32_16x16x32_bf16 v[84:87], a[48:51], v[48:51], -4.0
    v_exp_f32 v81, v81
    v_mfma_f32_16x16x32_bf16 v[84:87], a[52:55], v[52:55], v[84:87]
    v_cvt_pk_bf16_f32 v108, v80, v81
    v_fma_f32 v171, v171, v14, v254
    v_mfma_f32_16x16x32_bf16 v[84:87], a[56:59], v[56:59], v[84:87]
    ds_write_b32 v9, v20 offset:512
    v_mfma_f32_16x16x32_bf16 v[84:87], a[60:63], v[60:63], v[84:87]
    v_exp_f32 v82, v82
    v_mfma_f32_16x16x32_bf16 v[180:183], a[164:167], v[128:131], v[180:183]
    v_exp_f32 v83, v83
    v_mfma_f32_16x16x32_bf16 v[180:183], a[172:175], v[132:135], v[180:183]
    ds_read_b128 v[128:131], v5 offset:33280
    v_cvt_pk_bf16_f32 v109, v82, v83
    v_mfma_f32_16x16x32_bf16 v[180:183], a[180:183], v[136:139], v[180:183]
    ds_read_b128 v[132:135], v5 offset:35328
    ds_read_b128 v[136:139], v5 offset:37376
    v_mfma_f32_16x16x32_bf16 v[180:183], a[188:191], v[140:143], v[180:183]
    v_exp_f32 v84, v84
    v_mfma_f32_16x16x32_bf16 v[88:91], a[64:67], v[32:35], -4.0
    v_exp_f32 v85, v85
    v_mfma_f32_16x16x32_bf16 v[88:91], a[68:71], v[36:39], v[88:91]
    ds_read_b128 v[140:143], v5 offset:39424
    v_cvt_pk_bf16_f32 v110, v84, v85
    v_mfma_f32_16x16x32_bf16 v[88:91], a[72:75], v[40:43], v[88:91]
    v_exp_f32 v86, v86
    v_mfma_f32_16x16x32_bf16 v[88:91], a[76:79], v[44:47], v[88:91]
    s_waitcnt lgkmcnt(8)
    v_exp_f32 v87, v87
    v_mfma_f32_16x16x32_bf16 v[184:187], a[160:163], v[144:147], v[184:187]
    v_cvt_pk_bf16_f32 v111, v86, v87
    v_cvt_pk_bf16_f32 v197, v170, v171
    v_mfma_f32_16x16x32_bf16 v[184:187], a[168:171], v[148:151], v[184:187]
    ds_write_b128 v3, v[108:111] offset:3072
    v_mfma_f32_16x16x32_bf16 v[184:187], a[176:179], v[152:155], v[184:187]
    v_fma_f32 v172, v172, v14, v254
    v_add_u32 v1, s24, v2
    v_mfma_f32_16x16x32_bf16 v[184:187], a[184:187], v[156:159], v[184:187]
    v_exp_f32 v88, v88
    v_mfma_f32_16x16x32_bf16 v[92:95], a[80:83], v[32:35], -4.0
    v_exp_f32 v89, v89
    v_mfma_f32_16x16x32_bf16 v[92:95], a[84:87], v[36:39], v[92:95]
    v_cvt_pk_bf16_f32 v112, v88, v89
    v_fma_f32 v173, v173, v14, v254
    v_mfma_f32_16x16x32_bf16 v[92:95], a[88:91], v[40:43], v[92:95]
    buffer_store_dwordx4 v[192:195], v8, s[16:19], s25 offen sc0 sc1
    v_mfma_f32_16x16x32_bf16 v[92:95], a[92:95], v[44:47], v[92:95]
    v_exp_f32 v90, v90
    v_mfma_f32_16x16x32_bf16 v[188:191], a[164:167], v[144:147], v[188:191]
    v_exp_f32 v91, v91
    v_mfma_f32_16x16x32_bf16 v[188:191], a[172:175], v[148:151], v[188:191]
    ds_read_b128 v[144:147], v5 offset:34304
    v_cvt_pk_bf16_f32 v113, v90, v91
    v_mfma_f32_16x16x32_bf16 v[188:191], a[180:183], v[152:155], v[188:191]
    ds_read_b128 v[148:151], v5 offset:36352
    ds_read_b128 v[152:155], v5 offset:38400
    v_mfma_f32_16x16x32_bf16 v[188:191], a[188:191], v[156:159], v[188:191]
    v_exp_f32 v92, v92
    v_mfma_f32_16x16x32_bf16 v[64:67], a[64:67], v[48:51], -4.0
    v_exp_f32 v93, v93
    v_mfma_f32_16x16x32_bf16 v[64:67], a[68:71], v[52:55], v[64:67]
    buffer_load_dwordx4 v7, s[4:7], s22 offen offset:0 nt lds
    v_mfma_f32_16x16x32_bf16 v[64:67], a[72:75], v[56:59], v[64:67]
    v_cvt_pk_bf16_f32 v114, v92, v93
    v_cvt_pk_bf16_f32 v198, v172, v173
    v_mfma_f32_16x16x32_bf16 v[64:67], a[76:79], v[60:63], v[64:67]
    s_waitcnt lgkmcnt(4)
    v_exp_f32 v94, v94
    v_mfma_f32_16x16x32_bf16 v[176:179], a[192:195], v[128:131], v[176:179]
    v_exp_f32 v95, v95
    v_mfma_f32_16x16x32_bf16 v[176:179], a[200:203], v[132:135], v[176:179]
    ds_read_b128 v[156:159], v5 offset:40448
    v_cvt_pk_bf16_f32 v115, v94, v95
    v_mfma_f32_16x16x32_bf16 v[176:179], a[208:211], v[136:139], v[176:179]
    ds_write_b128 v3, v[112:115] offset:4096
    v_mfma_f32_16x16x32_bf16 v[176:179], a[216:219], v[140:143], v[176:179]
    v_exp_f32 v64, v64
    v_mfma_f32_16x16x32_bf16 v[68:71], a[80:83], v[48:51], -4.0
    v_exp_f32 v65, v65
    v_mfma_f32_16x16x32_bf16 v[68:71], a[84:87], v[52:55], v[68:71]
    v_cvt_pk_bf16_f32 v116, v64, v65
    v_fma_f32 v174, v174, v14, v254
    v_mfma_f32_16x16x32_bf16 v[68:71], a[88:91], v[56:59], v[68:71]
    v_exp_f32 v66, v66
    v_mfma_f32_16x16x32_bf16 v[68:71], a[92:95], v[60:63], v[68:71]
    buffer_load_dwordx4 v7, s[4:7], s22 offen offset:1024 nt lds
    v_mfma_f32_16x16x32_bf16 v[180:183], a[196:199], v[128:131], v[180:183]
    s_add_u32 s22, s22, 8192
    v_exp_f32 v67, v67
    v_mfma_f32_16x16x32_bf16 v[180:183], a[204:207], v[132:135], v[180:183]
    s_add_u32 s25, s25, 8192
    ds_read_b128 v[128:131], v6 offset:33280
    v_cvt_pk_bf16_f32 v117, v66, v67
    v_mfma_f32_16x16x32_bf16 v[180:183], a[212:215], v[136:139], v[180:183]
    v_exp_f32 v68, v68
    v_mfma_f32_16x16x32_bf16 v[180:183], a[220:223], v[140:143], v[180:183]
    v_exp_f32 v69, v69
    v_mfma_f32_16x16x32_bf16 v[72:75], a[96:99], v[32:35], -4.0
    v_cvt_pk_bf16_f32 v118, v68, v69
    v_fma_f32 v175, v175, v14, v254
    v_mfma_f32_16x16x32_bf16 v[72:75], a[100:103], v[36:39], v[72:75]
    v_exp_f32 v70, v70
    v_mfma_f32_16x16x32_bf16 v[72:75], a[104:107], v[40:43], v[72:75]
    v_exp_f32 v71, v71
    v_mfma_f32_16x16x32_bf16 v[72:75], a[108:111], v[44:47], v[72:75]
    s_waitcnt lgkmcnt(2)
    ds_read_b128 v[132:135], v6 offset:35328
    v_cvt_pk_bf16_f32 v119, v70, v71
    v_mfma_f32_16x16x32_bf16 v[184:187], a[192:195], v[144:147], v[184:187]
    ds_write_b128 v3, v[116:119] offset:5120
    v_mfma_f32_16x16x32_bf16 v[184:187], a[200:203], v[148:151], v[184:187]
    v_cvt_pk_bf16_f32 v199, v174, v175
    s_nop 0
    v_mfma_f32_16x16x32_bf16 v[184:187], a[208:211], v[152:155], v[184:187]
    v_exp_f32 v72, v72
    v_mfma_f32_16x16x32_bf16 v[184:187], a[216:219], v[156:159], v[184:187]
    ds_read_b128 v[136:139], v6 offset:37376
    ds_read_b128 v[140:143], v6 offset:39424
    v_mfma_f32_16x16x32_bf16 v[76:79], a[112:115], v[32:35], -4.0
    v_exp_f32 v73, v73
    v_mfma_f32_16x16x32_bf16 v[76:79], a[116:119], v[36:39], v[76:79]
    ds_read_b128 v[32:35], v1 offset:0
    v_cvt_pk_bf16_f32 v120, v72, v73
    v_mfma_f32_16x16x32_bf16 v[76:79], a[120:123], v[40:43], v[76:79]
    v_exp_f32 v74, v74
    v_mfma_f32_16x16x32_bf16 v[76:79], a[124:127], v[44:47], v[76:79]
    v_exp_f32 v75, v75
    v_mfma_f32_16x16x32_bf16 v[188:191], a[196:199], v[144:147], v[188:191]
    ds_read_b128 v[36:39], v1 offset:256
    v_cvt_pk_bf16_f32 v121, v74, v75
    v_mfma_f32_16x16x32_bf16 v[188:191], a[204:207], v[148:151], v[188:191]
    buffer_store_dwordx4 v[196:199], v8, s[16:19], s26 offen sc0 sc1
    v_mfma_f32_16x16x32_bf16 v[188:191], a[212:215], v[152:155], v[188:191]
    s_add_u32 s26, s26, 8192
    ds_read_b128 v[40:43], v1 offset:512
    ds_read_b128 v[44:47], v1 offset:768
    v_mfma_f32_16x16x32_bf16 v[188:191], a[220:223], v[156:159], v[188:191]
    v_exp_f32 v76, v76
    v_mfma_f32_16x16x32_bf16 v[80:83], a[96:99], v[48:51], -4.0
    v_exp_f32 v77, v77
    v_mfma_f32_16x16x32_bf16 v[80:83], a[100:103], v[52:55], v[80:83]
    ds_read_b128 v[144:147], v6 offset:34304
    v_cvt_pk_bf16_f32 v122, v76, v77
    v_mfma_f32_16x16x32_bf16 v[80:83], a[104:107], v[56:59], v[80:83]
    v_exp_f32 v78, v78
    v_mfma_f32_16x16x32_bf16 v[80:83], a[108:111], v[60:63], v[80:83]
    s_waitcnt lgkmcnt(5)
    v_exp_f32 v79, v79
    v_mfma_f32_16x16x32_bf16 v[176:179], a[224:227], v[128:131], v[176:179]
    ds_read_b128 v[148:151], v6 offset:36352
    v_cvt_pk_bf16_f32 v123, v78, v79
    v_mfma_f32_16x16x32_bf16 v[176:179], a[232:235], v[132:135], v[176:179]
    ds_write_b128 v3, v[120:123] offset:6144
    v_mfma_f32_16x16x32_bf16 v[176:179], a[240:243], v[136:139], v[176:179]
    s_nop 1
    v_mfma_f32_16x16x32_bf16 v[176:179], a[248:251], v[140:143], v[176:179]
    v_exp_f32 v80, v80
    v_mfma_f32_16x16x32_bf16 v[84:87], a[112:115], v[48:51], -4.0
    ds_read_b128 v[152:155], v6 offset:38400
    ds_read_b128 v[156:159], v6 offset:40448
    v_mfma_f32_16x16x32_bf16 v[84:87], a[116:119], v[52:55], v[84:87]
    v_exp_f32 v81, v81
    v_mfma_f32_16x16x32_bf16 v[84:87], a[120:123], v[56:59], v[84:87]
    ds_read_b128 v[48:51], v1 offset:4160
    v_cvt_pk_bf16_f32 v124, v80, v81
    v_mfma_f32_16x16x32_bf16 v[84:87], a[124:127], v[60:63], v[84:87]
    v_exp_f32 v82, v82
    v_mfma_f32_16x16x32_bf16 v[180:183], a[228:231], v[128:131], v[180:183]
    v_exp_f32 v83, v83
    v_mfma_f32_16x16x32_bf16 v[180:183], a[236:239], v[132:135], v[180:183]
    ds_read_b128 v[52:55], v1 offset:4416
    v_cvt_pk_bf16_f32 v125, v82, v83
    v_mfma_f32_16x16x32_bf16 v[180:183], a[244:247], v[136:139], v[180:183]
    ds_read_b128 v[56:59], v1 offset:4672
    ds_read_b128 v[60:63], v1 offset:4928
    v_mfma_f32_16x16x32_bf16 v[180:183], a[252:255], v[140:143], v[180:183]
    s_waitcnt lgkmcnt(9)
    v_exp_f32 v84, v84
    v_mfma_f32_16x16x32_bf16 v[88:91], a[0:3], v[32:35], -4.0
    v_exp_f32 v85, v85
    v_mfma_f32_16x16x32_bf16 v[88:91], a[4:7], v[36:39], v[88:91]
    v_cvt_pk_bf16_f32 v126, v84, v85
    v_mfma_f32_16x16x32_bf16 v[88:91], a[8:11], v[40:43], v[88:91]
    v_exp_f32 v86, v86
    v_mfma_f32_16x16x32_bf16 v[88:91], a[12:15], v[44:47], v[88:91]
    s_waitcnt lgkmcnt(4)
    v_exp_f32 v87, v87
    v_mfma_f32_16x16x32_bf16 v[184:187], a[224:227], v[144:147], v[184:187]
    v_cvt_pk_bf16_f32 v127, v86, v87
    s_nop 0
    v_mfma_f32_16x16x32_bf16 v[184:187], a[232:235], v[148:151], v[184:187]
    ds_write_b128 v3, v[124:127] offset:7168
    v_mfma_f32_16x16x32_bf16 v[184:187], a[240:243], v[152:155], v[184:187]
    s_nop 1
    v_mfma_f32_16x16x32_bf16 v[184:187], a[248:251], v[156:159], v[184:187]
    v_exp_f32 v88, v88
    v_mfma_f32_16x16x32_bf16 v[92:95], a[16:19], v[32:35], -4.0
    v_exp_f32 v89, v89
    v_mfma_f32_16x16x32_bf16 v[92:95], a[20:23], v[36:39], v[92:95]
    v_exp_f32 v90, v90
    v_mfma_f32_16x16x32_bf16 v[92:95], a[24:27], v[40:43], v[92:95]
    v_exp_f32 v91, v91
    v_mfma_f32_16x16x32_bf16 v[92:95], a[28:31], v[44:47], v[92:95]
    v_mfma_f32_16x16x32_bf16 v[188:191], a[228:231], v[144:147], v[188:191]
    v_mfma_f32_16x16x32_bf16 v[188:191], a[236:239], v[148:151], v[188:191]
    v_mfma_f32_16x16x32_bf16 v[188:191], a[244:247], v[152:155], v[188:191]
    s_waitcnt vmcnt(9) lgkmcnt(0)
    v_mfma_f32_16x16x32_bf16 v[188:191], a[252:255], v[156:159], v[188:191]
    s_barrier
L_mid0:
    v_mfma_f32_16x16x32_bf16 v[160:163], a[128:131], v[96:99], v[240:243]
    s_add_u32 s24, s24, 8320
    ds_read_b128 v[16:19], v10 offset:512
    ds_read_b128 v[128:131], v4 offset:0
    v_mfma_f32_16x16x32_bf16 v[160:163], a[136:139], v[104:107], v[160:163]
    s_cmp_eq_u32 s24, 124800
    v_exp_f32 v92, v92
    v_mfma_f32_16x16x32_bf16 v[160:163], a[144:147], v[112:115], v[160:163]
    s_cselect_b32 s24, 66560, s24
    ds_read_b128 v[132:135], v4 offset:2048
    ds_read_b128 v[136:139], v4 offset:4096
    v_mfma_f32_16x16x32_bf16 v[160:163], a[152:155], v[120:123], v[160:163]
    v_exp_f32 v93, v93
    v_mfma_f32_16x16x32_bf16 v[164:167], a[132:135], v[96:99], v[240:243]
    s_mov_b32 m0, s23
    ds_read_b128 v[140:143], v4 offset:6144
    ds_read_b128 v[144:147], v4 offset:1024
    v_mfma_f32_16x16x32_bf16 v[164:167], a[140:143], v[104:107], v[164:167]
    s_add_u32 s23, s23, 8320
    v_exp_f32 v94, v94
    v_mfma_f32_16x16x32_bf16 v[164:167], a[148:151], v[112:115], v[164:167]
    s_cmp_eq_u32 s23, s27
    ds_read_b128 v[148:151], v4 offset:3072
    ds_read_b128 v[152:155], v4 offset:5120
    v_mfma_f32_16x16x32_bf16 v[164:167], a[156:159], v[120:123], v[164:167]
    s_waitcnt lgkmcnt(7)
    v_exp_f32 v95, v95
    v_mfma_f32_16x16x32_bf16 v[64:67], a[0:3], v[48:51], -4.0
    s_cselect_b32 s23, s30, s23
    ds_read_b128 v[156:159], v4 offset:7168
    v_add_f32 v16, v16, v17
    v_mfma_f32_16x16x32_bf16 v[64:67], a[4:7], v[52:55], v[64:67]
    v_add_f32 v18, v18, v19
    v_add_f32 v16, v16, v18
    v_mfma_f32_16x16x32_bf16 v[64:67], a[8:11], v[56:59], v[64:67]
    v_rcp_f32 v13, v16
    v_mfma_f32_16x16x32_bf16 v[64:67], a[12:15], v[60:63], v[64:67]
    v_mov_b32 v14, v13
    v_max_u32 v12, v12, v13
    v_mfma_f32_16x16x32_bf16 v[20:23], v[24:27], v[96:99], 0
    v_cvt_pk_bf16_f32 v96, v88, v89
    v_cvt_pk_bf16_f32 v97, v90, v91
    v_mfma_f32_16x16x32_bf16 v[20:23], v[24:27], v[104:107], v[20:23]
    v_cvt_pk_bf16_f32 v98, v92, v93
    v_cvt_pk_bf16_f32 v99, v94, v95
    v_mfma_f32_16x16x32_bf16 v[20:23], v[24:27], v[112:115], v[20:23]
    ds_write_b128 v3, v[96:99] offset:33280
    v_mfma_f32_16x16x32_bf16 v[20:23], v[24:27], v[120:123], v[20:23]
    v_exp_f32 v64, v64
    v_mfma_f32_16x16x32_bf16 v[68:71], a[16:19], v[48:51], -4.0
    v_exp_f32 v65, v65
    v_mfma_f32_16x16x32_bf16 v[68:71], a[20:23], v[52:55], v[68:71]
    v_permlane32_swap_b32 v13, v14
    v_mul_f32 v253, -v240, v13
    v_mfma_f32_16x16x32_bf16 v[68:71], a[24:27], v[56:59], v[68:71]
    v_exp_f32 v66, v66
    v_mfma_f32_16x16x32_bf16 v[68:71], a[28:31], v[60:63], v[68:71]
    v_mul_f32 v254, -v240, v14
    v_fma_f32 v176, v176, v13, v253
    v_mfma_f32_16x16x32_bf16 v[168:171], a[128:131], v[100:103], v[240:243]
    v_exp_f32 v67, v67
    v_mfma_f32_16x16x32_bf16 v[168:171], a[136:139], v[108:111], v[168:171]
    v_fma_f32 v177, v177, v13, v253
    v_max_u32 v11, v11, v16
    v_mfma_f32_16x16x32_bf16 v[168:171], a[144:147], v[116:119], v[168:171]
    v_exp_f32 v68, v68
    v_mfma_f32_16x16x32_bf16 v[168:171], a[152:155], v[124:127], v[168:171]
    v_exp_f32 v69, v69
    v_mfma_f32_16x16x32_bf16 v[72:75], a[32:35], v[32:35], -4.0
    v_exp_f32 v70, v70
    v_mfma_f32_16x16x32_bf16 v[72:75], a[36:39], v[36:39], v[72:75]
    v_exp_f32 v71, v71
    v_mfma_f32_16x16x32_bf16 v[72:75], a[40:43], v[40:43], v[72:75]
    v_cvt_pk_bf16_f32 v192, v176, v177
    v_fma_f32 v178, v178, v13, v253
    v_mfma_f32_16x16x32_bf16 v[72:75], a[44:47], v[44:47], v[72:75]
    v_fma_f32 v179, v179, v13, v253
    v_cvt_pk_bf16_f32 v193, v178, v179
    v_mfma_f32_16x16x32_bf16 v[172:175], a[132:135], v[100:103], v[240:243]
    v_fma_f32 v180, v180, v13, v253
    v_fma_f32 v181, v181, v13, v253
    v_mfma_f32_16x16x32_bf16 v[172:175], a[140:143], v[108:111], v[172:175]
    v_cvt_pk_bf16_f32 v194, v180, v181
    v_fma_f32 v182, v182, v13, v253
    v_mfma_f32_16x16x32_bf16 v[172:175], a[148:151], v[116:119], v[172:175]
    v_exp_f32 v72, v72
    v_mfma_f32_16x16x32_bf16 v[172:175], a[156:159], v[124:127], v[172:175]
    v_exp_f32 v73, v73
    v_mfma_f32_16x16x32_bf16 v[76:79], a[48:51], v[32:35], -4.0
    v_cvt_pk_bf16_f32 v104, v72, v73
    v_fma_f32 v183, v183, v13, v253
    v_mfma_f32_16x16x32_bf16 v[76:79], a[52:55], v[36:39], v[76:79]
    v_exp_f32 v74, v74
    v_mfma_f32_16x16x32_bf16 v[76:79], a[56:59], v[40:43], v[76:79]
    v_exp_f32 v75, v75
    v_mfma_f32_16x16x32_bf16 v[76:79], a[60:63], v[44:47], v[76:79]
    v_cvt_pk_bf16_f32 v105, v74, v75
    v_cvt_pk_bf16_f32 v195, v182, v183
    v_mfma_f32_16x16x32_bf16 v[20:23], v[28:31], v[100:103], v[20:23]
    v_cvt_pk_bf16_f32 v100, v64, v65
    v_cvt_pk_bf16_f32 v101, v66, v67
    v_mfma_f32_16x16x32_bf16 v[20:23], v[28:31], v[108:111], v[20:23]
    v_cvt_pk_bf16_f32 v102, v68, v69
    v_cvt_pk_bf16_f32 v103, v70, v71
    v_mfma_f32_16x16x32_bf16 v[20:23], v[28:31], v[116:119], v[20:23]
    ds_write_b128 v3, v[100:103] offset:34304
    v_mfma_f32_16x16x32_bf16 v[20:23], v[28:31], v[124:127], v[20:23]
    v_exp_f32 v76, v76
    v_mfma_f32_16x16x32_bf16 v[80:83], a[32:35], v[48:51], -4.0
    v_exp_f32 v77, v77
    v_mfma_f32_16x16x32_bf16 v[80:83], a[36:39], v[52:55], v[80:83]
    v_cvt_pk_bf16_f32 v106, v76, v77
    v_fma_f32 v184, v184, v14, v254
    v_mfma_f32_16x16x32_bf16 v[80:83], a[40:43], v[56:59], v[80:83]
    v_exp_f32 v78, v78
    v_mfma_f32_16x16x32_bf16 v[80:83], a[44:47], v[60:63], v[80:83]
    s_waitcnt lgkmcnt(6)
    v_exp_f32 v79, v79
    v_mfma_f32_16x16x32_bf16 v[160:163], a[160:163], v[128:131], v[160:163]
    v_cvt_pk_bf16_f32 v107, v78, v79
    v_fma_f32 v185, v185, v14, v254
    v_mfma_f32_16x16x32_bf16 v[160:163], a[168:171], v[132:135], v[160:163]
    ds_write_b128 v3, v[104:107] offset:35328
    v_mfma_f32_16x16x32_bf16 v[160:163], a[176:179], v[136:139], v[160:163]
    v_cvt_pk_bf16_f32 v196, v184, v185
    v_fma_f32 v186, v186, v14, v254
    v_mfma_f32_16x16x32_bf16 v[160:163], a[184:187], v[140:143], v[160:163]
    v_exp_f32 v80, v80
    v_mfma_f32_16x16x32_bf16 v[84:87], a[48:51], v[48:51], -4.0
    v_exp_f32 v81, v81
    v_mfma_f32_16x16x32_bf16 v[84:87], a[52:55], v[52:55], v[84:87]
    v_cvt_pk_bf16_f32 v108, v80, v81
    v_fma_f32 v187, v187, v14, v254
    v_mfma_f32_16x16x32_bf16 v[84:87], a[56:59], v[56:59], v[84:87]
    ds_write_b32 v9, v20 offset:0
    v_mfma_f32_16x16x32_bf16 v[84:87], a[60:63], v[60:63], v[84:87]
    v_exp_f32 v82, v82
    v_mfma_f32_16x16x32_bf16 v[164:167], a[164:167], v[128:131], v[164:167]
    v_exp_f32 v83, v83
    v_mfma_f32_16x16x32_bf16 v[164:167], a[172:175], v[132:135], v[164:167]
    ds_read_b128 v[128:131], v5 offset:0
    v_cvt_pk_bf16_f32 v109, v82, v83
    v_mfma_f32_16x16x32_bf16 v[164:167], a[180:183], v[136:139], v[164:167]
    ds_read_b128 v[132:135], v5 offset:2048
    ds_read_b128 v[136:139], v5 offset:4096
    v_mfma_f32_16x16x32_bf16 v[164:167], a[188:191], v[140:143], v[164:167]
    v_exp_f32 v84, v84
    v_mfma_f32_16x16x32_bf16 v[88:91], a[64:67], v[32:35], -4.0
    v_exp_f32 v85, v85
    v_mfma_f32_16x16x32_bf16 v[88:91], a[68:71], v[36:39], v[88:91]
    ds_read_b128 v[140:143], v5 offset:6144
    v_cvt_pk_bf16_f32 v110, v84, v85
    v_mfma_f32_16x16x32_bf16 v[88:91], a[72:75], v[40:43], v[88:91]
    v_exp_f32 v86, v86
    v_mfma_f32_16x16x32_bf16 v[88:91], a[76:79], v[44:47], v[88:91]
    s_waitcnt lgkmcnt(8)
    v_exp_f32 v87, v87
    v_mfma_f32_16x16x32_bf16 v[168:171], a[160:163], v[144:147], v[168:171]
    v_cvt_pk_bf16_f32 v111, v86, v87
    v_cvt_pk_bf16_f32 v197, v186, v187
    v_mfma_f32_16x16x32_bf16 v[168:171], a[168:171], v[148:151], v[168:171]
    ds_write_b128 v3, v[108:111] offset:36352
    v_mfma_f32_16x16x32_bf16 v[168:171], a[176:179], v[152:155], v[168:171]
    v_fma_f32 v188, v188, v14, v254
    v_add_u32 v1, s24, v2
    v_mfma_f32_16x16x32_bf16 v[168:171], a[184:187], v[156:159], v[168:171]
    v_exp_f32 v88, v88
    v_mfma_f32_16x16x32_bf16 v[92:95], a[80:83], v[32:35], -4.0
    v_exp_f32 v89, v89
    v_mfma_f32_16x16x32_bf16 v[92:95], a[84:87], v[36:39], v[92:95]
    v_cvt_pk_bf16_f32 v112, v88, v89
    v_fma_f32 v189, v189, v14, v254
    v_mfma_f32_16x16x32_bf16 v[92:95], a[88:91], v[40:43], v[92:95]
    buffer_store_dwordx4 v[192:195], v8, s[16:19], s25 offen sc0 sc1
    v_mfma_f32_16x16x32_bf16 v[92:95], a[92:95], v[44:47], v[92:95]
    v_exp_f32 v90, v90
    v_mfma_f32_16x16x32_bf16 v[172:175], a[164:167], v[144:147], v[172:175]
    v_exp_f32 v91, v91
    v_mfma_f32_16x16x32_bf16 v[172:175], a[172:175], v[148:151], v[172:175]
    ds_read_b128 v[144:147], v5 offset:1024
    v_cvt_pk_bf16_f32 v113, v90, v91
    v_mfma_f32_16x16x32_bf16 v[172:175], a[180:183], v[152:155], v[172:175]
    ds_read_b128 v[148:151], v5 offset:3072
    ds_read_b128 v[152:155], v5 offset:5120
    v_mfma_f32_16x16x32_bf16 v[172:175], a[188:191], v[156:159], v[172:175]
    v_exp_f32 v92, v92
    v_mfma_f32_16x16x32_bf16 v[64:67], a[64:67], v[48:51], -4.0
    v_exp_f32 v93, v93
    v_mfma_f32_16x16x32_bf16 v[64:67], a[68:71], v[52:55], v[64:67]
    buffer_load_dwordx4 v7, s[4:7], s22 offen offset:0 nt lds
    v_mfma_f32_16x16x32_bf16 v[64:67], a[72:75], v[56:59], v[64:67]
    v_cvt_pk_bf16_f32 v114, v92, v93
    v_cvt_pk_bf16_f32 v198, v188, v189
    v_mfma_f32_16x16x32_bf16 v[64:67], a[76:79], v[60:63], v[64:67]
    s_waitcnt lgkmcnt(4)
    v_exp_f32 v94, v94
    v_mfma_f32_16x16x32_bf16 v[160:163], a[192:195], v[128:131], v[160:163]
    v_exp_f32 v95, v95
    v_mfma_f32_16x16x32_bf16 v[160:163], a[200:203], v[132:135], v[160:163]
    ds_read_b128 v[156:159], v5 offset:7168
    v_cvt_pk_bf16_f32 v115, v94, v95
    v_mfma_f32_16x16x32_bf16 v[160:163], a[208:211], v[136:139], v[160:163]
    ds_write_b128 v3, v[112:115] offset:37376
    v_mfma_f32_16x16x32_bf16 v[160:163], a[216:219], v[140:143], v[160:163]
    v_exp_f32 v64, v64
    v_mfma_f32_16x16x32_bf16 v[68:71], a[80:83], v[48:51], -4.0
    v_exp_f32 v65, v65
    v_mfma_f32_16x16x32_bf16 v[68:71], a[84:87], v[52:55], v[68:71]
    v_cvt_pk_bf16_f32 v116, v64, v65
    v_fma_f32 v190, v190, v14, v254
    v_mfma_f32_16x16x32_bf16 v[68:71], a[88:91], v[56:59], v[68:71]
    v_exp_f32 v66, v66
    v_mfma_f32_16x16x32_bf16 v[68:71], a[92:95], v[60:63], v[68:71]
    buffer_load_dwordx4 v7, s[4:7], s22 offen offset:1024 nt lds
    v_mfma_f32_16x16x32_bf16 v[164:167], a[196:199], v[128:131], v[164:167]
    s_add_u32 s22, s22, 8192
    v_exp_f32 v67, v67
    v_mfma_f32_16x16x32_bf16 v[164:167], a[204:207], v[132:135], v[164:167]
    s_add_u32 s25, s25, 8192
    ds_read_b128 v[128:131], v6 offset:0
    v_cvt_pk_bf16_f32 v117, v66, v67
    v_mfma_f32_16x16x32_bf16 v[164:167], a[212:215], v[136:139], v[164:167]
    v_exp_f32 v68, v68
    v_mfma_f32_16x16x32_bf16 v[164:167], a[220:223], v[140:143], v[164:167]
    v_exp_f32 v69, v69
    v_mfma_f32_16x16x32_bf16 v[72:75], a[96:99], v[32:35], -4.0
    v_cvt_pk_bf16_f32 v118, v68, v69
    v_fma_f32 v191, v191, v14, v254
    v_mfma_f32_16x16x32_bf16 v[72:75], a[100:103], v[36:39], v[72:75]
    v_exp_f32 v70, v70
    v_mfma_f32_16x16x32_bf16 v[72:75], a[104:107], v[40:43], v[72:75]
    v_exp_f32 v71, v71
    v_mfma_f32_16x16x32_bf16 v[72:75], a[108:111], v[44:47], v[72:75]
    s_waitcnt lgkmcnt(2)
    ds_read_b128 v[132:135], v6 offset:2048
    v_cvt_pk_bf16_f32 v119, v70, v71
    v_mfma_f32_16x16x32_bf16 v[168:171], a[192:195], v[144:147], v[168:171]
    ds_write_b128 v3, v[116:119] offset:38400
    v_mfma_f32_16x16x32_bf16 v[168:171], a[200:203], v[148:151], v[168:171]
    v_cvt_pk_bf16_f32 v199, v190, v191
    s_nop 0
    v_mfma_f32_16x16x32_bf16 v[168:171], a[208:211], v[152:155], v[168:171]
    v_exp_f32 v72, v72
    v_mfma_f32_16x16x32_bf16 v[168:171], a[216:219], v[156:159], v[168:171]
    ds_read_b128 v[136:139], v6 offset:4096
    ds_read_b128 v[140:143], v6 offset:6144
    v_mfma_f32_16x16x32_bf16 v[76:79], a[112:115], v[32:35], -4.0
    v_exp_f32 v73, v73
    v_mfma_f32_16x16x32_bf16 v[76:79], a[116:119], v[36:39], v[76:79]
    ds_read_b128 v[32:35], v1 offset:0
    v_cvt_pk_bf16_f32 v120, v72, v73
    v_mfma_f32_16x16x32_bf16 v[76:79], a[120:123], v[40:43], v[76:79]
    v_exp_f32 v74, v74
    v_mfma_f32_16x16x32_bf16 v[76:79], a[124:127], v[44:47], v[76:79]
    v_exp_f32 v75, v75
    v_mfma_f32_16x16x32_bf16 v[172:175], a[196:199], v[144:147], v[172:175]
    ds_read_b128 v[36:39], v1 offset:256
    v_cvt_pk_bf16_f32 v121, v74, v75
    v_mfma_f32_16x16x32_bf16 v[172:175], a[204:207], v[148:151], v[172:175]
    buffer_store_dwordx4 v[196:199], v8, s[16:19], s26 offen sc0 sc1
    v_mfma_f32_16x16x32_bf16 v[172:175], a[212:215], v[152:155], v[172:175]
    s_add_u32 s26, s26, 8192
    ds_read_b128 v[40:43], v1 offset:512
    ds_read_b128 v[44:47], v1 offset:768
    v_mfma_f32_16x16x32_bf16 v[172:175], a[220:223], v[156:159], v[172:175]
    v_exp_f32 v76, v76
    v_mfma_f32_16x16x32_bf16 v[80:83], a[96:99], v[48:51], -4.0
    v_exp_f32 v77, v77
    v_mfma_f32_16x16x32_bf16 v[80:83], a[100:103], v[52:55], v[80:83]
    ds_read_b128 v[144:147], v6 offset:1024
    v_cvt_pk_bf16_f32 v122, v76, v77
    v_mfma_f32_16x16x32_bf16 v[80:83], a[104:107], v[56:59], v[80:83]
    v_exp_f32 v78, v78
    v_mfma_f32_16x16x32_bf16 v[80:83], a[108:111], v[60:63], v[80:83]
    s_waitcnt lgkmcnt(5)
    v_exp_f32 v79, v79
    v_mfma_f32_16x16x32_bf16 v[160:163], a[224:227], v[128:131], v[160:163]
    ds_read_b128 v[148:151], v6 offset:3072
    v_cvt_pk_bf16_f32 v123, v78, v79
    v_mfma_f32_16x16x32_bf16 v[160:163], a[232:235], v[132:135], v[160:163]
    ds_write_b128 v3, v[120:123] offset:39424
    v_mfma_f32_16x16x32_bf16 v[160:163], a[240:243], v[136:139], v[160:163]
    s_nop 1
    v_mfma_f32_16x16x32_bf16 v[160:163], a[248:251], v[140:143], v[160:163]
    v_exp_f32 v80, v80
    v_mfma_f32_16x16x32_bf16 v[84:87], a[112:115], v[48:51], -4.0
    ds_read_b128 v[152:155], v6 offset:5120
    ds_read_b128 v[156:159], v6 offset:7168
    v_mfma_f32_16x16x32_bf16 v[84:87], a[116:119], v[52:55], v[84:87]
    v_exp_f32 v81, v81
    v_mfma_f32_16x16x32_bf16 v[84:87], a[120:123], v[56:59], v[84:87]
    ds_read_b128 v[48:51], v1 offset:4160
    v_cvt_pk_bf16_f32 v124, v80, v81
    v_mfma_f32_16x16x32_bf16 v[84:87], a[124:127], v[60:63], v[84:87]
    v_exp_f32 v82, v82
    v_mfma_f32_16x16x32_bf16 v[164:167], a[228:231], v[128:131], v[164:167]
    v_exp_f32 v83, v83
    v_mfma_f32_16x16x32_bf16 v[164:167], a[236:239], v[132:135], v[164:167]
    ds_read_b128 v[52:55], v1 offset:4416
    v_cvt_pk_bf16_f32 v125, v82, v83
    v_mfma_f32_16x16x32_bf16 v[164:167], a[244:247], v[136:139], v[164:167]
    ds_read_b128 v[56:59], v1 offset:4672
    ds_read_b128 v[60:63], v1 offset:4928
    v_mfma_f32_16x16x32_bf16 v[164:167], a[252:255], v[140:143], v[164:167]
    s_waitcnt lgkmcnt(9)
    v_exp_f32 v84, v84
    v_mfma_f32_16x16x32_bf16 v[88:91], a[0:3], v[32:35], -4.0
    v_exp_f32 v85, v85
    v_mfma_f32_16x16x32_bf16 v[88:91], a[4:7], v[36:39], v[88:91]
    v_cvt_pk_bf16_f32 v126, v84, v85
    v_mfma_f32_16x16x32_bf16 v[88:91], a[8:11], v[40:43], v[88:91]
    v_exp_f32 v86, v86
    v_mfma_f32_16x16x32_bf16 v[88:91], a[12:15], v[44:47], v[88:91]
    s_waitcnt lgkmcnt(4)
    v_exp_f32 v87, v87
    v_mfma_f32_16x16x32_bf16 v[168:171], a[224:227], v[144:147], v[168:171]
    v_cvt_pk_bf16_f32 v127, v86, v87
    s_nop 0
    v_mfma_f32_16x16x32_bf16 v[168:171], a[232:235], v[148:151], v[168:171]
    ds_write_b128 v3, v[124:127] offset:40448
    v_mfma_f32_16x16x32_bf16 v[168:171], a[240:243], v[152:155], v[168:171]
    s_nop 1
    v_mfma_f32_16x16x32_bf16 v[168:171], a[248:251], v[156:159], v[168:171]
    v_exp_f32 v88, v88
    v_mfma_f32_16x16x32_bf16 v[92:95], a[16:19], v[32:35], -4.0
    s_sub_u32 s21, s21, 1
    v_exp_f32 v89, v89
    v_mfma_f32_16x16x32_bf16 v[92:95], a[20:23], v[36:39], v[92:95]
    s_cmp_lg_u32 s21, 0
    v_exp_f32 v90, v90
    v_mfma_f32_16x16x32_bf16 v[92:95], a[24:27], v[40:43], v[92:95]
    v_exp_f32 v91, v91
    v_mfma_f32_16x16x32_bf16 v[92:95], a[28:31], v[44:47], v[92:95]
    v_mfma_f32_16x16x32_bf16 v[172:175], a[228:231], v[144:147], v[172:175]
    v_mfma_f32_16x16x32_bf16 v[172:175], a[236:239], v[148:151], v[172:175]
    v_mfma_f32_16x16x32_bf16 v[172:175], a[244:247], v[152:155], v[172:175]
    s_waitcnt vmcnt(9) lgkmcnt(0)
    v_mfma_f32_16x16x32_bf16 v[172:175], a[252:255], v[156:159], v[172:175]
    s_barrier
    s_cbranch_scc1 L_loop0
    s_branch L_after
    .p2align 6
L_loop1:
    v_mfma_f32_16x16x32_bf16 v[176:179], a[128:131], v[96:99], v[240:243]
    s_add_u32 s24, s24, 8320
    ds_read_b128 v[16:19], v10 offset:0
    ds_read_b128 v[128:131], v4 offset:33280
    v_mfma_f32_16x16x32_bf16 v[176:179], a[136:139], v[104:107], v[176:179]
    s_cmp_eq_u32 s24, 124800
    v_exp_f32 v92, v92
    v_mfma_f32_16x16x32_bf16 v[176:179], a[144:147], v[112:115], v[176:179]
    s_cselect_b32 s24, 66560, s24
    ds_read_b128 v[132:135], v4 offset:35328
    ds_read_b128 v[136:139], v4 offset:37376
    v_mfma_f32_16x16x32_bf16 v[176:179], a[152:155], v[120:123], v[176:179]
    v_exp_f32 v93, v93
    v_mfma_f32_16x16x32_bf16 v[180:183], a[132:135], v[96:99], v[240:243]
    s_mov_b32 m0, s23
    ds_read_b128 v[140:143], v4 offset:39424
    ds_read_b128 v[144:147], v4 offset:34304
    v_mfma_f32_16x16x32_bf16 v[180:183], a[140:143], v[104:107], v[180:183]
    s_add_u32 s23, s23, 8320
    v_exp_f32 v94, v94
    v_mfma_f32_16x16x32_bf16 v[180:183], a[148:151], v[112:115], v[180:183]
    s_cmp_eq_u32 s23, s27
    ds_read_b128 v[148:151], v4 offset:36352
    ds_read_b128 v[152:155], v4 offset:38400
    v_mfma_f32_16x16x32_bf16 v[180:183], a[156:159], v[120:123], v[180:183]
    s_waitcnt lgkmcnt(7)
    v_exp_f32 v95, v95
    v_mfma_f32_16x16x32_bf16 v[64:67], a[0:3], v[48:51], -4.0
    s_cselect_b32 s23, s30, s23
    ds_read_b128 v[156:159], v4 offset:40448
    v_add_f32 v16, v16, v17
    v_mfma_f32_16x16x32_bf16 v[64:67], a[4:7], v[52:55], v[64:67]
    v_add_f32 v18, v18, v19
    v_add_f32 v16, v16, v18
    v_mfma_f32_16x16x32_bf16 v[64:67], a[8:11], v[56:59], v[64:67]
    v_rcp_f32 v13, v16
    v_mfma_f32_16x16x32_bf16 v[64:67], a[12:15], v[60:63], v[64:67]
    v_mov_b32 v14, v13
    v_max_u32 v12, v12, v13
    v_mfma_f32_16x16x32_bf16 v[20:23], v[24:27], v[96:99], 0
    v_cvt_pk_bf16_f32 v96, v88, v89
    v_cvt_pk_bf16_f32 v97, v90, v91
    v_mfma_f32_16x16x32_bf16 v[20:23], v[24:27], v[104:107], v[20:23]
    v_cvt_pk_bf16_f32 v98, v92, v93
    v_cvt_pk_bf16_f32 v99, v94, v95
    v_mfma_f32_16x16x32_bf16 v[20:23], v[24:27], v[112:115], v[20:23]
    ds_write_b128 v3, v[96:99] offset:0
    v_mfma_f32_16x16x32_bf16 v[20:23], v[24:27], v[120:123], v[20:23]
    v_exp_f32 v64, v64
    v_mfma_f32_16x16x32_bf16 v[68:71], a[16:19], v[48:51], -4.0
    v_exp_f32 v65, v65
    v_mfma_f32_16x16x32_bf16 v[68:71], a[20:23], v[52:55], v[68:71]
    v_permlane32_swap_b32 v13, v14
    v_mul_f32 v253, -v240, v13
    v_mfma_f32_16x16x32_bf16 v[68:71], a[24:27], v[56:59], v[68:71]
    v_exp_f32 v66, v66
    v_mfma_f32_16x16x32_bf16 v[68:71], a[28:31], v[60:63], v[68:71]
    v_mul_f32 v254, -v240, v14
    v_fma_f32 v160, v160, v13, v253
    v_mfma_f32_16x16x32_bf16 v[184:187], a[128:131], v[100:103], v[240:243]
    v_exp_f32 v67, v67
    v_mfma_f32_16x16x32_bf16 v[184:187], a[136:139], v[108:111], v[184:187]
    v_fma_f32 v161, v161, v13, v253
    v_max_u32 v11, v11, v16
    v_mfma_f32_16x16x32_bf16 v[184:187], a[144:147], v[116:119], v[184:187]
    v_exp_f32 v68, v68
    v_mfma_f32_16x16x32_bf16 v[184:187], a[152:155], v[124:127], v[184:187]
    v_exp_f32 v69, v69
    v_mfma_f32_16x16x32_bf16 v[72:75], a[32:35], v[32:35], -4.0
    v_exp_f32 v70, v70
    v_mfma_f32_16x16x32_bf16 v[72:75], a[36:39], v[36:39], v[72:75]
    v_exp_f32 v71, v71
    v_mfma_f32_16x16x32_bf16 v[72:75], a[40:43], v[40:43], v[72:75]
    v_cvt_pk_bf16_f32 v192, v160, v161
    v_fma_f32 v162, v162, v13, v253
    v_mfma_f32_16x16x32_bf16 v[72:75], a[44:47], v[44:47], v[72:75]
    v_fma_f32 v163, v163, v13, v253
    v_cvt_pk_bf16_f32 v193, v162, v163
    v_mfma_f32_16x16x32_bf16 v[188:191], a[132:135], v[100:103], v[240:243]
    v_fma_f32 v164, v164, v13, v253
    v_fma_f32 v165, v165, v13, v253
    v_mfma_f32_16x16x32_bf16 v[188:191], a[140:143], v[108:111], v[188:191]
    v_cvt_pk_bf16_f32 v194, v164, v165
    v_fma_f32 v166, v166, v13, v253
    v_mfma_f32_16x16x32_bf16 v[188:191], a[148:151], v[116:119], v[188:191]
    v_exp_f32 v72, v72
    v_mfma_f32_16x16x32_bf16 v[188:191], a[156:159], v[124:127], v[188:191]
    v_exp_f32 v73, v73
    v_mfma_f32_16x16x32_bf16 v[76:79], a[48:51], v[32:35], -4.0
    v_cvt_pk_bf16_f32 v104, v72, v73
    v_fma_f32 v167, v167, v13, v253
    v_mfma_f32_16x16x32_bf16 v[76:79], a[52:55], v[36:39], v[76:79]
    v_exp_f32 v74, v74
    v_mfma_f32_16x16x32_bf16 v[76:79], a[56:59], v[40:43], v[76:79]
    v_exp_f32 v75, v75
    v_mfma_f32_16x16x32_bf16 v[76:79], a[60:63], v[44:47], v[76:79]
    v_cvt_pk_bf16_f32 v105, v74, v75
    v_cvt_pk_bf16_f32 v195, v166, v167
    v_mfma_f32_16x16x32_bf16 v[20:23], v[28:31], v[100:103], v[20:23]
    v_cvt_pk_bf16_f32 v100, v64, v65
    v_cvt_pk_bf16_f32 v101, v66, v67
    v_mfma_f32_16x16x32_bf16 v[20:23], v[28:31], v[108:111], v[20:23]
    v_cvt_pk_bf16_f32 v102, v68, v69
    v_cvt_pk_bf16_f32 v103, v70, v71
    v_mfma_f32_16x16x32_bf16 v[20:23], v[28:31], v[116:119], v[20:23]
    ds_write_b128 v3, v[100:103] offset:1024
    v_mfma_f32_16x16x32_bf16 v[20:23], v[28:31], v[124:127], v[20:23]
    v_exp_f32 v76, v76
    v_mfma_f32_16x16x32_bf16 v[80:83], a[32:35], v[48:51], -4.0
    v_exp_f32 v77, v77
    v_mfma_f32_16x16x32_bf16 v[80:83], a[36:39], v[52:55], v[80:83]
    v_cvt_pk_bf16_f32 v106, v76, v77
    v_fma_f32 v168, v168, v14, v254
    v_mfma_f32_16x16x32_bf16 v[80:83], a[40:43], v[56:59], v[80:83]
    v_exp_f32 v78, v78
    v_mfma_f32_16x16x32_bf16 v[80:83], a[44:47], v[60:63], v[80:83]
    s_waitcnt lgkmcnt(6)
    v_exp_f32 v79, v79
    v_mfma_f32_16x16x32_bf16 v[176:179], a[160:163], v[128:131], v[176:179]
    v_cvt_pk_bf16_f32 v107, v78, v79
    v_fma_f32 v169, v169, v14, v254
    v_mfma_f32_16x16x32_bf16 v[176:179], a[168:171], v[132:135], v[176:179]
    ds_write_b128 v3, v[104:107] offset:2048
    v_mfma_f32_16x16x32_bf16 v[176:179], a[176:179], v[136:139], v[176:179]
    v_cvt_pk_bf16_f32 v196, v168, v169
    v_fma_f32 v170, v170, v14, v254
    v_mfma_f32_16x16x32_bf16 v[176:179], a[184:187], v[140:143], v[176:179]
    v_exp_f32 v80, v80
    v_mfma_f32_16x16x32_bf16 v[84:87], a[48:51], v[48:51], -4.0
    v_exp_f32 v81, v81
    v_mfma_f32_16x16x32_bf16 v[84:87], a[52:55], v[52:55], v[84:87]
    v_cvt_pk_bf16_f32 v108, v80, v81
    v_fma_f32 v171, v171, v14, v254
    v_mfma_f32_16x16x32_bf16 v[84:87], a[56:59], v[56:59], v[84:87]
    ds_write_b32 v9, v20 offset:512
    v_mfma_f32_16x16x32_bf16 v[84:87], a[60:63], v[60:63], v[84:87]
    v_exp_f32 v82, v82
    v_mfma_f32_16x16x32_bf16 v[180:183], a[164:167], v[128:131], v[180:183]
    v_exp_f32 v83, v83
    v_mfma_f32_16x16x32_bf16 v[180:183], a[172:175], v[132:135], v[180:183]
    ds_read_b128 v[128:131], v5 offset:33280
    v_cvt_pk_bf16_f32 v109, v82, v83
    v_mfma_f32_16x16x32_bf16 v[180:183], a[180:183], v[136:139], v[180:183]
    ds_read_b128 v[132:135], v5 offset:35328
    ds_read_b128 v[136:139], v5 offset:37376
    v_mfma_f32_16x16x32_bf16 v[180:183], a[188:191], v[140:143], v[180:183]
    v_exp_f32 v84, v84
    v_mfma_f32_16x16x32_bf16 v[88:91], a[64:67], v[32:35], -4.0
    v_exp_f32 v85, v85
    v_mfma_f32_16x16x32_bf16 v[88:91], a[68:71], v[36:39], v[88:91]
    ds_read_b128 v[140:143], v5 offset:39424
    v_cvt_pk_bf16_f32 v110, v84, v85
    v_mfma_f32_16x16x32_bf16 v[88:91], a[72:75], v[40:43], v[88:91]
    v_exp_f32 v86, v86
    v_mfma_f32_16x16x32_bf16 v[88:91], a[76:79], v[44:47], v[88:91]
    s_waitcnt lgkmcnt(8)
    v_exp_f32 v87, v87
    v_mfma_f32_16x16x32_bf16 v[184:187], a[160:163], v[144:147], v[184:187]
    v_cvt_pk_bf16_f32 v111, v86, v87
    v_cvt_pk_bf16_f32 v197, v170, v171
    v_mfma_f32_16x16x32_bf16 v[184:187], a[168:171], v[148:151], v[184:187]
    ds_write_b128 v3, v[108:111] offset:3072
    v_mfma_f32_16x16x32_bf16 v[184:187], a[176:179], v[152:155], v[184:187]
    v_fma_f32 v172, v172, v14, v254
    v_add_u32 v1, s24, v2
    v_mfma_f32_16x16x32_bf16 v[184:187], a[184:187], v[156:159], v[184:187]
    v_exp_f32 v88, v88
    v_mfma_f32_16x16x32_bf16 v[92:95], a[80:83], v[32:35], -4.0
    v_exp_f32 v89, v89
    v_mfma_f32_16x16x32_bf16 v[92:95], a[84:87], v[36:39], v[92:95]
    v_cvt_pk_bf16_f32 v112, v88, v89
    v_fma_f32 v173, v173, v14, v254
    v_mfma_f32_16x16x32_bf16 v[92:95], a[88:91], v[40:43], v[92:95]
    buffer_store_dwordx4 v[192:195], v8, s[16:19], s25 offen sc0 sc1
    v_mfma_f32_16x16x32_bf16 v[92:95], a[92:95], v[44:47], v[92:95]
    v_exp_f32 v90, v90
    v_mfma_f32_16x16x32_bf16 v[188:191], a[164:167], v[144:147], v[188:191]
    v_exp_f32 v91, v91
    v_mfma_f32_16x16x32_bf16 v[188:191], a[172:175], v[148:151], v[188:191]
    ds_read_b128 v[144:147], v5 offset:34304
    v_cvt_pk_bf16_f32 v113, v90, v91
    v_mfma_f32_16x16x32_bf16 v[188:191], a[180:183], v[152:155], v[188:191]
    ds_read_b128 v[148:151], v5 offset:36352
    ds_read_b128 v[152:155], v5 offset:38400
    v_mfma_f32_16x16x32_bf16 v[188:191], a[188:191], v[156:159], v[188:191]
    v_exp_f32 v92, v92
    v_mfma_f32_16x16x32_bf16 v[64:67], a[64:67], v[48:51], -4.0
    v_exp_f32 v93, v93
    v_mfma_f32_16x16x32_bf16 v[64:67], a[68:71], v[52:55], v[64:67]
    buffer_load_dwordx4 v7, s[4:7], s22 offen offset:0 nt lds
    v_mfma_f32_16x16x32_bf16 v[64:67], a[72:75], v[56:59], v[64:67]
    v_cvt_pk_bf16_f32 v114, v92, v93
    v_cvt_pk_bf16_f32 v198, v172, v173
    v_mfma_f32_16x16x32_bf16 v[64:67], a[76:79], v[60:63], v[64:67]
    s_waitcnt lgkmcnt(4)
    v_exp_f32 v94, v94
    v_mfma_f32_16x16x32_bf16 v[176:179], a[192:195], v[128:131], v[176:179]
    v_exp_f32 v95, v95
    v_mfma_f32_16x16x32_bf16 v[176:179], a[200:203], v[132:135], v[176:179]
    ds_read_b128 v[156:159], v5 offset:40448
    v_cvt_pk_bf16_f32 v115, v94, v95
    v_mfma_f32_16x16x32_bf16 v[176:179], a[208:211], v[136:139], v[176:179]
    ds_write_b128 v3, v[112:115] offset:4096
    v_mfma_f32_16x16x32_bf16 v[176:179], a[216:219], v[140:143], v[176:179]
    v_exp_f32 v64, v64
    v_mfma_f32_16x16x32_bf16 v[68:71], a[80:83], v[48:51], -4.0
    v_exp_f32 v65, v65
    v_mfma_f32_16x16x32_bf16 v[68:71], a[84:87], v[52:55], v[68:71]
    v_cvt_pk_bf16_f32 v116, v64, v65
    v_fma_f32 v174, v174, v14, v254
    v_mfma_f32_16x16x32_bf16 v[68:71], a[88:91], v[56:59], v[68:71]
    v_exp_f32 v66, v66
    v_mfma_f32_16x16x32_bf16 v[68:71], a[92:95], v[60:63], v[68:71]
    buffer_load_dwordx4 v7, s[4:7], s22 offen offset:1024 nt lds
    v_mfma_f32_16x16x32_bf16 v[180:183], a[196:199], v[128:131], v[180:183]
    s_add_u32 s22, s22, 8192
    v_exp_f32 v67, v67
    v_mfma_f32_16x16x32_bf16 v[180:183], a[204:207], v[132:135], v[180:183]
    s_add_u32 s25, s25, 8192
    ds_read_b128 v[128:131], v6 offset:33280
    v_cvt_pk_bf16_f32 v117, v66, v67
    v_mfma_f32_16x16x32_bf16 v[180:183], a[212:215], v[136:139], v[180:183]
    v_exp_f32 v68, v68
    v_mfma_f32_16x16x32_bf16 v[180:183], a[220:223], v[140:143], v[180:183]
    v_exp_f32 v69, v69
    v_mfma_f32_16x16x32_bf16 v[72:75], a[96:99], v[32:35], -4.0
    v_cvt_pk_bf16_f32 v118, v68, v69
    v_fma_f32 v175, v175, v14, v254
    v_mfma_f32_16x16x32_bf16 v[72:75], a[100:103], v[36:39], v[72:75]
    v_exp_f32 v70, v70
    v_mfma_f32_16x16x32_bf16 v[72:75], a[104:107], v[40:43], v[72:75]
    v_exp_f32 v71, v71
    v_mfma_f32_16x16x32_bf16 v[72:75], a[108:111], v[44:47], v[72:75]
    s_waitcnt lgkmcnt(2)
    ds_read_b128 v[132:135], v6 offset:35328
    v_cvt_pk_bf16_f32 v119, v70, v71
    v_mfma_f32_16x16x32_bf16 v[184:187], a[192:195], v[144:147], v[184:187]
    ds_write_b128 v3, v[116:119] offset:5120
    v_mfma_f32_16x16x32_bf16 v[184:187], a[200:203], v[148:151], v[184:187]
    v_cvt_pk_bf16_f32 v199, v174, v175
    s_nop 0
    v_mfma_f32_16x16x32_bf16 v[184:187], a[208:211], v[152:155], v[184:187]
    v_exp_f32 v72, v72
    v_mfma_f32_16x16x32_bf16 v[184:187], a[216:219], v[156:159], v[184:187]
    ds_read_b128 v[136:139], v6 offset:37376
    ds_read_b128 v[140:143], v6 offset:39424
    v_mfma_f32_16x16x32_bf16 v[76:79], a[112:115], v[32:35], -4.0
    v_exp_f32 v73, v73
    v_mfma_f32_16x16x32_bf16 v[76:79], a[116:119], v[36:39], v[76:79]
    ds_read_b128 v[32:35], v1 offset:0
    v_cvt_pk_bf16_f32 v120, v72, v73
    v_mfma_f32_16x16x32_bf16 v[76:79], a[120:123], v[40:43], v[76:79]
    v_exp_f32 v74, v74
    v_mfma_f32_16x16x32_bf16 v[76:79], a[124:127], v[44:47], v[76:79]
    v_exp_f32 v75, v75
    v_mfma_f32_16x16x32_bf16 v[188:191], a[196:199], v[144:147], v[188:191]
    ds_read_b128 v[36:39], v1 offset:256
    v_cvt_pk_bf16_f32 v121, v74, v75
    v_mfma_f32_16x16x32_bf16 v[188:191], a[204:207], v[148:151], v[188:191]
    buffer_store_dwordx4 v[196:199], v8, s[16:19], s26 offen sc0 sc1
    v_mfma_f32_16x16x32_bf16 v[188:191], a[212:215], v[152:155], v[188:191]
    s_add_u32 s26, s26, 8192
    ds_read_b128 v[40:43], v1 offset:512
    ds_read_b128 v[44:47], v1 offset:768
    v_mfma_f32_16x16x32_bf16 v[188:191], a[220:223], v[156:159], v[188:191]
    v_exp_f32 v76, v76
    v_mfma_f32_16x16x32_bf16 v[80:83], a[96:99], v[48:51], -4.0
    v_exp_f32 v77, v77
    v_mfma_f32_16x16x32_bf16 v[80:83], a[100:103], v[52:55], v[80:83]
    ds_read_b128 v[144:147], v6 offset:34304
    v_cvt_pk_bf16_f32 v122, v76, v77
    v_mfma_f32_16x16x32_bf16 v[80:83], a[104:107], v[56:59], v[80:83]
    v_exp_f32 v78, v78
    v_mfma_f32_16x16x32_bf16 v[80:83], a[108:111], v[60:63], v[80:83]
    s_waitcnt lgkmcnt(5)
    v_exp_f32 v79, v79
    v_mfma_f32_16x16x32_bf16 v[176:179], a[224:227], v[128:131], v[176:179]
    ds_read_b128 v[148:151], v6 offset:36352
    v_cvt_pk_bf16_f32 v123, v78, v79
    v_mfma_f32_16x16x32_bf16 v[176:179], a[232:235], v[132:135], v[176:179]
    ds_write_b128 v3, v[120:123] offset:6144
    v_mfma_f32_16x16x32_bf16 v[176:179], a[240:243], v[136:139], v[176:179]
    s_nop 1
    v_mfma_f32_16x16x32_bf16 v[176:179], a[248:251], v[140:143], v[176:179]
    v_exp_f32 v80, v80
    v_mfma_f32_16x16x32_bf16 v[84:87], a[112:115], v[48:51], -4.0
    ds_read_b128 v[152:155], v6 offset:38400
    ds_read_b128 v[156:159], v6 offset:40448
    v_mfma_f32_16x16x32_bf16 v[84:87], a[116:119], v[52:55], v[84:87]
    v_exp_f32 v81, v81
    v_mfma_f32_16x16x32_bf16 v[84:87], a[120:123], v[56:59], v[84:87]
    ds_read_b128 v[48:51], v1 offset:4160
    v_cvt_pk_bf16_f32 v124, v80, v81
    v_mfma_f32_16x16x32_bf16 v[84:87], a[124:127], v[60:63], v[84:87]
    v_exp_f32 v82, v82
    v_mfma_f32_16x16x32_bf16 v[180:183], a[228:231], v[128:131], v[180:183]
    v_exp_f32 v83, v83
    v_mfma_f32_16x16x32_bf16 v[180:183], a[236:239], v[132:135], v[180:183]
    ds_read_b128 v[52:55], v1 offset:4416
    v_cvt_pk_bf16_f32 v125, v82, v83
    v_mfma_f32_16x16x32_bf16 v[180:183], a[244:247], v[136:139], v[180:183]
    ds_read_b128 v[56:59], v1 offset:4672
    ds_read_b128 v[60:63], v1 offset:4928
    v_mfma_f32_16x16x32_bf16 v[180:183], a[252:255], v[140:143], v[180:183]
    s_waitcnt lgkmcnt(9)
    v_exp_f32 v84, v84
    v_mfma_f32_16x16x32_bf16 v[88:91], a[0:3], v[32:35], -4.0
    v_exp_f32 v85, v85
    v_mfma_f32_16x16x32_bf16 v[88:91], a[4:7], v[36:39], v[88:91]
    v_cvt_pk_bf16_f32 v126, v84, v85
    v_mfma_f32_16x16x32_bf16 v[88:91], a[8:11], v[40:43], v[88:91]
    v_exp_f32 v86, v86
    v_mfma_f32_16x16x32_bf16 v[88:91], a[12:15], v[44:47], v[88:91]
    s_waitcnt lgkmcnt(4)
    v_exp_f32 v87, v87
    v_mfma_f32_16x16x32_bf16 v[184:187], a[224:227], v[144:147], v[184:187]
    v_cvt_pk_bf16_f32 v127, v86, v87
    s_nop 0
    v_mfma_f32_16x16x32_bf16 v[184:187], a[232:235], v[148:151], v[184:187]
    ds_write_b128 v3, v[124:127] offset:7168
    v_mfma_f32_16x16x32_bf16 v[184:187], a[240:243], v[152:155], v[184:187]
    s_nop 1
    v_mfma_f32_16x16x32_bf16 v[184:187], a[248:251], v[156:159], v[184:187]
    v_exp_f32 v88, v88
    v_mfma_f32_16x16x32_bf16 v[92:95], a[16:19], v[32:35], -4.0
    v_exp_f32 v89, v89
    v_mfma_f32_16x16x32_bf16 v[92:95], a[20:23], v[36:39], v[92:95]
    v_exp_f32 v90, v90
    v_mfma_f32_16x16x32_bf16 v[92:95], a[24:27], v[40:43], v[92:95]
    v_exp_f32 v91, v91
    v_mfma_f32_16x16x32_bf16 v[92:95], a[28:31], v[44:47], v[92:95]
    s_waitcnt vmcnt(9) lgkmcnt(0)
    v_mfma_f32_16x16x32_bf16 v[188:191], a[228:231], v[144:147], v[188:191]
    s_barrier
    v_mfma_f32_16x16x32_bf16 v[188:191], a[236:239], v[148:151], v[188:191]
    v_mfma_f32_16x16x32_bf16 v[188:191], a[244:247], v[152:155], v[188:191]
    v_mfma_f32_16x16x32_bf16 v[188:191], a[252:255], v[156:159], v[188:191]
L_mid1:
    v_mfma_f32_16x16x32_bf16 v[160:163], a[128:131], v[96:99], v[240:243]
    s_add_u32 s24, s24, 8320
    ds_read_b128 v[16:19], v10 offset:512
    ds_read_b128 v[128:131], v4 offset:0
    v_mfma_f32_16x16x32_bf16 v[160:163], a[136:139], v[104:107], v[160:163]
    s_cmp_eq_u32 s24, 124800
    v_exp_f32 v92, v92
    v_mfma_f32_16x16x32_bf16 v[160:163], a[144:147], v[112:115], v[160:163]
    s_cselect_b32 s24, 66560, s24
    ds_read_b128 v[132:135], v4 offset:2048
    ds_read_b128 v[136:139], v4 offset:4096
    v_mfma_f32_16x16x32_bf16 v[160:163], a[152:155], v[120:123], v[160:163]
    v_exp_f32 v93, v93
    v_mfma_f32_16x16x32_bf16 v[164:167], a[132:135], v[96:99], v[240:243]
    s_mov_b32 m0, s23
    ds_read_b128 v[140:143], v4 offset:6144
    ds_read_b128 v[144:147], v4 offset:1024
    v_mfma_f32_16x16x32_bf16 v[164:167], a[140:143], v[104:107], v[164:167]
    s_add_u32 s23, s23, 8320
    v_exp_f32 v94, v94
    v_mfma_f32_16x16x32_bf16 v[164:167], a[148:151], v[112:115], v[164:167]
    s_cmp_eq_u32 s23, s27
    ds_read_b128 v[148:151], v4 offset:3072
    ds_read_b128 v[152:155], v4 offset:5120
    v_mfma_f32_16x16x32_bf16 v[164:167], a[156:159], v[120:123], v[164:167]
    s_waitcnt lgkmcnt(7)
    v_exp_f32 v95, v95
    v_mfma_f32_16x16x32_bf16 v[64:67], a[0:3], v[48:51], -4.0
    s_cselect_b32 s23, s30, s23
    ds_read_b128 v[156:159], v4 offset:7168
    v_add_f32 v16, v16, v17
    v_mfma_f32_16x16x32_bf16 v[64:67], a[4:7], v[52:55], v[64:67]
    v_add_f32 v18, v18, v19
    v_add_f32 v16, v16, v18
    v_mfma_f32_16x16x32_bf16 v[64:67], a[8:11], v[56:59], v[64:67]
    v_rcp_f32 v13, v16
    v_mfma_f32_16x16x32_bf16 v[64:67], a[12:15], v[60:63], v[64:67]
    v_mov_b32 v14, v13
    v_max_u32 v12, v12, v13
    v_mfma_f32_16x16x32_bf16 v[20:23], v[24:27], v[96:99], 0
    v_cvt_pk_bf16_f32 v96, v88, v89
    v_cvt_pk_bf16_f32 v97, v90, v91
    v_mfma_f32_16x16x32_bf16 v[20:23], v[24:27], v[104:107], v[20:23]
    v_cvt_pk_bf16_f32 v98, v92, v93
    v_cvt_pk_bf16_f32 v99, v94, v95
    v_mfma_f32_16x16x32_bf16 v[20:23], v[24:27], v[112:115], v[20:23]
    ds_write_b128 v3, v[96:99] offset:33280
    v_mfma_f32_16x16x32_bf16 v[20:23], v[24:27], v[120:123], v[20:23]
    v_exp_f32 v64, v64
    v_mfma_f32_16x16x32_bf16 v[68:71], a[16:19], v[48:51], -4.0
    v_exp_f32 v65, v65
    v_mfma_f32_16x16x32_bf16 v[68:71], a[20:23], v[52:55], v[68:71]
    v_permlane32_swap_b32 v13, v14
    v_mul_f32 v253, -v240, v13
    v_mfma_f32_16x16x32_bf16 v[68:71], a[24:27], v[56:59], v[68:71]
    v_exp_f32 v66, v66
    v_mfma_f32_16x16x32_bf16 v[68:71], a[28:31], v[60:63], v[68:71]
    v_mul_f32 v254, -v240, v14
    v_fma_f32 v176, v176, v13, v253
    v_mfma_f32_16x16x32_bf16 v[168:171], a[128:131], v[100:103], v[240:243]
    v_exp_f32 v67, v67
    v_mfma_f32_16x16x32_bf16 v[168:171], a[136:139], v[108:111], v[168:171]
    v_fma_f32 v177, v177, v13, v253
    v_max_u32 v11, v11, v16
    v_mfma_f32_16x16x32_bf16 v[168:171], a[144:147], v[116:119], v[168:171]
    v_exp_f32 v68, v68
    v_mfma_f32_16x16x32_bf16 v[168:171], a[152:155], v[124:127], v[168:171]
    v_exp_f32 v69, v69
    v_mfma_f32_16x16x32_bf16 v[72:75], a[32:35], v[32:35], -4.0
    v_exp_f32 v70, v70
    v_mfma_f32_16x16x32_bf16 v[72:75], a[36:39], v[36:39], v[72:75]
    v_exp_f32 v71, v71
    v_mfma_f32_16x16x32_bf16 v[72:75], a[40:43], v[40:43], v[72:75]
    v_cvt_pk_bf16_f32 v192, v176, v177
    v_fma_f32 v178, v178, v13, v253
    v_mfma_f32_16x16x32_bf16 v[72:75], a[44:47], v[44:47], v[72:75]
    v_fma_f32 v179, v179, v13, v253
    v_cvt_pk_bf16_f32 v193, v178, v179
    v_mfma_f32_16x16x32_bf16 v[172:175], a[132:135], v[100:103], v[240:243]
    v_fma_f32 v180, v180, v13, v253
    v_fma_f32 v181, v181, v13, v253
    v_mfma_f32_16x16x32_bf16 v[172:175], a[140:143], v[108:111], v[172:175]
    v_cvt_pk_bf16_f32 v194, v180, v181
    v_fma_f32 v182, v182, v13, v253
    v_mfma_f32_16x16x32_bf16 v[172:175], a[148:151], v[116:119], v[172:175]
    v_exp_f32 v72, v72
    v_mfma_f32_16x16x32_bf16 v[172:175], a[156:159], v[124:127], v[172:175]
    v_exp_f32 v73, v73
    v_mfma_f32_16x16x32_bf16 v[76:79], a[48:51], v[32:35], -4.0
    v_cvt_pk_bf16_f32 v104, v72, v73
    v_fma_f32 v183, v183, v13, v253
    v_mfma_f32_16x16x32_bf16 v[76:79], a[52:55], v[36:39], v[76:79]
    v_exp_f32 v74, v74
    v_mfma_f32_16x16x32_bf16 v[76:79], a[56:59], v[40:43], v[76:79]
    v_exp_f32 v75, v75
    v_mfma_f32_16x16x32_bf16 v[76:79], a[60:63], v[44:47], v[76:79]
    v_cvt_pk_bf16_f32 v105, v74, v75
    v_cvt_pk_bf16_f32 v195, v182, v183
    v_mfma_f32_16x16x32_bf16 v[20:23], v[28:31], v[100:103], v[20:23]
    v_cvt_pk_bf16_f32 v100, v64, v65
    v_cvt_pk_bf16_f32 v101, v66, v67
    v_mfma_f32_16x16x32_bf16 v[20:23], v[28:31], v[108:111], v[20:23]
    v_cvt_pk_bf16_f32 v102, v68, v69
    v_cvt_pk_bf16_f32 v103, v70, v71
    v_mfma_f32_16x16x32_bf16 v[20:23], v[28:31], v[116:119], v[20:23]
    ds_write_b128 v3, v[100:103] offset:34304
    v_mfma_f32_16x16x32_bf16 v[20:23], v[28:31], v[124:127], v[20:23]
    v_exp_f32 v76, v76
    v_mfma_f32_16x16x32_bf16 v[80:83], a[32:35], v[48:51], -4.0
    v_exp_f32 v77, v77
    v_mfma_f32_16x16x32_bf16 v[80:83], a[36:39], v[52:55], v[80:83]
    v_cvt_pk_bf16_f32 v106, v76, v77
    v_fma_f32 v184, v184, v14, v254
    v_mfma_f32_16x16x32_bf16 v[80:83], a[40:43], v[56:59], v[80:83]
    v_exp_f32 v78, v78
    v_mfma_f32_16x16x32_bf16 v[80:83], a[44:47], v[60:63], v[80:83]
    s_waitcnt lgkmcnt(6)
    v_exp_f32 v79, v79
    v_mfma_f32_16x16x32_bf16 v[160:163], a[160:163], v[128:131], v[160:163]
    v_cvt_pk_bf16_f32 v107, v78, v79
    v_fma_f32 v185, v185, v14, v254
    v_mfma_f32_16x16x32_bf16 v[160:163], a[168:171], v[132:135], v[160:163]
    ds_write_b128 v3, v[104:107] offset:35328
    v_mfma_f32_16x16x32_bf16 v[160:163], a[176:179], v[136:139], v[160:163]
    v_cvt_pk_bf16_f32 v196, v184, v185
    v_fma_f32 v186, v186, v14, v254
    v_mfma_f32_16x16x32_bf16 v[160:163], a[184:187], v[140:143], v[160:163]
    v_exp_f32 v80, v80
    v_mfma_f32_16x16x32_bf16 v[84:87], a[48:51], v[48:51], -4.0
    v_exp_f32 v81, v81
    v_mfma_f32_16x16x32_bf16 v[84:87], a[52:55], v[52:55], v[84:87]
    v_cvt_pk_bf16_f32 v108, v80, v81
    v_fma_f32 v187, v187, v14, v254
    v_mfma_f32_16x16x32_bf16 v[84:87], a[56:59], v[56:59], v[84:87]
    ds_write_b32 v9, v20 offset:0
    v_mfma_f32_16x16x32_bf16 v[84:87], a[60:63], v[60:63], v[84:87]
    v_exp_f32 v82, v82
    v_mfma_f32_16x16x32_bf16 v[164:167], a[164:167], v[128:131], v[164:167]
    v_exp_f32 v83, v83
    v_mfma_f32_16x16x32_bf16 v[164:167], a[172:175], v[132:135], v[164:167]
    ds_read_b128 v[128:131], v5 offset:0
    v_cvt_pk_bf16_f32 v109, v82, v83
    v_mfma_f32_16x16x32_bf16 v[164:167], a[180:183], v[136:139], v[164:167]
    ds_read_b128 v[132:135], v5 offset:2048
    ds_read_b128 v[136:139], v5 offset:4096
    v_mfma_f32_16x16x32_bf16 v[164:167], a[188:191], v[140:143], v[164:167]
    v_exp_f32 v84, v84
    v_mfma_f32_16x16x32_bf16 v[88:91], a[64:67], v[32:35], -4.0
    v_exp_f32 v85, v85
    v_mfma_f32_16x16x32_bf16 v[88:91], a[68:71], v[36:39], v[88:91]
    ds_read_b128 v[140:143], v5 offset:6144
    v_cvt_pk_bf16_f32 v110, v84, v85
    v_mfma_f32_16x16x32_bf16 v[88:91], a[72:75], v[40:43], v[88:91]
    v_exp_f32 v86, v86
    v_mfma_f32_16x16x32_bf16 v[88:91], a[76:79], v[44:47], v[88:91]
    s_waitcnt lgkmcnt(8)
    v_exp_f32 v87, v87
    v_mfma_f32_16x16x32_bf16 v[168:171], a[160:163], v[144:147], v[168:171]
    v_cvt_pk_bf16_f32 v111, v86, v87
    v_cvt_pk_bf16_f32 v197, v186, v187
    v_mfma_f32_16x16x32_bf16 v[168:171], a[168:171], v[148:151], v[168:171]
    ds_write_b128 v3, v[108:111] offset:36352
    v_mfma_f32_16x16x32_bf16 v[168:171], a[176:179], v[152:155], v[168:171]
    v_fma_f32 v188, v188, v14, v254
    v_add_u32 v1, s24, v2
    v_mfma_f32_16x16x32_bf16 v[168:171], a[184:187], v[156:159], v[168:171]
    v_exp_f32 v88, v88
    v_mfma_f32_16x16x32_bf16 v[92:95], a[80:83], v[32:35], -4.0
    v_exp_f32 v89, v89
    v_mfma_f32_16x16x32_bf16 v[92:95], a[84:87], v[36:39], v[92:95]
    v_cvt_pk_bf16_f32 v112, v88, v89
    v_fma_f32 v189, v189, v14, v254
    v_mfma_f32_16x16x32_bf16 v[92:95], a[88:91], v[40:43], v[92:95]
    buffer_store_dwordx4 v[192:195], v8, s[16:19], s25 offen sc0 sc1
    v_mfma_f32_16x16x32_bf16 v[92:95], a[92:95], v[44:47], v[92:95]
    v_exp_f32 v90, v90
    v_mfma_f32_16x16x32_bf16 v[172:175], a[164:167], v[144:147], v[172:175]
    v_exp_f32 v91, v91
    v_mfma_f32_16x16x32_bf16 v[172:175], a[172:175], v[148:151], v[172:175]
    ds_read_b128 v[144:147], v5 offset:1024
    v_cvt_pk_bf16_f32 v113, v90, v91
    v_mfma_f32_16x16x32_bf16 v[172:175], a[180:183], v[152:155], v[172:175]
    ds_read_b128 v[148:151], v5 offset:3072
    ds_read_b128 v[152:155], v5 offset:5120
    v_mfma_f32_16x16x32_bf16 v[172:175], a[188:191], v[156:159], v[172:175]
    v_exp_f32 v92, v92
    v_mfma_f32_16x16x32_bf16 v[64:67], a[64:67], v[48:51], -4.0
    v_exp_f32 v93, v93
    v_mfma_f32_16x16x32_bf16 v[64:67], a[68:71], v[52:55], v[64:67]
    buffer_load_dwordx4 v7, s[4:7], s22 offen offset:0 nt lds
    v_mfma_f32_16x16x32_bf16 v[64:67], a[72:75], v[56:59], v[64:67]
    v_cvt_pk_bf16_f32 v114, v92, v93
    v_cvt_pk_bf16_f32 v198, v188, v189
    v_mfma_f32_16x16x32_bf16 v[64:67], a[76:79], v[60:63], v[64:67]
    s_waitcnt lgkmcnt(4)
    v_exp_f32 v94, v94
    v_mfma_f32_16x16x32_bf16 v[160:163], a[192:195], v[128:131], v[160:163]
    v_exp_f32 v95, v95
    v_mfma_f32_16x16x32_bf16 v[160:163], a[200:203], v[132:135], v[160:163]
    ds_read_b128 v[156:159], v5 offset:7168
    v_cvt_pk_bf16_f32 v115, v94, v95
    v_mfma_f32_16x16x32_bf16 v[160:163], a[208:211], v[136:139], v[160:163]
    ds_write_b128 v3, v[112:115] offset:37376
    v_mfma_f32_16x16x32_bf16 v[160:163], a[216:219], v[140:143], v[160:163]
    v_exp_f32 v64, v64
    v_mfma_f32_16x16x32_bf16 v[68:71], a[80:83], v[48:51], -4.0
    v_exp_f32 v65, v65
    v_mfma_f32_16x16x32_bf16 v[68:71], a[84:87], v[52:55], v[68:71]
    v_cvt_pk_bf16_f32 v116, v64, v65
    v_fma_f32 v190, v190, v14, v254
    v_mfma_f32_16x16x32_bf16 v[68:71], a[88:91], v[56:59], v[68:71]
    v_exp_f32 v66, v66
    v_mfma_f32_16x16x32_bf16 v[68:71], a[92:95], v[60:63], v[68:71]
    buffer_load_dwordx4 v7, s[4:7], s22 offen offset:1024 nt lds
    v_mfma_f32_16x16x32_bf16 v[164:167], a[196:199], v[128:131], v[164:167]
    s_add_u32 s22, s22, 8192
    v_exp_f32 v67, v67
    v_mfma_f32_16x16x32_bf16 v[164:167], a[204:207], v[132:135], v[164:167]
    s_add_u32 s25, s25, 8192
    ds_read_b128 v[128:131], v6 offset:0
    v_cvt_pk_bf16_f32 v117, v66, v67
    v_mfma_f32_16x16x32_bf16 v[164:167], a[212:215], v[136:139], v[164:167]
    v_exp_f32 v68, v68
    v_mfma_f32_16x16x32_bf16 v[164:167], a[220:223], v[140:143], v[164:167]
    v_exp_f32 v69, v69
    v_mfma_f32_16x16x32_bf16 v[72:75], a[96:99], v[32:35], -4.0
    v_cvt_pk_bf16_f32 v118, v68, v69
    v_fma_f32 v191, v191, v14, v254
    v_mfma_f32_16x16x32_bf16 v[72:75], a[100:103], v[36:39], v[72:75]
    v_exp_f32 v70, v70
    v_mfma_f32_16x16x32_bf16 v[72:75], a[104:107], v[40:43], v[72:75]
    v_exp_f32 v71, v71
    v_mfma_f32_16x16x32_bf16 v[72:75], a[108:111], v[44:47], v[72:75]
    s_waitcnt lgkmcnt(2)
    ds_read_b128 v[132:135], v6 offset:2048
    v_cvt_pk_bf16_f32 v119, v70, v71
    v_mfma_f32_16x16x32_bf16 v[168:171], a[192:195], v[144:147], v[168:171]
    ds_write_b128 v3, v[116:119] offset:38400
    v_mfma_f32_16x16x32_bf16 v[168:171], a[200:203], v[148:151], v[168:171]
    v_cvt_pk_bf16_f32 v199, v190, v191
    s_nop 0
    v_mfma_f32_16x16x32_bf16 v[168:171], a[208:211], v[152:155], v[168:171]
    v_exp_f32 v72, v72
    v_mfma_f32_16x16x32_bf16 v[168:171], a[216:219], v[156:159], v[168:171]
    ds_read_b128 v[136:139], v6 offset:4096
    ds_read_b128 v[140:143], v6 offset:6144
    v_mfma_f32_16x16x32_bf16 v[76:79], a[112:115], v[32:35], -4.0
    v_exp_f32 v73, v73
    v_mfma_f32_16x16x32_bf16 v[76:79], a[116:119], v[36:39], v[76:79]
    ds_read_b128 v[32:35], v1 offset:0
    v_cvt_pk_bf16_f32 v120, v72, v73
    v_mfma_f32_16x16x32_bf16 v[76:79], a[120:123], v[40:43], v[76:79]
    v_exp_f32 v74, v74
    v_mfma_f32_16x16x32_bf16 v[76:79], a[124:127], v[44:47], v[76:79]
    v_exp_f32 v75, v75
    v_mfma_f32_16x16x32_bf16 v[172:175], a[196:199], v[144:147], v[172:175]
    ds_read_b128 v[36:39], v1 offset:256
    v_cvt_pk_bf16_f32 v121, v74, v75
    v_mfma_f32_16x16x32_bf16 v[172:175], a[204:207], v[148:151], v[172:175]
    buffer_store_dwordx4 v[196:199], v8, s[16:19], s26 offen sc0 sc1
    v_mfma_f32_16x16x32_bf16 v[172:175], a[212:215], v[152:155], v[172:175]
    s_add_u32 s26, s26, 8192
    ds_read_b128 v[40:43], v1 offset:512
    ds_read_b128 v[44:47], v1 offset:768
    v_mfma_f32_16x16x32_bf16 v[172:175], a[220:223], v[156:159], v[172:175]
    v_exp_f32 v76, v76
    v_mfma_f32_16x16x32_bf16 v[80:83], a[96:99], v[48:51], -4.0
    v_exp_f32 v77, v77
    v_mfma_f32_16x16x32_bf16 v[80:83], a[100:103], v[52:55], v[80:83]
    ds_read_b128 v[144:147], v6 offset:1024
    v_cvt_pk_bf16_f32 v122, v76, v77
    v_mfma_f32_16x16x32_bf16 v[80:83], a[104:107], v[56:59], v[80:83]
    v_exp_f32 v78, v78
    v_mfma_f32_16x16x32_bf16 v[80:83], a[108:111], v[60:63], v[80:83]
    s_waitcnt lgkmcnt(5)
    v_exp_f32 v79, v79
    v_mfma_f32_16x16x32_bf16 v[160:163], a[224:227], v[128:131], v[160:163]
    ds_read_b128 v[148:151], v6 offset:3072
    v_cvt_pk_bf16_f32 v123, v78, v79
    v_mfma_f32_16x16x32_bf16 v[160:163], a[232:235], v[132:135], v[160:163]
    ds_write_b128 v3, v[120:123] offset:39424
    v_mfma_f32_16x16x32_bf16 v[160:163], a[240:243], v[136:139], v[160:163]
    s_nop 1
    v_mfma_f32_16x16x32_bf16 v[160:163], a[248:251], v[140:143], v[160:163]
    v_exp_f32 v80, v80
    v_mfma_f32_16x16x32_bf16 v[84:87], a[112:115], v[48:51], -4.0
    ds_read_b128 v[152:155], v6 offset:5120
    ds_read_b128 v[156:159], v6 offset:7168
    v_mfma_f32_16x16x32_bf16 v[84:87], a[116:119], v[52:55], v[84:87]
    v_exp_f32 v81, v81
    v_mfma_f32_16x16x32_bf16 v[84:87], a[120:123], v[56:59], v[84:87]
    ds_read_b128 v[48:51], v1 offset:4160
    v_cvt_pk_bf16_f32 v124, v80, v81
    v_mfma_f32_16x16x32_bf16 v[84:87], a[124:127], v[60:63], v[84:87]
    v_exp_f32 v82, v82
    v_mfma_f32_16x16x32_bf16 v[164:167], a[228:231], v[128:131], v[164:167]
    v_exp_f32 v83, v83
    v_mfma_f32_16x16x32_bf16 v[164:167], a[236:239], v[132:135], v[164:167]
    ds_read_b128 v[52:55], v1 offset:4416
    v_cvt_pk_bf16_f32 v125, v82, v83
    v_mfma_f32_16x16x32_bf16 v[164:167], a[244:247], v[136:139], v[164:167]
    ds_read_b128 v[56:59], v1 offset:4672
    ds_read_b128 v[60:63], v1 offset:4928
    v_mfma_f32_16x16x32_bf16 v[164:167], a[252:255], v[140:143], v[164:167]
    s_waitcnt lgkmcnt(9)
    v_exp_f32 v84, v84
    v_mfma_f32_16x16x32_bf16 v[88:91], a[0:3], v[32:35], -4.0
    v_exp_f32 v85, v85
    v_mfma_f32_16x16x32_bf16 v[88:91], a[4:7], v[36:39], v[88:91]
    v_cvt_pk_bf16_f32 v126, v84, v85
    v_mfma_f32_16x16x32_bf16 v[88:91], a[8:11], v[40:43], v[88:91]
    v_exp_f32 v86, v86
    v_mfma_f32_16x16x32_bf16 v[88:91], a[12:15], v[44:47], v[88:91]
    s_waitcnt lgkmcnt(4)
    v_exp_f32 v87, v87
    v_mfma_f32_16x16x32_bf16 v[168:171], a[224:227], v[144:147], v[168:171]
    v_cvt_pk_bf16_f32 v127, v86, v87
    s_nop 0
    v_mfma_f32_16x16x32_bf16 v[168:171], a[232:235], v[148:151], v[168:171]
    ds_write_b128 v3, v[124:127] offset:40448
    v_mfma_f32_16x16x32_bf16 v[168:171], a[240:243], v[152:155], v[168:171]
    s_nop 1
    v_mfma_f32_16x16x32_bf16 v[168:171], a[248:251], v[156:159], v[168:171]
    v_exp_f32 v88, v88
    v_mfma_f32_16x16x32_bf16 v[92:95], a[16:19], v[32:35], -4.0
    s_sub_u32 s21, s21, 1
    v_exp_f32 v89, v89
    v_mfma_f32_16x16x32_bf16 v[92:95], a[20:23], v[36:39], v[92:95]
    s_cmp_lg_u32 s21, 0
    v_exp_f32 v90, v90
    v_mfma_f32_16x16x32_bf16 v[92:95], a[24:27], v[40:43], v[92:95]
    v_exp_f32 v91, v91
    v_mfma_f32_16x16x32_bf16 v[92:95], a[28:31], v[44:47], v[92:95]
    s_waitcnt vmcnt(9) lgkmcnt(0)
    v_mfma_f32_16x16x32_bf16 v[172:175], a[228:231], v[144:147], v[172:175]
    s_barrier
    v_mfma_f32_16x16x32_bf16 v[172:175], a[236:239], v[148:151], v[172:175]
    v_mfma_f32_16x16x32_bf16 v[172:175], a[244:247], v[152:155], v[172:175]
    v_mfma_f32_16x16x32_bf16 v[172:175], a[252:255], v[156:159], v[172:175]
    s_cbranch_scc1 L_loop1
L_after:
    v_mfma_f32_16x16x32_bf16 v[176:179], a[128:131], v[96:99], v[240:243]
    ds_read_b128 v[16:19], v10 offset:0
    ds_read_b128 v[128:131], v4 offset:33280
    v_mfma_f32_16x16x32_bf16 v[176:179], a[136:139], v[104:107], v[176:179]
    v_exp_f32 v92, v92
    v_mfma_f32_16x16x32_bf16 v[176:179], a[144:147], v[112:115], v[176:179]
    ds_read_b128 v[132:135], v4 offset:35328
    ds_read_b128 v[136:139], v4 offset:37376
    v_mfma_f32_16x16x32_bf16 v[176:179], a[152:155], v[120:123], v[176:179]
    v_exp_f32 v93, v93
    v_mfma_f32_16x16x32_bf16 v[180:183], a[132:135], v[96:99], v[240:243]
    ds_read_b128 v[140:143], v4 offset:39424
    ds_read_b128 v[144:147], v4 offset:34304
    v_mfma_f32_16x16x32_bf16 v[180:183], a[140:143], v[104:107], v[180:183]
    v_exp_f32 v94, v94
    v_mfma_f32_16x16x32_bf16 v[180:183], a[148:151], v[112:115], v[180:183]
    ds_read_b128 v[148:151], v4 offset:36352
    ds_read_b128 v[152:155], v4 offset:38400
    v_mfma_f32_16x16x32_bf16 v[180:183], a[156:159], v[120:123], v[180:183]
    s_waitcnt lgkmcnt(7)
    v_exp_f32 v95, v95
    v_mfma_f32_16x16x32_bf16 v[64:67], a[0:3], v[48:51], -4.0
    ds_read_b128 v[156:159], v4 offset:40448
    v_add_f32 v16, v16, v17
    v_mfma_f32_16x16x32_bf16 v[64:67], a[4:7], v[52:55], v[64:67]
    v_add_f32 v18, v18, v19
    v_add_f32 v16, v16, v18
    v_mfma_f32_16x16x32_bf16 v[64:67], a[8:11], v[56:59], v[64:67]
    v_rcp_f32 v13, v16
    v_mfma_f32_16x16x32_bf16 v[64:67], a[12:15], v[60:63], v[64:67]
    v_mov_b32 v14, v13
    v_max_u32 v12, v12, v13
    v_mfma_f32_16x16x32_bf16 v[20:23], v[24:27], v[96:99], 0
    v_cvt_pk_bf16_f32 v96, v88, v89
    v_cvt_pk_bf16_f32 v97, v90, v91
    v_mfma_f32_16x16x32_bf16 v[20:23], v[24:27], v[104:107], v[20:23]
    v_cvt_pk_bf16_f32 v98, v92, v93
    v_cvt_pk_bf16_f32 v99, v94, v95
    v_mfma_f32_16x16x32_bf16 v[20:23], v[24:27], v[112:115], v[20:23]
    ds_write_b128 v3, v[96:99] offset:0
    v_mfma_f32_16x16x32_bf16 v[20:23], v[24:27], v[120:123], v[20:23]
    v_exp_f32 v64, v64
    v_mfma_f32_16x16x32_bf16 v[68:71], a[16:19], v[48:51], -4.0
    v_exp_f32 v65, v65
    v_mfma_f32_16x16x32_bf16 v[68:71], a[20:23], v[52:55], v[68:71]
    v_permlane32_swap_b32 v13, v14
    v_mul_f32 v253, -v240, v13
    v_mfma_f32_16x16x32_bf16 v[68:71], a[24:27], v[56:59], v[68:71]
    v_exp_f32 v66, v66
    v_mfma_f32_16x16x32_bf16 v[68:71], a[28:31], v[60:63], v[68:71]
    v_mul_f32 v254, -v240, v14
    v_fma_f32 v160, v160, v13, v253
    v_mfma_f32_16x16x32_bf16 v[184:187], a[128:131], v[100:103], v[240:243]
    v_exp_f32 v67, v67
    v_mfma_f32_16x16x32_bf16 v[184:187], a[136:139], v[108:111], v[184:187]
    v_fma_f32 v161, v161, v13, v253
    v_max_u32 v11, v11, v16
    v_mfma_f32_16x16x32_bf16 v[184:187], a[144:147], v[116:119], v[184:187]
    v_exp_f32 v68, v68
    v_mfma_f32_16x16x32_bf16 v[184:187], a[152:155], v[124:127], v[184:187]
    v_exp_f32 v69, v69
    v_mfma_f32_16x16x32_bf16 v[72:75], a[32:35], v[32:35], -4.0
    v_exp_f32 v70, v70
    v_mfma_f32_16x16x32_bf16 v[72:75], a[36:39], v[36:39], v[72:75]
    v_exp_f32 v71, v71
    v_mfma_f32_16x16x32_bf16 v[72:75], a[40:43], v[40:43], v[72:75]
    v_cvt_pk_bf16_f32 v192, v160, v161
    v_fma_f32 v162, v162, v13, v253
    v_mfma_f32_16x16x32_bf16 v[72:75], a[44:47], v[44:47], v[72:75]
    v_fma_f32 v163, v163, v13, v253
    v_cvt_pk_bf16_f32 v193, v162, v163
    v_mfma_f32_16x16x32_bf16 v[188:191], a[132:135], v[100:103], v[240:243]
    v_fma_f32 v164, v164, v13, v253
    v_fma_f32 v165, v165, v13, v253
    v_mfma_f32_16x16x32_bf16 v[188:191], a[140:143], v[108:111], v[188:191]
    v_cvt_pk_bf16_f32 v194, v164, v165
    v_fma_f32 v166, v166, v13, v253
    v_mfma_f32_16x16x32_bf16 v[188:191], a[148:151], v[116:119], v[188:191]
    v_exp_f32 v72, v72
    v_mfma_f32_16x16x32_bf16 v[188:191], a[156:159], v[124:127], v[188:191]
    v_exp_f32 v73, v73
    v_mfma_f32_16x16x32_bf16 v[76:79], a[48:51], v[32:35], -4.0
    v_cvt_pk_bf16_f32 v104, v72, v73
    v_fma_f32 v167, v167, v13, v253
    v_mfma_f32_16x16x32_bf16 v[76:79], a[52:55], v[36:39], v[76:79]
    v_exp_f32 v74, v74
    v_mfma_f32_16x16x32_bf16 v[76:79], a[56:59], v[40:43], v[76:79]
    v_exp_f32 v75, v75
    v_mfma_f32_16x16x32_bf16 v[76:79], a[60:63], v[44:47], v[76:79]
    v_cvt_pk_bf16_f32 v105, v74, v75
    v_cvt_pk_bf16_f32 v195, v166, v167
    v_mfma_f32_16x16x32_bf16 v[20:23], v[28:31], v[100:103], v[20:23]
    v_cvt_pk_bf16_f32 v100, v64, v65
    v_cvt_pk_bf16_f32 v101, v66, v67
    v_mfma_f32_16x16x32_bf16 v[20:23], v[28:31], v[108:111], v[20:23]
    v_cvt_pk_bf16_f32 v102, v68, v69
    v_cvt_pk_bf16_f32 v103, v70, v71
    v_mfma_f32_16x16x32_bf16 v[20:23], v[28:31], v[116:119], v[20:23]
    ds_write_b128 v3, v[100:103] offset:1024
    v_mfma_f32_16x16x32_bf16 v[20:23], v[28:31], v[124:127], v[20:23]
    v_exp_f32 v76, v76
    v_mfma_f32_16x16x32_bf16 v[80:83], a[32:35], v[48:51], -4.0
    v_exp_f32 v77, v77
    v_mfma_f32_16x16x32_bf16 v[80:83], a[36:39], v[52:55], v[80:83]
    v_cvt_pk_bf16_f32 v106, v76, v77
    v_fma_f32 v168, v168, v14, v254
    v_mfma_f32_16x16x32_bf16 v[80:83], a[40:43], v[56:59], v[80:83]
    v_exp_f32 v78, v78
    v_mfma_f32_16x16x32_bf16 v[80:83], a[44:47], v[60:63], v[80:83]
    s_waitcnt lgkmcnt(6)
    v_exp_f32 v79, v79
    v_mfma_f32_16x16x32_bf16 v[176:179], a[160:163], v[128:131], v[176:179]
    v_cvt_pk_bf16_f32 v107, v78, v79
    v_fma_f32 v169, v169, v14, v254
    v_mfma_f32_16x16x32_bf16 v[176:179], a[168:171], v[132:135], v[176:179]
    ds_write_b128 v3, v[104:107] offset:2048
    v_mfma_f32_16x16x32_bf16 v[176:179], a[176:179], v[136:139], v[176:179]
    v_cvt_pk_bf16_f32 v196, v168, v169
    v_fma_f32 v170, v170, v14, v254
    v_mfma_f32_16x16x32_bf16 v[176:179], a[184:187], v[140:143], v[176:179]
    v_exp_f32 v80, v80
    v_mfma_f32_16x16x32_bf16 v[84:87], a[48:51], v[48:51], -4.0
    v_exp_f32 v81, v81
    v_mfma_f32_16x16x32_bf16 v[84:87], a[52:55], v[52:55], v[84:87]
    v_cvt_pk_bf16_f32 v108, v80, v81
    v_fma_f32 v171, v171, v14, v254
    v_mfma_f32_16x16x32_bf16 v[84:87], a[56:59], v[56:59], v[84:87]
    ds_write_b32 v9, v20 offset:512
    v_mfma_f32_16x16x32_bf16 v[84:87], a[60:63], v[60:63], v[84:87]
    v_exp_f32 v82, v82
    v_mfma_f32_16x16x32_bf16 v[180:183], a[164:167], v[128:131], v[180:183]
    v_exp_f32 v83, v83
    v_mfma_f32_16x16x32_bf16 v[180:183], a[172:175], v[132:135], v[180:183]
    ds_read_b128 v[128:131], v5 offset:33280
    v_cvt_pk_bf16_f32 v109, v82, v83
    v_mfma_f32_16x16x32_bf16 v[180:183], a[180:183], v[136:139], v[180:183]
    ds_read_b128 v[132:135], v5 offset:35328
    ds_read_b128 v[136:139], v5 offset:37376
    v_mfma_f32_16x16x32_bf16 v[180:183], a[188:191], v[140:143], v[180:183]
    v_exp_f32 v84, v84
    v_mfma_f32_16x16x32_bf16 v[88:91], a[64:67], v[32:35], -4.0
    v_exp_f32 v85, v85
    v_mfma_f32_16x16x32_bf16 v[88:91], a[68:71], v[36:39], v[88:91]
    ds_read_b128 v[140:143], v5 offset:39424
    v_cvt_pk_bf16_f32 v110, v84, v85
    v_mfma_f32_16x16x32_bf16 v[88:91], a[72:75], v[40:43], v[88:91]
    v_exp_f32 v86, v86
    v_mfma_f32_16x16x32_bf16 v[88:91], a[76:79], v[44:47], v[88:91]
    s_waitcnt lgkmcnt(8)
    v_exp_f32 v87, v87
    v_mfma_f32_16x16x32_bf16 v[184:187], a[160:163], v[144:147], v[184:187]
    v_cvt_pk_bf16_f32 v111, v86, v87
    v_cvt_pk_bf16_f32 v197, v170, v171
    v_mfma_f32_16x16x32_bf16 v[184:187], a[168:171], v[148:151], v[184:187]
    ds_write_b128 v3, v[108:111] offset:3072
    v_mfma_f32_16x16x32_bf16 v[184:187], a[176:179], v[152:155], v[184:187]
    v_fma_f32 v172, v172, v14, v254
    v_fma_f32 v173, v173, v14, v254
    v_mfma_f32_16x16x32_bf16 v[184:187], a[184:187], v[156:159], v[184:187]
    v_exp_f32 v88, v88
    v_mfma_f32_16x16x32_bf16 v[92:95], a[80:83], v[32:35], -4.0
    v_exp_f32 v89, v89
    v_mfma_f32_16x16x32_bf16 v[92:95], a[84:87], v[36:39], v[92:95]
    v_cvt_pk_bf16_f32 v112, v88, v89
    v_cvt_pk_bf16_f32 v198, v172, v173
    v_mfma_f32_16x16x32_bf16 v[92:95], a[88:91], v[40:43], v[92:95]
    buffer_store_dwordx4 v[192:195], v8, s[16:19], s25 offen sc0 sc1
    v_mfma_f32_16x16x32_bf16 v[92:95], a[92:95], v[44:47], v[92:95]
    v_exp_f32 v90, v90
    v_mfma_f32_16x16x32_bf16 v[188:191], a[164:167], v[144:147], v[188:191]
    s_add_u32 s25, s25, 8192
    v_exp_f32 v91, v91
    v_mfma_f32_16x16x32_bf16 v[188:191], a[172:175], v[148:151], v[188:191]
    ds_read_b128 v[144:147], v5 offset:34304
    v_cvt_pk_bf16_f32 v113, v90, v91
    v_mfma_f32_16x16x32_bf16 v[188:191], a[180:183], v[152:155], v[188:191]
    v_exp_f32 v92, v92
    v_mfma_f32_16x16x32_bf16 v[188:191], a[188:191], v[156:159], v[188:191]
    v_exp_f32 v93, v93
    v_mfma_f32_16x16x32_bf16 v[64:67], a[64:67], v[48:51], -4.0
    ds_read_b128 v[148:151], v5 offset:36352
    v_cvt_pk_bf16_f32 v114, v92, v93
    v_mfma_f32_16x16x32_bf16 v[64:67], a[68:71], v[52:55], v[64:67]
    v_exp_f32 v94, v94
    v_mfma_f32_16x16x32_bf16 v[64:67], a[72:75], v[56:59], v[64:67]
    v_exp_f32 v95, v95
    v_mfma_f32_16x16x32_bf16 v[64:67], a[76:79], v[60:63], v[64:67]
    s_waitcnt lgkmcnt(3)
    ds_read_b128 v[152:155], v5 offset:38400
    v_cvt_pk_bf16_f32 v115, v94, v95
    v_mfma_f32_16x16x32_bf16 v[176:179], a[192:195], v[128:131], v[176:179]
    ds_write_b128 v3, v[112:115] offset:4096
    v_mfma_f32_16x16x32_bf16 v[176:179], a[200:203], v[132:135], v[176:179]
    v_fma_f32 v174, v174, v14, v254
    v_fma_f32 v175, v175, v14, v254
    v_mfma_f32_16x16x32_bf16 v[176:179], a[208:211], v[136:139], v[176:179]
    v_exp_f32 v64, v64
    v_mfma_f32_16x16x32_bf16 v[176:179], a[216:219], v[140:143], v[176:179]
    ds_read_b128 v[156:159], v5 offset:40448
    v_cvt_pk_bf16_f32 v199, v174, v175
    v_mfma_f32_16x16x32_bf16 v[68:71], a[80:83], v[48:51], -4.0
    v_exp_f32 v65, v65
    v_mfma_f32_16x16x32_bf16 v[68:71], a[84:87], v[52:55], v[68:71]
    v_cvt_pk_bf16_f32 v116, v64, v65
    v_mfma_f32_16x16x32_bf16 v[68:71], a[88:91], v[56:59], v[68:71]
    v_exp_f32 v66, v66
    v_mfma_f32_16x16x32_bf16 v[68:71], a[92:95], v[60:63], v[68:71]
    v_exp_f32 v67, v67
    v_mfma_f32_16x16x32_bf16 v[180:183], a[196:199], v[128:131], v[180:183]
    ds_read_b128 v[128:131], v6 offset:33280
    v_cvt_pk_bf16_f32 v117, v66, v67
    v_mfma_f32_16x16x32_bf16 v[180:183], a[204:207], v[132:135], v[180:183]
    buffer_store_dwordx4 v[196:199], v8, s[16:19], s26 offen sc0 sc1
    v_mfma_f32_16x16x32_bf16 v[180:183], a[212:215], v[136:139], v[180:183]
    s_add_u32 s26, s26, 8192
    v_exp_f32 v68, v68
    v_mfma_f32_16x16x32_bf16 v[180:183], a[220:223], v[140:143], v[180:183]
    v_exp_f32 v69, v69
    v_mfma_f32_16x16x32_bf16 v[72:75], a[96:99], v[32:35], -4.0
    ds_read_b128 v[132:135], v6 offset:35328
    v_cvt_pk_bf16_f32 v118, v68, v69
    v_mfma_f32_16x16x32_bf16 v[72:75], a[100:103], v[36:39], v[72:75]
    v_exp_f32 v70, v70
    v_mfma_f32_16x16x32_bf16 v[72:75], a[104:107], v[40:43], v[72:75]
    v_exp_f32 v71, v71
    v_mfma_f32_16x16x32_bf16 v[72:75], a[108:111], v[44:47], v[72:75]
    s_waitcnt lgkmcnt(2)
    ds_read_b128 v[136:139], v6 offset:37376
    v_cvt_pk_bf16_f32 v119, v70, v71
    v_mfma_f32_16x16x32_bf16 v[184:187], a[192:195], v[144:147], v[184:187]
    ds_write_b128 v3, v[116:119] offset:5120
    v_mfma_f32_16x16x32_bf16 v[184:187], a[200:203], v[148:151], v[184:187]
    s_nop 1
    v_mfma_f32_16x16x32_bf16 v[184:187], a[208:211], v[152:155], v[184:187]
    v_exp_f32 v72, v72
    v_mfma_f32_16x16x32_bf16 v[184:187], a[216:219], v[156:159], v[184:187]
    ds_read_b128 v[140:143], v6 offset:39424
    v_mfma_f32_16x16x32_bf16 v[76:79], a[112:115], v[32:35], -4.0
    v_exp_f32 v73, v73
    v_mfma_f32_16x16x32_bf16 v[76:79], a[116:119], v[36:39], v[76:79]
    v_cvt_pk_bf16_f32 v120, v72, v73
    v_mfma_f32_16x16x32_bf16 v[76:79], a[120:123], v[40:43], v[76:79]
    v_exp_f32 v74, v74
    v_mfma_f32_16x16x32_bf16 v[76:79], a[124:127], v[44:47], v[76:79]
    v_exp_f32 v75, v75
    v_mfma_f32_16x16x32_bf16 v[188:191], a[196:199], v[144:147], v[188:191]
    ds_read_b128 v[144:147], v6 offset:34304
    v_cvt_pk_bf16_f32 v121, v74, v75
    v_mfma_f32_16x16x32_bf16 v[188:191], a[204:207], v[148:151], v[188:191]
    ds_read_b128 v[148:151], v6 offset:36352
    s_nop 0
    v_mfma_f32_16x16x32_bf16 v[188:191], a[212:215], v[152:155], v[188:191]
    v_exp_f32 v76, v76
    v_mfma_f32_16x16x32_bf16 v[188:191], a[220:223], v[156:159], v[188:191]
    v_exp_f32 v77, v77
    v_mfma_f32_16x16x32_bf16 v[80:83], a[96:99], v[48:51], -4.0
    ds_read_b128 v[152:155], v6 offset:38400
    v_cvt_pk_bf16_f32 v122, v76, v77
    v_mfma_f32_16x16x32_bf16 v[80:83], a[100:103], v[52:55], v[80:83]
    v_exp_f32 v78, v78
    v_mfma_f32_16x16x32_bf16 v[80:83], a[104:107], v[56:59], v[80:83]
    v_exp_f32 v79, v79
    v_mfma_f32_16x16x32_bf16 v[80:83], a[108:111], v[60:63], v[80:83]
    s_waitcnt lgkmcnt(3)
    ds_read_b128 v[156:159], v6 offset:40448
    v_cvt_pk_bf16_f32 v123, v78, v79
    v_mfma_f32_16x16x32_bf16 v[176:179], a[224:227], v[128:131], v[176:179]
    ds_write_b128 v3, v[120:123] offset:6144
    v_mfma_f32_16x16x32_bf16 v[176:179], a[232:235], v[132:135], v[176:179]
    s_nop 1
    v_mfma_f32_16x16x32_bf16 v[176:179], a[240:243], v[136:139], v[176:179]
    v_exp_f32 v80, v80
    v_mfma_f32_16x16x32_bf16 v[176:179], a[248:251], v[140:143], v[176:179]
    v_exp_f32 v81, v81
    v_mfma_f32_16x16x32_bf16 v[84:87], a[112:115], v[48:51], -4.0
    v_cvt_pk_bf16_f32 v124, v80, v81
    v_mfma_f32_16x16x32_bf16 v[84:87], a[116:119], v[52:55], v[84:87]
    v_exp_f32 v82, v82
    v_mfma_f32_16x16x32_bf16 v[84:87], a[120:123], v[56:59], v[84:87]
    v_exp_f32 v83, v83
    v_mfma_f32_16x16x32_bf16 v[84:87], a[124:127], v[60:63], v[84:87]
    v_cvt_pk_bf16_f32 v125, v82, v83
    s_nop 0
    v_mfma_f32_16x16x32_bf16 v[180:183], a[228:231], v[128:131], v[180:183]
    s_nop 1
    v_mfma_f32_16x16x32_bf16 v[180:183], a[236:239], v[132:135], v[180:183]
    s_nop 1
    v_mfma_f32_16x16x32_bf16 v[180:183], a[244:247], v[136:139], v[180:183]
    v_exp_f32 v84, v84
    v_mfma_f32_16x16x32_bf16 v[180:183], a[252:255], v[140:143], v[180:183]
    v_exp_f32 v85, v85
    v_mfma_f32_16x16x32_bf16 v[20:23], v[24:27], v[96:99], 0
    v_cvt_pk_bf16_f32 v126, v84, v85
    v_mfma_f32_16x16x32_bf16 v[20:23], v[24:27], v[104:107], v[20:23]
    v_exp_f32 v86, v86
    v_mfma_f32_16x16x32_bf16 v[20:23], v[24:27], v[112:115], v[20:23]
    v_exp_f32 v87, v87
    v_mfma_f32_16x16x32_bf16 v[20:23], v[24:27], v[120:123], v[20:23]
    v_cvt_pk_bf16_f32 v127, v86, v87
    v_mfma_f32_16x16x32_bf16 v[20:23], v[28:31], v[100:103], v[20:23]
    ds_write_b128 v3, v[124:127] offset:7168
    v_mfma_f32_16x16x32_bf16 v[20:23], v[28:31], v[108:111], v[20:23]
    v_mfma_f32_16x16x32_bf16 v[20:23], v[28:31], v[116:119], v[20:23]
    v_mfma_f32_16x16x32_bf16 v[20:23], v[28:31], v[124:127], v[20:23]
    s_waitcnt lgkmcnt(2)
    s_nop 1
    v_mfma_f32_16x16x32_bf16 v[184:187], a[224:227], v[144:147], v[184:187]
    s_nop 1
    v_mfma_f32_16x16x32_bf16 v[184:187], a[232:235], v[148:151], v[184:187]
    s_nop 1
    v_mfma_f32_16x16x32_bf16 v[184:187], a[240:243], v[152:155], v[184:187]
    ds_write_b32 v9, v20 offset:0
    v_mfma_f32_16x16x32_bf16 v[184:187], a[248:251], v[156:159], v[184:187]
    v_mfma_f32_16x16x32_bf16 v[188:191], a[228:231], v[144:147], v[188:191]
    v_mfma_f32_16x16x32_bf16 v[188:191], a[236:239], v[148:151], v[188:191]
    v_mfma_f32_16x16x32_bf16 v[188:191], a[244:247], v[152:155], v[188:191]
    s_waitcnt lgkmcnt(0)
    v_mfma_f32_16x16x32_bf16 v[188:191], a[252:255], v[156:159], v[188:191]
    s_barrier
    v_mfma_f32_16x16x32_bf16 v[160:163], a[128:131], v[96:99], v[240:243]
    ds_read_b128 v[16:19], v10 offset:512
    ds_read_b128 v[128:131], v4 offset:0
    v_mfma_f32_16x16x32_bf16 v[160:163], a[136:139], v[104:107], v[160:163]
    ds_read_b128 v[132:135], v4 offset:2048
    ds_read_b128 v[136:139], v4 offset:4096
    v_mfma_f32_16x16x32_bf16 v[160:163], a[144:147], v[112:115], v[160:163]
    ds_read_b128 v[140:143], v4 offset:6144
    ds_read_b128 v[144:147], v5 offset:0
    v_mfma_f32_16x16x32_bf16 v[160:163], a[152:155], v[120:123], v[160:163]
    s_waitcnt lgkmcnt(5)
    ds_read_b128 v[148:151], v5 offset:2048
    ds_read_b128 v[152:155], v5 offset:4096
    v_mfma_f32_16x16x32_bf16 v[164:167], a[132:135], v[96:99], v[240:243]
    ds_read_b128 v[156:159], v5 offset:6144
    ds_read_b128 v[64:67], v6 offset:0
    v_mfma_f32_16x16x32_bf16 v[164:167], a[140:143], v[104:107], v[164:167]
    ds_read_b128 v[68:71], v6 offset:2048
    ds_read_b128 v[72:75], v6 offset:4096
    v_mfma_f32_16x16x32_bf16 v[164:167], a[148:151], v[112:115], v[164:167]
    v_add_f32 v16, v16, v17
    v_add_f32 v18, v18, v19
    v_mfma_f32_16x16x32_bf16 v[164:167], a[156:159], v[120:123], v[164:167]
    s_waitcnt lgkmcnt(7)
    ds_read_b128 v[76:79], v6 offset:6144
    v_add_f32 v16, v16, v18
    v_mfma_f32_16x16x32_bf16 v[160:163], a[160:163], v[128:131], v[160:163]
    v_rcp_f32 v13, v16
    v_mfma_f32_16x16x32_bf16 v[160:163], a[168:171], v[132:135], v[160:163]
    ds_read_b128 v[80:83], v4 offset:1024
    v_mov_b32 v14, v13
    v_mfma_f32_16x16x32_bf16 v[160:163], a[176:179], v[136:139], v[160:163]
    ds_read_b128 v[84:87], v4 offset:3072
    v_max_u32 v12, v12, v13
    v_mfma_f32_16x16x32_bf16 v[160:163], a[184:187], v[140:143], v[160:163]
    ds_read_b128 v[88:91], v4 offset:5120
    v_permlane32_swap_b32 v13, v14
    v_mfma_f32_16x16x32_bf16 v[164:167], a[164:167], v[128:131], v[164:167]
    ds_read_b128 v[92:95], v4 offset:7168
    v_mul_f32 v253, -v240, v13
    v_mfma_f32_16x16x32_bf16 v[164:167], a[172:175], v[132:135], v[164:167]
    ds_read_b128 v[32:35], v5 offset:1024
    v_mul_f32 v254, -v240, v14
    v_mfma_f32_16x16x32_bf16 v[164:167], a[180:183], v[136:139], v[164:167]
    ds_read_b128 v[36:39], v5 offset:3072
    ds_read_b128 v[40:43], v5 offset:5120
    v_mfma_f32_16x16x32_bf16 v[164:167], a[188:191], v[140:143], v[164:167]
    s_waitcnt lgkmcnt(11)
    ds_read_b128 v[44:47], v5 offset:7168
    ds_read_b128 v[48:51], v6 offset:1024
    v_mfma_f32_16x16x32_bf16 v[160:163], a[192:195], v[144:147], v[160:163]
    ds_read_b128 v[52:55], v6 offset:3072
    v_fma_f32 v176, v176, v13, v253
    v_mfma_f32_16x16x32_bf16 v[160:163], a[200:203], v[148:151], v[160:163]
    ds_read_b128 v[56:59], v6 offset:5120
    v_fma_f32 v177, v177, v13, v253
    v_mfma_f32_16x16x32_bf16 v[160:163], a[208:211], v[152:155], v[160:163]
    ds_read_b128 v[60:63], v6 offset:7168
    v_cvt_pk_bf16_f32 v192, v176, v177
    v_mfma_f32_16x16x32_bf16 v[160:163], a[216:219], v[156:159], v[160:163]
    v_fma_f32 v178, v178, v13, v253
    v_fma_f32 v179, v179, v13, v253
    v_mfma_f32_16x16x32_bf16 v[164:167], a[196:199], v[144:147], v[164:167]
    v_cvt_pk_bf16_f32 v193, v178, v179
    v_max_u32 v11, v11, v16
    v_mfma_f32_16x16x32_bf16 v[164:167], a[204:207], v[148:151], v[164:167]
    v_fma_f32 v180, v180, v13, v253
    v_fma_f32 v181, v181, v13, v253
    v_mfma_f32_16x16x32_bf16 v[164:167], a[212:215], v[152:155], v[164:167]
    v_cvt_pk_bf16_f32 v194, v180, v181
    v_fma_f32 v182, v182, v13, v253
    v_mfma_f32_16x16x32_bf16 v[164:167], a[220:223], v[156:159], v[164:167]
    s_waitcnt lgkmcnt(12)
    v_fma_f32 v183, v183, v13, v253
    v_cvt_pk_bf16_f32 v195, v182, v183
    v_mfma_f32_16x16x32_bf16 v[160:163], a[224:227], v[64:67], v[160:163]
    v_fma_f32 v184, v184, v14, v254
    v_fma_f32 v185, v185, v14, v254
    v_mfma_f32_16x16x32_bf16 v[160:163], a[232:235], v[68:71], v[160:163]
    ds_read_b128 v[16:19], v10 offset:0
    v_cvt_pk_bf16_f32 v196, v184, v185
    v_mfma_f32_16x16x32_bf16 v[160:163], a[240:243], v[72:75], v[160:163]
    buffer_store_dwordx4 v[192:195], v8, s[16:19], s25 offen sc0 sc1
    v_mfma_f32_16x16x32_bf16 v[160:163], a[248:251], v[76:79], v[160:163]
    v_fma_f32 v186, v186, v14, v254
    v_fma_f32 v187, v187, v14, v254
    v_mfma_f32_16x16x32_bf16 v[164:167], a[228:231], v[64:67], v[164:167]
    s_add_u32 s25, s25, 8192
    v_cvt_pk_bf16_f32 v197, v186, v187
    v_fma_f32 v188, v188, v14, v254
    v_mfma_f32_16x16x32_bf16 v[164:167], a[236:239], v[68:71], v[164:167]
    v_fma_f32 v189, v189, v14, v254
    v_cvt_pk_bf16_f32 v198, v188, v189
    v_mfma_f32_16x16x32_bf16 v[164:167], a[244:247], v[72:75], v[164:167]
    v_fma_f32 v190, v190, v14, v254
    v_fma_f32 v191, v191, v14, v254
    v_mfma_f32_16x16x32_bf16 v[164:167], a[252:255], v[76:79], v[164:167]
    s_waitcnt lgkmcnt(0)
    v_add_f32 v16, v16, v17
    v_add_f32 v18, v18, v19
    v_mfma_f32_16x16x32_bf16 v[168:171], a[128:131], v[100:103], v[240:243]
    v_add_f32 v16, v16, v18
    v_cvt_pk_bf16_f32 v199, v190, v191
    v_mfma_f32_16x16x32_bf16 v[168:171], a[136:139], v[108:111], v[168:171]
    v_rcp_f32 v13, v16
    v_mfma_f32_16x16x32_bf16 v[168:171], a[144:147], v[116:119], v[168:171]
    v_mov_b32 v14, v13
    v_max_u32 v12, v12, v13
    v_mfma_f32_16x16x32_bf16 v[168:171], a[152:155], v[124:127], v[168:171]
    v_permlane32_swap_b32 v13, v14
    v_mul_f32 v253, -v240, v13
    v_mfma_f32_16x16x32_bf16 v[172:175], a[132:135], v[100:103], v[240:243]
    v_mul_f32 v254, -v240, v14
    v_max_u32 v11, v11, v16
    v_mfma_f32_16x16x32_bf16 v[172:175], a[140:143], v[108:111], v[172:175]
    buffer_store_dwordx4 v[196:199], v8, s[16:19], s26 offen sc0 sc1
    v_mfma_f32_16x16x32_bf16 v[172:175], a[148:151], v[116:119], v[172:175]
    s_add_u32 s26, s26, 8192
    v_fma_f32 v160, v160, v13, v253
    v_fma_f32 v161, v161, v13, v253
    v_mfma_f32_16x16x32_bf16 v[172:175], a[156:159], v[124:127], v[172:175]
    v_cvt_pk_bf16_f32 v192, v160, v161
    v_fma_f32 v162, v162, v13, v253
    v_mfma_f32_16x16x32_bf16 v[168:171], a[160:163], v[80:83], v[168:171]
    v_fma_f32 v163, v163, v13, v253
    v_cvt_pk_bf16_f32 v193, v162, v163
    v_mfma_f32_16x16x32_bf16 v[168:171], a[168:171], v[84:87], v[168:171]
    v_fma_f32 v164, v164, v13, v253
    v_fma_f32 v165, v165, v13, v253
    v_mfma_f32_16x16x32_bf16 v[168:171], a[176:179], v[88:91], v[168:171]
    v_cvt_pk_bf16_f32 v194, v164, v165
    v_fma_f32 v166, v166, v13, v253
    v_mfma_f32_16x16x32_bf16 v[168:171], a[184:187], v[92:95], v[168:171]
    v_fma_f32 v167, v167, v13, v253
    v_cvt_pk_bf16_f32 v195, v166, v167
    v_mfma_f32_16x16x32_bf16 v[172:175], a[164:167], v[80:83], v[172:175]
    v_mfma_f32_16x16x32_bf16 v[172:175], a[172:175], v[84:87], v[172:175]
    v_mfma_f32_16x16x32_bf16 v[172:175], a[180:183], v[88:91], v[172:175]
    buffer_store_dwordx4 v[192:195], v8, s[16:19], s25 offen sc0 sc1
    v_mfma_f32_16x16x32_bf16 v[172:175], a[188:191], v[92:95], v[172:175]
    v_mfma_f32_16x16x32_bf16 v[168:171], a[192:195], v[32:35], v[168:171]
    s_add_u32 s25, s25, 8192
    v_mfma_f32_16x16x32_bf16 v[168:171], a[200:203], v[36:39], v[168:171]
    v_mfma_f32_16x16x32_bf16 v[168:171], a[208:211], v[40:43], v[168:171]
    v_mfma_f32_16x16x32_bf16 v[168:171], a[216:219], v[44:47], v[168:171]
    v_mfma_f32_16x16x32_bf16 v[172:175], a[196:199], v[32:35], v[172:175]
    v_mfma_f32_16x16x32_bf16 v[172:175], a[204:207], v[36:39], v[172:175]
    v_mfma_f32_16x16x32_bf16 v[172:175], a[212:215], v[40:43], v[172:175]
    v_mfma_f32_16x16x32_bf16 v[172:175], a[220:223], v[44:47], v[172:175]
    v_mfma_f32_16x16x32_bf16 v[168:171], a[224:227], v[48:51], v[168:171]
    v_mfma_f32_16x16x32_bf16 v[168:171], a[232:235], v[52:55], v[168:171]
    v_mfma_f32_16x16x32_bf16 v[168:171], a[240:243], v[56:59], v[168:171]
    v_mfma_f32_16x16x32_bf16 v[168:171], a[248:251], v[60:63], v[168:171]
    s_nop 1
    v_mfma_f32_16x16x32_bf16 v[172:175], a[228:231], v[48:51], v[172:175]
    s_nop 1
    v_mfma_f32_16x16x32_bf16 v[172:175], a[236:239], v[52:55], v[172:175]
    s_nop 1
    v_mfma_f32_16x16x32_bf16 v[172:175], a[244:247], v[56:59], v[172:175]
    v_fma_f32 v168, v168, v14, v254
    v_fma_f32 v169, v169, v14, v254
    v_mfma_f32_16x16x32_bf16 v[172:175], a[252:255], v[60:63], v[172:175]
    v_cvt_pk_bf16_f32 v196, v168, v169
    v_fma_f32 v170, v170, v14, v254
    v_fma_f32 v171, v171, v14, v254
    v_cvt_pk_bf16_f32 v197, v170, v171
    s_nop 3
    v_fma_f32 v172, v172, v14, v254
    v_fma_f32 v173, v173, v14, v254
    v_cvt_pk_bf16_f32 v198, v172, v173
    v_fma_f32 v174, v174, v14, v254
    v_fma_f32 v175, v175, v14, v254
    v_cvt_pk_bf16_f32 v199, v174, v175
    buffer_store_dwordx4 v[196:199], v8, s[16:19], s26 offen sc0 sc1
    s_add_u32 s26, s26, 8192
    s_mov_b32 s49, 0x57800000
    s_mov_b32 s50, 0x41800000
    v_cmp_lt_u32 vcc, s49, v11
    v_cmp_lt_u32 s[52:53], s50, v12
    s_nop 3
    s_or_b64 vcc, vcc, s[52:53]
    s_nop 3
    s_cbranch_vccnz L_fallback
    s_endpgm
L_fallback:
    s_waitcnt vmcnt(0) lgkmcnt(0)
    s_barrier
    s_mov_b32 s22, 0
    s_mov_b32 s25, 0
    s_mov_b32 s26, 4096
    s_mov_b32 s21, 41
    v_add_u32 v1, 66560, v2
    v_mbcnt_lo_u32_b32 v218, -1, 0
    v_mbcnt_hi_u32_b32 v218, -1, v218
    v_and_b32 v217, 15, v218
    v_lshlrev_b32 v217, 6, v217
    v_add_u32 v217, 158592, v217
    v_lshrrev_b32 v218, 4, v218
    v_lshl_add_u32 v216, v218, 2, v217
    s_lshl_b32 s49, s20, 4
    v_add_u32 v216, s49, v216
L_fb_loop:
    s_mov_b32 m0, s30
    s_nop 0
    buffer_load_dwordx4 v7, s[4:7], s22 offen offset:0 nt lds
    buffer_load_dwordx4 v7, s[4:7], s22 offen offset:1024 nt lds
    s_waitcnt vmcnt(0)
    s_barrier
    ds_read_b128 v[32:35], v1 offset:0
    ds_read_b128 v[36:39], v1 offset:256
    ds_read_b128 v[40:43], v1 offset:512
    ds_read_b128 v[44:47], v1 offset:768
    ds_read_b128 v[48:51], v1 offset:4160
    ds_read_b128 v[52:55], v1 offset:4416
    ds_read_b128 v[56:59], v1 offset:4672
    ds_read_b128 v[60:63], v1 offset:4928
    s_waitcnt lgkmcnt(7)
    v_mfma_f32_16x16x32_bf16 v[64:67], a[0:3], v[32:35], 0
    s_waitcnt lgkmcnt(6)
    v_mfma_f32_16x16x32_bf16 v[64:67], a[4:7], v[36:39], v[64:67]
    s_waitcnt lgkmcnt(5)
    v_mfma_f32_16x16x32_bf16 v[64:67], a[8:11], v[40:43], v[64:67]
    s_waitcnt lgkmcnt(4)
    v_mfma_f32_16x16x32_bf16 v[64:67], a[12:15], v[44:47], v[64:67]
    s_waitcnt lgkmcnt(3)
    v_mfma_f32_16x16x32_bf16 v[68:71], a[0:3], v[48:51], 0
    s_waitcnt lgkmcnt(2)
    v_mfma_f32_16x16x32_bf16 v[68:71], a[4:7], v[52:55], v[68:71]
    s_waitcnt lgkmcnt(1)
    v_mfma_f32_16x16x32_bf16 v[68:71], a[8:11], v[56:59], v[68:71]
    s_waitcnt lgkmcnt(0)
    v_mfma_f32_16x16x32_bf16 v[68:71], a[12:15], v[60:63], v[68:71]
    v_mfma_f32_16x16x32_bf16 v[72:75], a[16:19], v[32:35], 0
    v_mfma_f32_16x16x32_bf16 v[72:75], a[20:23], v[36:39], v[72:75]
    v_mfma_f32_16x16x32_bf16 v[72:75], a[24:27], v[40:43], v[72:75]
    v_mfma_f32_16x16x32_bf16 v[72:75], a[28:31], v[44:47], v[72:75]
    v_mfma_f32_16x16x32_bf16 v[76:79], a[16:19], v[48:51], 0
    v_mfma_f32_16x16x32_bf16 v[76:79], a[20:23], v[52:55], v[76:79]
    v_mfma_f32_16x16x32_bf16 v[76:79], a[24:27], v[56:59], v[76:79]
    v_mfma_f32_16x16x32_bf16 v[76:79], a[28:31], v[60:63], v[76:79]
    v_mfma_f32_16x16x32_bf16 v[80:83], a[32:35], v[32:35], 0
    v_mfma_f32_16x16x32_bf16 v[80:83], a[36:39], v[36:39], v[80:83]
    v_mfma_f32_16x16x32_bf16 v[80:83], a[40:43], v[40:43], v[80:83]
    v_mfma_f32_16x16x32_bf16 v[80:83], a[44:47], v[44:47], v[80:83]
    v_mfma_f32_16x16x32_bf16 v[84:87], a[32:35], v[48:51], 0
    v_mfma_f32_16x16x32_bf16 v[84:87], a[36:39], v[52:55], v[84:87]
    v_mfma_f32_16x16x32_bf16 v[84:87], a[40:43], v[56:59], v[84:87]
    v_mfma_f32_16x16x32_bf16 v[84:87], a[44:47], v[60:63], v[84:87]
    v_mfma_f32_16x16x32_bf16 v[88:91], a[48:51], v[32:35], 0
    v_mfma_f32_16x16x32_bf16 v[88:91], a[52:55], v[36:39], v[88:91]
    v_mfma_f32_16x16x32_bf16 v[88:91], a[56:59], v[40:43], v[88:91]
    v_mfma_f32_16x16x32_bf16 v[88:91], a[60:63], v[44:47], v[88:91]
    v_mfma_f32_16x16x32_bf16 v[92:95], a[48:51], v[48:51], 0
    v_mfma_f32_16x16x32_bf16 v[92:95], a[52:55], v[52:55], v[92:95]
    v_mfma_f32_16x16x32_bf16 v[92:95], a[56:59], v[56:59], v[92:95]
    v_mfma_f32_16x16x32_bf16 v[92:95], a[60:63], v[60:63], v[92:95]
    v_mfma_f32_16x16x32_bf16 v[96:99], a[64:67], v[32:35], 0
    v_mfma_f32_16x16x32_bf16 v[96:99], a[68:71], v[36:39], v[96:99]
    v_mfma_f32_16x16x32_bf16 v[96:99], a[72:75], v[40:43], v[96:99]
    v_mfma_f32_16x16x32_bf16 v[96:99], a[76:79], v[44:47], v[96:99]
    v_mfma_f32_16x16x32_bf16 v[100:103], a[64:67], v[48:51], 0
    v_mfma_f32_16x16x32_bf16 v[100:103], a[68:71], v[52:55], v[100:103]
    v_mfma_f32_16x16x32_bf16 v[100:103], a[72:75], v[56:59], v[100:103]
    v_mfma_f32_16x16x32_bf16 v[100:103], a[76:79], v[60:63], v[100:103]
    v_mfma_f32_16x16x32_bf16 v[104:107], a[80:83], v[32:35], 0
    v_mfma_f32_16x16x32_bf16 v[104:107], a[84:87], v[36:39], v[104:107]
    v_mfma_f32_16x16x32_bf16 v[104:107], a[88:91], v[40:43], v[104:107]
    v_mfma_f32_16x16x32_bf16 v[104:107], a[92:95], v[44:47], v[104:107]
    v_mfma_f32_16x16x32_bf16 v[108:111], a[80:83], v[48:51], 0
    v_mfma_f32_16x16x32_bf16 v[108:111], a[84:87], v[52:55], v[108:111]
    v_mfma_f32_16x16x32_bf16 v[108:111], a[88:91], v[56:59], v[108:111]
    v_mfma_f32_16x16x32_bf16 v[108:111], a[92:95], v[60:63], v[108:111]
    v_mfma_f32_16x16x32_bf16 v[112:115], a[96:99], v[32:35], 0
    v_mfma_f32_16x16x32_bf16 v[112:115], a[100:103], v[36:39], v[112:115]
    v_mfma_f32_16x16x32_bf16 v[112:115], a[104:107], v[40:43], v[112:115]
    v_mfma_f32_16x16x32_bf16 v[112:115], a[108:111], v[44:47], v[112:115]
    v_mfma_f32_16x16x32_bf16 v[116:119], a[96:99], v[48:51], 0
    v_mfma_f32_16x16x32_bf16 v[116:119], a[100:103], v[52:55], v[116:119]
    v_mfma_f32_16x16x32_bf16 v[116:119], a[104:107], v[56:59], v[116:119]
    v_mfma_f32_16x16x32_bf16 v[116:119], a[108:111], v[60:63], v[116:119]
    v_mfma_f32_16x16x32_bf16 v[120:123], a[112:115], v[32:35], 0
    v_mfma_f32_16x16x32_bf16 v[120:123], a[116:119], v[36:39], v[120:123]
    v_mfma_f32_16x16x32_bf16 v[120:123], a[120:123], v[40:43], v[120:123]
    v_mfma_f32_16x16x32_bf16 v[120:123], a[124:127], v[44:47], v[120:123]
    v_mfma_f32_16x16x32_bf16 v[124:127], a[112:115], v[48:51], 0
    v_mfma_f32_16x16x32_bf16 v[124:127], a[116:119], v[52:55], v[124:127]
    v_mfma_f32_16x16x32_bf16 v[124:127], a[120:123], v[56:59], v[124:127]
    v_mfma_f32_16x16x32_bf16 v[124:127], a[124:127], v[60:63], v[124:127]
    v_max_f32 v220, v64, v65
    v_max3_f32 v220, v220, v66, v67
    v_max3_f32 v220, v220, v72, v73
    v_max3_f32 v220, v220, v74, v75
    v_max3_f32 v220, v220, v80, v81
    v_max3_f32 v220, v220, v82, v83
    v_max3_f32 v220, v220, v88, v89
    v_max3_f32 v220, v220, v90, v91
    v_max3_f32 v220, v220, v96, v97
    v_max3_f32 v220, v220, v98, v99
    v_max3_f32 v220, v220, v104, v105
    v_max3_f32 v220, v220, v106, v107
    v_max3_f32 v220, v220, v112, v113
    v_max3_f32 v220, v220, v114, v115
    v_max3_f32 v220, v220, v120, v121
    v_max3_f32 v220, v220, v122, v123
    ds_write_b32 v216, v220 offset:0
    v_max_f32 v221, v68, v69
    v_max3_f32 v221, v221, v70, v71
    v_max3_f32 v221, v221, v76, v77
    v_max3_f32 v221, v221, v78, v79
    v_max3_f32 v221, v221, v84, v85
    v_max3_f32 v221, v221, v86, v87
    v_max3_f32 v221, v221, v92, v93
    v_max3_f32 v221, v221, v94, v95
    v_max3_f32 v221, v221, v100, v101
    v_max3_f32 v221, v221, v102, v103
    v_max3_f32 v221, v221, v108, v109
    v_max3_f32 v221, v221, v110, v111
    v_max3_f32 v221, v221, v116, v117
    v_max3_f32 v221, v221, v118, v119
    v_max3_f32 v221, v221, v124, v125
    v_max3_f32 v221, v221, v126, v127
    ds_write_b32 v216, v221 offset:1024
    s_waitcnt lgkmcnt(0)
    s_barrier
    ds_read_b128 v[224:227], v217 offset:0
    ds_read_b128 v[228:231], v217 offset:16
    ds_read_b128 v[232:235], v217 offset:32
    ds_read_b128 v[236:239], v217 offset:48
    s_waitcnt lgkmcnt(3)
    v_max_f32 v220, v224, v225
    v_max3_f32 v220, v220, v226, v227
    s_waitcnt lgkmcnt(2)
    v_max3_f32 v220, v220, v228, v229
    v_max3_f32 v220, v220, v230, v231
    s_waitcnt lgkmcnt(1)
    v_max3_f32 v220, v220, v232, v233
    v_max3_f32 v220, v220, v234, v235
    s_waitcnt lgkmcnt(0)
    v_max3_f32 v220, v220, v236, v237
    v_max3_f32 v220, v220, v238, v239
    ds_read_b128 v[224:227], v217 offset:1024
    ds_read_b128 v[228:231], v217 offset:1040
    ds_read_b128 v[232:235], v217 offset:1056
    ds_read_b128 v[236:239], v217 offset:1072
    s_waitcnt lgkmcnt(3)
    v_max_f32 v221, v224, v225
    v_max3_f32 v221, v221, v226, v227
    s_waitcnt lgkmcnt(2)
    v_max3_f32 v221, v221, v228, v229
    v_max3_f32 v221, v221, v230, v231
    s_waitcnt lgkmcnt(1)
    v_max3_f32 v221, v221, v232, v233
    v_max3_f32 v221, v221, v234, v235
    s_waitcnt lgkmcnt(0)
    v_max3_f32 v221, v221, v236, v237
    v_max3_f32 v221, v221, v238, v239
    v_sub_f32 v64, v64, v220
    v_sub_f32 v65, v65, v220
    v_sub_f32 v66, v66, v220
    v_sub_f32 v67, v67, v220
    v_exp_f32 v64, v64
    v_exp_f32 v65, v65
    v_exp_f32 v66, v66
    v_exp_f32 v67, v67
    v_cvt_pk_bf16_f32 v128, v64, v65
    v_cvt_pk_bf16_f32 v129, v66, v67
    v_sub_f32 v68, v68, v221
    v_sub_f32 v69, v69, v221
    v_sub_f32 v70, v70, v221
    v_sub_f32 v71, v71, v221
    v_exp_f32 v68, v68
    v_exp_f32 v69, v69
    v_exp_f32 v70, v70
    v_exp_f32 v71, v71
    v_cvt_pk_bf16_f32 v132, v68, v69
    v_cvt_pk_bf16_f32 v133, v70, v71
    v_sub_f32 v72, v72, v220
    v_sub_f32 v73, v73, v220
    v_sub_f32 v74, v74, v220
    v_sub_f32 v75, v75, v220
    v_exp_f32 v72, v72
    v_exp_f32 v73, v73
    v_exp_f32 v74, v74
    v_exp_f32 v75, v75
    v_cvt_pk_bf16_f32 v130, v72, v73
    v_cvt_pk_bf16_f32 v131, v74, v75
    v_sub_f32 v76, v76, v221
    v_sub_f32 v77, v77, v221
    v_sub_f32 v78, v78, v221
    v_sub_f32 v79, v79, v221
    v_exp_f32 v76, v76
    v_exp_f32 v77, v77
    v_exp_f32 v78, v78
    v_exp_f32 v79, v79
    v_cvt_pk_bf16_f32 v134, v76, v77
    v_cvt_pk_bf16_f32 v135, v78, v79
    v_sub_f32 v80, v80, v220
    v_sub_f32 v81, v81, v220
    v_sub_f32 v82, v82, v220
    v_sub_f32 v83, v83, v220
    v_exp_f32 v80, v80
    v_exp_f32 v81, v81
    v_exp_f32 v82, v82
    v_exp_f32 v83, v83
    v_cvt_pk_bf16_f32 v136, v80, v81
    v_cvt_pk_bf16_f32 v137, v82, v83
    v_sub_f32 v84, v84, v221
    v_sub_f32 v85, v85, v221
    v_sub_f32 v86, v86, v221
    v_sub_f32 v87, v87, v221
    v_exp_f32 v84, v84
    v_exp_f32 v85, v85
    v_exp_f32 v86, v86
    v_exp_f32 v87, v87
    v_cvt_pk_bf16_f32 v140, v84, v85
    v_cvt_pk_bf16_f32 v141, v86, v87
    v_sub_f32 v88, v88, v220
    v_sub_f32 v89, v89, v220
    v_sub_f32 v90, v90, v220
    v_sub_f32 v91, v91, v220
    v_exp_f32 v88, v88
    v_exp_f32 v89, v89
    v_exp_f32 v90, v90
    v_exp_f32 v91, v91
    v_cvt_pk_bf16_f32 v138, v88, v89
    v_cvt_pk_bf16_f32 v139, v90, v91
    v_sub_f32 v92, v92, v221
    v_sub_f32 v93, v93, v221
    v_sub_f32 v94, v94, v221
    v_sub_f32 v95, v95, v221
    v_exp_f32 v92, v92
    v_exp_f32 v93, v93
    v_exp_f32 v94, v94
    v_exp_f32 v95, v95
    v_cvt_pk_bf16_f32 v142, v92, v93
    v_cvt_pk_bf16_f32 v143, v94, v95
    v_sub_f32 v96, v96, v220
    v_sub_f32 v97, v97, v220
    v_sub_f32 v98, v98, v220
    v_sub_f32 v99, v99, v220
    v_exp_f32 v96, v96
    v_exp_f32 v97, v97
    v_exp_f32 v98, v98
    v_exp_f32 v99, v99
    v_cvt_pk_bf16_f32 v144, v96, v97
    v_cvt_pk_bf16_f32 v145, v98, v99
    v_sub_f32 v100, v100, v221
    v_sub_f32 v101, v101, v221
    v_sub_f32 v102, v102, v221
    v_sub_f32 v103, v103, v221
    v_exp_f32 v100, v100
    v_exp_f32 v101, v101
    v_exp_f32 v102, v102
    v_exp_f32 v103, v103
    v_cvt_pk_bf16_f32 v148, v100, v101
    v_cvt_pk_bf16_f32 v149, v102, v103
    v_sub_f32 v104, v104, v220
    v_sub_f32 v105, v105, v220
    v_sub_f32 v106, v106, v220
    v_sub_f32 v107, v107, v220
    v_exp_f32 v104, v104
    v_exp_f32 v105, v105
    v_exp_f32 v106, v106
    v_exp_f32 v107, v107
    v_cvt_pk_bf16_f32 v146, v104, v105
    v_cvt_pk_bf16_f32 v147, v106, v107
    v_sub_f32 v108, v108, v221
    v_sub_f32 v109, v109, v221
    v_sub_f32 v110, v110, v221
    v_sub_f32 v111, v111, v221
    v_exp_f32 v108, v108
    v_exp_f32 v109, v109
    v_exp_f32 v110, v110
    v_exp_f32 v111, v111
    v_cvt_pk_bf16_f32 v150, v108, v109
    v_cvt_pk_bf16_f32 v151, v110, v111
    v_sub_f32 v112, v112, v220
    v_sub_f32 v113, v113, v220
    v_sub_f32 v114, v114, v220
    v_sub_f32 v115, v115, v220
    v_exp_f32 v112, v112
    v_exp_f32 v113, v113
    v_exp_f32 v114, v114
    v_exp_f32 v115, v115
    v_cvt_pk_bf16_f32 v152, v112, v113
    v_cvt_pk_bf16_f32 v153, v114, v115
    v_sub_f32 v116, v116, v221
    v_sub_f32 v117, v117, v221
    v_sub_f32 v118, v118, v221
    v_sub_f32 v119, v119, v221
    v_exp_f32 v116, v116
    v_exp_f32 v117, v117
    v_exp_f32 v118, v118
    v_exp_f32 v119, v119
    v_cvt_pk_bf16_f32 v156, v116, v117
    v_cvt_pk_bf16_f32 v157, v118, v119
    v_sub_f32 v120, v120, v220
    v_sub_f32 v121, v121, v220
    v_sub_f32 v122, v122, v220
    v_sub_f32 v123, v123, v220
    v_exp_f32 v120, v120
    v_exp_f32 v121, v121
    v_exp_f32 v122, v122
    v_exp_f32 v123, v123
    v_cvt_pk_bf16_f32 v154, v120, v121
    v_cvt_pk_bf16_f32 v155, v122, v123
    v_sub_f32 v124, v124, v221
    v_sub_f32 v125, v125, v221
    v_sub_f32 v126, v126, v221
    v_sub_f32 v127, v127, v221
    v_exp_f32 v124, v124
    v_exp_f32 v125, v125
    v_exp_f32 v126, v126
    v_exp_f32 v127, v127
    v_cvt_pk_bf16_f32 v158, v124, v125
    v_cvt_pk_bf16_f32 v159, v126, v127
    ds_write_b128 v3, v[128:131] offset:0
    ds_write_b128 v3, v[132:135] offset:1024
    ds_write_b128 v3, v[136:139] offset:2048
    ds_write_b128 v3, v[140:143] offset:3072
    ds_write_b128 v3, v[144:147] offset:4096
    ds_write_b128 v3, v[148:151] offset:5120
    ds_write_b128 v3, v[152:155] offset:6144
    ds_write_b128 v3, v[156:159] offset:7168
    v_mfma_f32_16x16x32_bf16 v[20:23], v[24:27], v[128:131], 0
    v_mfma_f32_16x16x32_bf16 v[20:23], v[24:27], v[136:139], v[20:23]
    v_mfma_f32_16x16x32_bf16 v[20:23], v[24:27], v[144:147], v[20:23]
    v_mfma_f32_16x16x32_bf16 v[20:23], v[24:27], v[152:155], v[20:23]
    v_mfma_f32_16x16x32_bf16 v[20:23], v[28:31], v[132:135], v[20:23]
    v_mfma_f32_16x16x32_bf16 v[20:23], v[28:31], v[140:143], v[20:23]
    v_mfma_f32_16x16x32_bf16 v[20:23], v[28:31], v[148:151], v[20:23]
    v_mfma_f32_16x16x32_bf16 v[20:23], v[28:31], v[156:159], v[20:23]
    s_nop 7
    ds_write_b32 v9, v20 offset:0
    s_waitcnt lgkmcnt(0)
    s_barrier
    v_mfma_f32_16x16x32_bf16 v[160:163], a[128:131], v[128:131], 0
    v_mfma_f32_16x16x32_bf16 v[160:163], a[136:139], v[136:139], v[160:163]
    v_mfma_f32_16x16x32_bf16 v[160:163], a[144:147], v[144:147], v[160:163]
    v_mfma_f32_16x16x32_bf16 v[160:163], a[152:155], v[152:155], v[160:163]
    v_mfma_f32_16x16x32_bf16 v[164:167], a[132:135], v[128:131], 0
    v_mfma_f32_16x16x32_bf16 v[164:167], a[140:143], v[136:139], v[164:167]
    v_mfma_f32_16x16x32_bf16 v[164:167], a[148:151], v[144:147], v[164:167]
    v_mfma_f32_16x16x32_bf16 v[164:167], a[156:159], v[152:155], v[164:167]
    v_mfma_f32_16x16x32_bf16 v[168:171], a[128:131], v[132:135], 0
    v_mfma_f32_16x16x32_bf16 v[168:171], a[136:139], v[140:143], v[168:171]
    v_mfma_f32_16x16x32_bf16 v[168:171], a[144:147], v[148:151], v[168:171]
    v_mfma_f32_16x16x32_bf16 v[168:171], a[152:155], v[156:159], v[168:171]
    v_mfma_f32_16x16x32_bf16 v[172:175], a[132:135], v[132:135], 0
    v_mfma_f32_16x16x32_bf16 v[172:175], a[140:143], v[140:143], v[172:175]
    v_mfma_f32_16x16x32_bf16 v[172:175], a[148:151], v[148:151], v[172:175]
    v_mfma_f32_16x16x32_bf16 v[172:175], a[156:159], v[156:159], v[172:175]
    ds_read_b128 v[224:227], v4 offset:0
    ds_read_b128 v[228:231], v4 offset:2048
    ds_read_b128 v[232:235], v4 offset:4096
    ds_read_b128 v[236:239], v4 offset:6144
    s_waitcnt lgkmcnt(3)
    v_mfma_f32_16x16x32_bf16 v[160:163], a[160:163], v[224:227], v[160:163]
    s_waitcnt lgkmcnt(2)
    v_mfma_f32_16x16x32_bf16 v[160:163], a[168:171], v[228:231], v[160:163]
    s_waitcnt lgkmcnt(1)
    v_mfma_f32_16x16x32_bf16 v[160:163], a[176:179], v[232:235], v[160:163]
    s_waitcnt lgkmcnt(0)
    v_mfma_f32_16x16x32_bf16 v[160:163], a[184:187], v[236:239], v[160:163]
    v_mfma_f32_16x16x32_bf16 v[164:167], a[164:167], v[224:227], v[164:167]
    v_mfma_f32_16x16x32_bf16 v[164:167], a[172:175], v[228:231], v[164:167]
    v_mfma_f32_16x16x32_bf16 v[164:167], a[180:183], v[232:235], v[164:167]
    v_mfma_f32_16x16x32_bf16 v[164:167], a[188:191], v[236:239], v[164:167]
    ds_read_b128 v[224:227], v4 offset:1024
    ds_read_b128 v[228:231], v4 offset:3072
    ds_read_b128 v[232:235], v4 offset:5120
    ds_read_b128 v[236:239], v4 offset:7168
    s_waitcnt lgkmcnt(3)
    v_mfma_f32_16x16x32_bf16 v[168:171], a[160:163], v[224:227], v[168:171]
    s_waitcnt lgkmcnt(2)
    v_mfma_f32_16x16x32_bf16 v[168:171], a[168:171], v[228:231], v[168:171]
    s_waitcnt lgkmcnt(1)
    v_mfma_f32_16x16x32_bf16 v[168:171], a[176:179], v[232:235], v[168:171]
    s_waitcnt lgkmcnt(0)
    v_mfma_f32_16x16x32_bf16 v[168:171], a[184:187], v[236:239], v[168:171]
    v_mfma_f32_16x16x32_bf16 v[172:175], a[164:167], v[224:227], v[172:175]
    v_mfma_f32_16x16x32_bf16 v[172:175], a[172:175], v[228:231], v[172:175]
    v_mfma_f32_16x16x32_bf16 v[172:175], a[180:183], v[232:235], v[172:175]
    v_mfma_f32_16x16x32_bf16 v[172:175], a[188:191], v[236:239], v[172:175]
    ds_read_b128 v[224:227], v5 offset:0
    ds_read_b128 v[228:231], v5 offset:2048
    ds_read_b128 v[232:235], v5 offset:4096
    ds_read_b128 v[236:239], v5 offset:6144
    s_waitcnt lgkmcnt(3)
    v_mfma_f32_16x16x32_bf16 v[160:163], a[192:195], v[224:227], v[160:163]
    s_waitcnt lgkmcnt(2)
    v_mfma_f32_16x16x32_bf16 v[160:163], a[200:203], v[228:231], v[160:163]
    s_waitcnt lgkmcnt(1)
    v_mfma_f32_16x16x32_bf16 v[160:163], a[208:211], v[232:235], v[160:163]
    s_waitcnt lgkmcnt(0)
    v_mfma_f32_16x16x32_bf16 v[160:163], a[216:219], v[236:239], v[160:163]
    v_mfma_f32_16x16x32_bf16 v[164:167], a[196:199], v[224:227], v[164:167]
    v_mfma_f32_16x16x32_bf16 v[164:167], a[204:207], v[228:231], v[164:167]
    v_mfma_f32_16x16x32_bf16 v[164:167], a[212:215], v[232:235], v[164:167]
    v_mfma_f32_16x16x32_bf16 v[164:167], a[220:223], v[236:239], v[164:167]
    ds_read_b128 v[224:227], v5 offset:1024
    ds_read_b128 v[228:231], v5 offset:3072
    ds_read_b128 v[232:235], v5 offset:5120
    ds_read_b128 v[236:239], v5 offset:7168
    s_waitcnt lgkmcnt(3)
    v_mfma_f32_16x16x32_bf16 v[168:171], a[192:195], v[224:227], v[168:171]
    s_waitcnt lgkmcnt(2)
    v_mfma_f32_16x16x32_bf16 v[168:171], a[200:203], v[228:231], v[168:171]
    s_waitcnt lgkmcnt(1)
    v_mfma_f32_16x16x32_bf16 v[168:171], a[208:211], v[232:235], v[168:171]
    s_waitcnt lgkmcnt(0)
    v_mfma_f32_16x16x32_bf16 v[168:171], a[216:219], v[236:239], v[168:171]
    v_mfma_f32_16x16x32_bf16 v[172:175], a[196:199], v[224:227], v[172:175]
    v_mfma_f32_16x16x32_bf16 v[172:175], a[204:207], v[228:231], v[172:175]
    v_mfma_f32_16x16x32_bf16 v[172:175], a[212:215], v[232:235], v[172:175]
    v_mfma_f32_16x16x32_bf16 v[172:175], a[220:223], v[236:239], v[172:175]
    ds_read_b128 v[224:227], v6 offset:0
    ds_read_b128 v[228:231], v6 offset:2048
    ds_read_b128 v[232:235], v6 offset:4096
    ds_read_b128 v[236:239], v6 offset:6144
    s_waitcnt lgkmcnt(3)
    v_mfma_f32_16x16x32_bf16 v[160:163], a[224:227], v[224:227], v[160:163]
    s_waitcnt lgkmcnt(2)
    v_mfma_f32_16x16x32_bf16 v[160:163], a[232:235], v[228:231], v[160:163]
    s_waitcnt lgkmcnt(1)
    v_mfma_f32_16x16x32_bf16 v[160:163], a[240:243], v[232:235], v[160:163]
    s_waitcnt lgkmcnt(0)
    v_mfma_f32_16x16x32_bf16 v[160:163], a[248:251], v[236:239], v[160:163]
    v_mfma_f32_16x16x32_bf16 v[164:167], a[228:231], v[224:227], v[164:167]
    v_mfma_f32_16x16x32_bf16 v[164:167], a[236:239], v[228:231], v[164:167]
    v_mfma_f32_16x16x32_bf16 v[164:167], a[244:247], v[232:235], v[164:167]
    v_mfma_f32_16x16x32_bf16 v[164:167], a[252:255], v[236:239], v[164:167]
    ds_read_b128 v[224:227], v6 offset:1024
    ds_read_b128 v[228:231], v6 offset:3072
    ds_read_b128 v[232:235], v6 offset:5120
    ds_read_b128 v[236:239], v6 offset:7168
    s_waitcnt lgkmcnt(3)
    v_mfma_f32_16x16x32_bf16 v[168:171], a[224:227], v[224:227], v[168:171]
    s_waitcnt lgkmcnt(2)
    v_mfma_f32_16x16x32_bf16 v[168:171], a[232:235], v[228:231], v[168:171]
    s_waitcnt lgkmcnt(1)
    v_mfma_f32_16x16x32_bf16 v[168:171], a[240:243], v[232:235], v[168:171]
    s_waitcnt lgkmcnt(0)
    v_mfma_f32_16x16x32_bf16 v[168:171], a[248:251], v[236:239], v[168:171]
    v_mfma_f32_16x16x32_bf16 v[172:175], a[228:231], v[224:227], v[172:175]
    v_mfma_f32_16x16x32_bf16 v[172:175], a[236:239], v[228:231], v[172:175]
    v_mfma_f32_16x16x32_bf16 v[172:175], a[244:247], v[232:235], v[172:175]
    v_mfma_f32_16x16x32_bf16 v[172:175], a[252:255], v[236:239], v[172:175]
    ds_read_b128 v[16:19], v10 offset:0
    s_waitcnt lgkmcnt(0)
    v_add_f32 v16, v16, v17
    v_add_f32 v18, v18, v19
    v_add_f32 v16, v16, v18
    v_rcp_f32 v13, v16
    s_nop 0
    v_mov_b32 v14, v13
    s_nop 1
    v_permlane32_swap_b32 v13, v14
    v_mul_f32 v160, v160, v13
    v_mul_f32 v161, v161, v13
    v_cvt_pk_bf16_f32 v192, v160, v161
    v_mul_f32 v162, v162, v13
    v_mul_f32 v163, v163, v13
    v_cvt_pk_bf16_f32 v193, v162, v163
    v_mul_f32 v164, v164, v13
    v_mul_f32 v165, v165, v13
    v_cvt_pk_bf16_f32 v194, v164, v165
    v_mul_f32 v166, v166, v13
    v_mul_f32 v167, v167, v13
    v_cvt_pk_bf16_f32 v195, v166, v167
    buffer_store_dwordx4 v[192:195], v8, s[16:19], s25 offen sc0 sc1
    v_mul_f32 v168, v168, v14
    v_mul_f32 v169, v169, v14
    v_cvt_pk_bf16_f32 v196, v168, v169
    v_mul_f32 v170, v170, v14
    v_mul_f32 v171, v171, v14
    v_cvt_pk_bf16_f32 v197, v170, v171
    v_mul_f32 v172, v172, v14
    v_mul_f32 v173, v173, v14
    v_cvt_pk_bf16_f32 v198, v172, v173
    v_mul_f32 v174, v174, v14
    v_mul_f32 v175, v175, v14
    v_cvt_pk_bf16_f32 v199, v174, v175
    buffer_store_dwordx4 v[196:199], v8, s[16:19], s26 offen sc0 sc1
    s_add_u32 s25, s25, 8192
    s_add_u32 s26, s26, 8192
    s_add_u32 s22, s22, 8192
    s_waitcnt vmcnt(0) lgkmcnt(0)
    s_barrier
    s_sub_u32 s21, s21, 1
    s_cmp_lg_u32 s21, 0
    s_cbranch_scc1 L_fb_loop
L_end:
    s_endpgm
.section .rodata,"a"
.p2align 6
.amdhsa_kernel standalone__mha_softmax__near_ridge_kernel
  .amdhsa_next_free_vgpr 512
  .amdhsa_next_free_sgpr 102
  .amdhsa_accum_offset 256
  .amdhsa_group_segment_fixed_size 0
  .amdhsa_kernarg_size 48
  .amdhsa_user_sgpr_count 2
  .amdhsa_user_sgpr_kernarg_segment_ptr 1
  .amdhsa_system_sgpr_workgroup_id_x 1
.end_amdhsa_kernel
```
